```python
import torch

def _softmax(x, axis=-1):
    return torch.softmax(x, dim=axis)
def _gelu(x):
    return torch.nn.functional.gelu(x, approximate="tanh")
def _silu(x):
    return torch.nn.functional.silu(x)
def _sigmoid(x):
    return torch.sigmoid(x)
def _layernorm(x, axis=-1, eps=1e-5):
    m = x.mean(dim=axis, keepdim=True)
    v = x.var(dim=axis, keepdim=True, unbiased=False)
    return (x - m) / torch.sqrt(v + eps)
def _scatter_add(tgt, idx, src, axis=0):
    return tgt.clone().index_add_(axis, idx, src)
def _segment_sum(src, seg, n):
    out = torch.zeros((n,) + src.shape[1:], dtype=src.dtype)
    return out.index_add_(0, seg, src)
def _pad(x, pw):
    flat = tuple(v for pair in reversed(pw) for v in pair)
    return torch.nn.functional.pad(x, flat)

kernel_name = 'standalone__grouped_kv_mqa__prompt'

def setup_inputs():

    _w = (lambda a: (lambda t: t.to(torch.bfloat16) if t.is_floating_point() else t)(torch.as_tensor(a)))
    B, S, D, H = 1, 2048, 1024, 32
    Dh = D // H
    return {
        "x": _w((lambda *s: torch.randn(*s, dtype=torch.bfloat16) * 0.05)(B, S, D)),
        "wq": _w((lambda *s: torch.randn(*s, dtype=torch.bfloat16) * 0.8)(D, H * Dh)),
        "wk": _w((lambda *s: torch.randn(*s, dtype=torch.bfloat16) * 0.8)(D, Dh)),
        "wv": _w((lambda *s: torch.randn(*s, dtype=torch.bfloat16) * 0.05)(D, Dh)),
        "wo": _w((lambda *s: torch.randn(*s, dtype=torch.bfloat16) * 0.05)(H * Dh, D)),
    }

def reference(x, wq, wk, wv, wo):
    B, S, D = x.shape
    H = 32
    Dh = D // H
    q = (lambda x, *d: x.permute(*d))((x @ wq).reshape(B, S, H, Dh), 0, 2, 1, 3)
    k = x @ wk
    v = x @ wv
    scores = torch.einsum("bhqd,bkd->bhqk", q, k) * (Dh ** -0.5)
    p = _softmax(scores, axis=-1)
    o = torch.einsum("bhqk,bkd->bhqd", p, v)
    return (lambda x, *d: x.permute(*d))(o, 0, 2, 1, 3).reshape(B, S, H * Dh) @ wo
```

```asm
; @launch grid=(256,1,1) block=(320,1,1) lds=163840
.amdgcn_target "amdgcn-amd-amdhsa--gfx950"
.text
.globl standalone__grouped_kv_mqa__prompt_kernel
.p2align 8
.type standalone__grouped_kv_mqa__prompt_kernel,@function
standalone__grouped_kv_mqa__prompt_kernel:
    s_cmp_ge_u32 s2, 256
    s_cbranch_scc1 L_end
    s_load_dwordx16 s[4:19], s[0:1], 0
    v_lshrrev_b32 v2, 6, v0
    s_and_b32 s49, s2, 7
    v_readfirstlane_b32 s48, v2
    s_lshr_b32 s50, s2, 3
    s_getpc_b64 s[72:73]
L_pc:
    v_and_b32 v0, 63, v0
    v_mad_u32_u24 v3, v2, 3, v0
    v_lshl_add_u32 v3, v3, 5, s50
    v_lshlrev_b32 v3, 7, v3
    v_min_u32 v3, L_end-L_pc, v3
    s_mov_b64 exec, 7
    global_load_dword v254, v3, s[72:73]
    s_mov_b64 exec, -1
    v_lshlrev_b32 v1, 4, v0
    s_lshr_b32 s56, s50, 3
    s_lshr_b32 s51, s49, 1
    s_lshl_b32 s51, s51, 2
    s_add_u32 s51, s51, s56
    s_and_b32 s52, s49, 1
    s_lshl_b32 s52, s52, 3
    s_and_b32 s56, s50, 7
    s_add_u32 s52, s52, s56
    s_lshr_b32 s56, s52, 1
    s_and_b32 s54, s52, 1
    s_lshl_b32 s53, s51, 3
    s_add_u32 s53, s53, s56
    s_mov_b32 s67, 0
    s_cmp_eq_u32 s48, 0
    s_cbranch_scc1 L_loader
    s_sub_u32 s48, s48, 1
    s_lshl_b32 s56, s50, 2
    s_add_u32 s56, s56, s48
    s_and_b32 s56, s56, 63
    s_lshl_b32 s56, s56, 10
    v_and_b32 v3, 7, v0
    v_lshl_add_u32 v3, v3, 7, s56
    s_mov_b64 exec, 0xff
    s_cmp_lt_u32 s50, 16
    s_waitcnt lgkmcnt(0)
    s_cselect_b32 s58, s8, s10
    s_cselect_b32 s59, s9, s11
    global_load_dword v255, v3, s[58:59]
    s_mov_b64 exec, -1
    s_branch L_compute
L_loader:
    v_lshrrev_b32 v2, 3, v0
    v_lshrrev_b32 v3, 4, v0
    v_and_b32 v4, 7, v0
    v_xor_b32 v5, v4, v3
    v_lshlrev_b32 v2, 11, v2
    v_lshl_add_u32 v6, v5, 4, v2
    v_xor_b32 v7, 64, v6
    v_add_u32 v7, 15360, v7
    s_lshl_b32 s58, s53, 15
    s_lshl_b32 s59, s54, 8
    s_add_u32 s58, s58, s59
    s_lshl_b32 s59, s54, 13
    s_lshl_b32 s88, s54, 12
    s_mov_b32 s22, 4194304
    s_mov_b32 s23, 0x20000
    s_mov_b32 s30, 65536
    s_mov_b32 s31, 0x20000
    s_waitcnt lgkmcnt(0)
    s_mov_b32 s20, s4
    s_mov_b32 s21, s5
    s_cmp_eq_u32 s54, 0
    s_cselect_b32 s28, s8, s10
    s_cselect_b32 s29, s9, s11
    s_add_u32 m0, s88, 0
    s_add_u32 s66, s58, 0
    buffer_load_dwordx4 v6, s[20:23], s66 offen offset:0 lds
    buffer_load_dwordx4 v7, s[20:23], s66 offen offset:1024 lds
    s_mov_b32 m0, 114688
    s_add_u32 s66, s59, 0
    buffer_load_dwordx4 v1, s[28:31], s66 offen offset:0 lds
    buffer_load_dwordx4 v1, s[28:31], s66 offen offset:1024 lds
    buffer_load_dwordx4 v1, s[28:31], s66 offen offset:2048 lds
    buffer_load_dwordx4 v1, s[28:31], s66 offen offset:3072 lds
    s_add_u32 m0, s88, 2048
    s_add_u32 s66, s58, 128
    buffer_load_dwordx4 v6, s[20:23], s66 offen offset:0 lds
    buffer_load_dwordx4 v7, s[20:23], s66 offen offset:1024 lds
    s_mov_b32 m0, 118784
    s_add_u32 s66, s59, 4096
    buffer_load_dwordx4 v1, s[28:31], s66 offen offset:0 lds
    buffer_load_dwordx4 v1, s[28:31], s66 offen offset:1024 lds
    buffer_load_dwordx4 v1, s[28:31], s66 offen offset:2048 lds
    buffer_load_dwordx4 v1, s[28:31], s66 offen offset:3072 lds
    s_add_u32 m0, s88, 8192
    s_add_u32 s66, s58, 512
    buffer_load_dwordx4 v6, s[20:23], s66 offen offset:0 lds
    buffer_load_dwordx4 v7, s[20:23], s66 offen offset:1024 lds
    s_mov_b32 m0, 122880
    s_add_u32 s66, s59, 16384
    buffer_load_dwordx4 v1, s[28:31], s66 offen offset:0 lds
    buffer_load_dwordx4 v1, s[28:31], s66 offen offset:1024 lds
    buffer_load_dwordx4 v1, s[28:31], s66 offen offset:2048 lds
    buffer_load_dwordx4 v1, s[28:31], s66 offen offset:3072 lds
    s_add_u32 m0, s88, 10240
    s_add_u32 s66, s58, 640
    buffer_load_dwordx4 v6, s[20:23], s66 offen offset:0 lds
    buffer_load_dwordx4 v7, s[20:23], s66 offen offset:1024 lds
    s_mov_b32 m0, 126976
    s_add_u32 s66, s59, 20480
    buffer_load_dwordx4 v1, s[28:31], s66 offen offset:0 lds
    buffer_load_dwordx4 v1, s[28:31], s66 offen offset:1024 lds
    buffer_load_dwordx4 v1, s[28:31], s66 offen offset:2048 lds
    buffer_load_dwordx4 v1, s[28:31], s66 offen offset:3072 lds
    s_add_u32 m0, s88, 16384
    s_add_u32 s66, s58, 1024
    buffer_load_dwordx4 v6, s[20:23], s66 offen offset:0 lds
    buffer_load_dwordx4 v7, s[20:23], s66 offen offset:1024 lds
    s_mov_b32 m0, 131072
    s_add_u32 s66, s59, 32768
    buffer_load_dwordx4 v1, s[28:31], s66 offen offset:0 lds
    buffer_load_dwordx4 v1, s[28:31], s66 offen offset:1024 lds
    buffer_load_dwordx4 v1, s[28:31], s66 offen offset:2048 lds
    buffer_load_dwordx4 v1, s[28:31], s66 offen offset:3072 lds
    s_add_u32 m0, s88, 18432
    s_add_u32 s66, s58, 1152
    buffer_load_dwordx4 v6, s[20:23], s66 offen offset:0 lds
    buffer_load_dwordx4 v7, s[20:23], s66 offen offset:1024 lds
    s_mov_b32 m0, 135168
    s_add_u32 s66, s59, 36864
    buffer_load_dwordx4 v1, s[28:31], s66 offen offset:0 lds
    buffer_load_dwordx4 v1, s[28:31], s66 offen offset:1024 lds
    buffer_load_dwordx4 v1, s[28:31], s66 offen offset:2048 lds
    buffer_load_dwordx4 v1, s[28:31], s66 offen offset:3072 lds
    s_add_u32 m0, s88, 24576
    s_add_u32 s66, s58, 1536
    buffer_load_dwordx4 v6, s[20:23], s66 offen offset:0 lds
    buffer_load_dwordx4 v7, s[20:23], s66 offen offset:1024 lds
    s_mov_b32 m0, 139264
    s_add_u32 s66, s59, 49152
    buffer_load_dwordx4 v1, s[28:31], s66 offen offset:0 lds
    buffer_load_dwordx4 v1, s[28:31], s66 offen offset:1024 lds
    buffer_load_dwordx4 v1, s[28:31], s66 offen offset:2048 lds
    buffer_load_dwordx4 v1, s[28:31], s66 offen offset:3072 lds
    s_add_u32 m0, s88, 26624
    s_add_u32 s66, s58, 1664
    buffer_load_dwordx4 v6, s[20:23], s66 offen offset:0 lds
    buffer_load_dwordx4 v7, s[20:23], s66 offen offset:1024 lds
    s_mov_b32 m0, 143360
    s_add_u32 s66, s59, 53248
    buffer_load_dwordx4 v1, s[28:31], s66 offen offset:0 lds
    buffer_load_dwordx4 v1, s[28:31], s66 offen offset:1024 lds
    buffer_load_dwordx4 v1, s[28:31], s66 offen offset:2048 lds
    buffer_load_dwordx4 v1, s[28:31], s66 offen offset:3072 lds
    s_mov_b32 s24, s6
    s_mov_b32 s25, s7
    s_mov_b32 s26, 2097152
    s_mov_b32 s27, 0x20000
    v_and_b32 v5, 1, v3
    v_lshlrev_b32 v14, 1, v5
    v_xor_b32 v14, v4, v14
    v_lshl_add_u32 v10, v14, 4, v2
    v_xor_b32 v11, 64, v10
    v_add_u32 v11, 15360, v11
    v_add_u32 v12, 30720, v10
    v_add_u32 v13, 30720, v11
    s_lshr_b32 s56, s51, 1
    s_mul_i32 s55, s56, 8
    s_lshr_b32 s56, s51, 2
    s_mul_i32 s56, s56, 2
    s_add_u32 s55, s55, s56
    s_and_b32 s56, s51, 1
    s_mul_i32 s56, s56, 1
    s_add_u32 s55, s55, s56
    s_mul_i32 s56, s52, 8
    s_add_u32 s55, s55, s56
    s_lshl_b32 s60, s51, 18
    s_lshl_b32 s61, s52, 7
    s_add_u32 s56, s55, 0
    s_and_b32 s56, s56, 15
    s_lshl_b32 s66, s56, 17
    s_add_u32 s66, s66, s61
    s_mov_b32 m0, 81920
    s_nop 0
    buffer_load_dwordx4 v10, s[24:27], s66 offen offset:0 lds
    buffer_load_dwordx4 v11, s[24:27], s66 offen offset:1024 lds
    buffer_load_dwordx4 v12, s[24:27], s66 offen offset:2048 lds
    buffer_load_dwordx4 v13, s[24:27], s66 offen offset:3072 lds
    s_mov_b32 m0, 86016
    s_add_u32 s66, s66, 65536
    buffer_load_dwordx4 v10, s[24:27], s66 offen offset:0 lds
    buffer_load_dwordx4 v11, s[24:27], s66 offen offset:1024 lds
    buffer_load_dwordx4 v12, s[24:27], s66 offen offset:2048 lds
    buffer_load_dwordx4 v13, s[24:27], s66 offen offset:3072 lds
    s_xor_b32 s58, s58, 256
    s_xor_b32 s59, s59, 8192
    s_xor_b32 s88, s88, 4096
    s_bfe_u32 s57, s53, 0x20001
    s_add_u32 s68, s57, 0
    s_and_b32 s68, s68, 3
    s_lshl_b32 s80, s68, 12
    s_lshl_b32 s68, s68, 16
    s_add_u32 s84, s68, s60
    s_add_u32 s68, s57, 1
    s_and_b32 s68, s68, 3
    s_lshl_b32 s81, s68, 12
    s_lshl_b32 s68, s68, 16
    s_add_u32 s85, s68, s60
    s_add_u32 s68, s57, 2
    s_and_b32 s68, s68, 3
    s_lshl_b32 s82, s68, 12
    s_lshl_b32 s68, s68, 16
    s_add_u32 s86, s68, s60
    s_add_u32 s68, s57, 3
    s_and_b32 s68, s68, 3
    s_lshl_b32 s83, s68, 12
    s_lshl_b32 s68, s68, 16
    s_add_u32 s87, s68, s60
    s_andn2_b32 s68, 1, s53
    s_lshl_b32 s57, s68, 11
    s_add_u32 s80, s80, s57
    s_lshl_b32 s57, s68, 15
    s_add_u32 s84, s84, s57
    v_add_u32 v8, 30720, v6
    v_add_u32 v9, 30720, v7
    s_add_u32 m0, s88, 0
    s_add_u32 s66, s58, 0
    buffer_load_dwordx4 v6, s[20:23], s66 offen offset:0 lds
    buffer_load_dwordx4 v7, s[20:23], s66 offen offset:1024 lds
    s_mov_b32 m0, 147456
    s_add_u32 s66, s59, 0
    buffer_load_dwordx4 v1, s[28:31], s66 offen offset:0 lds
    buffer_load_dwordx4 v1, s[28:31], s66 offen offset:1024 lds
    buffer_load_dwordx4 v1, s[28:31], s66 offen offset:2048 lds
    buffer_load_dwordx4 v1, s[28:31], s66 offen offset:3072 lds
    s_add_u32 m0, s88, 2048
    s_add_u32 s66, s58, 128
    s_waitcnt vmcnt(45)
    buffer_load_dwordx4 v6, s[20:23], s66 offen offset:0 lds
    buffer_load_dwordx4 v7, s[20:23], s66 offen offset:1024 lds
    s_mov_b32 m0, 151552
    s_add_u32 s66, s59, 4096
    buffer_load_dwordx4 v1, s[28:31], s66 offen offset:0 lds
    buffer_load_dwordx4 v1, s[28:31], s66 offen offset:1024 lds
    buffer_load_dwordx4 v1, s[28:31], s66 offen offset:2048 lds
    buffer_load_dwordx4 v1, s[28:31], s66 offen offset:3072 lds
    s_add_u32 m0, s88, 8192
    s_add_u32 s66, s58, 512
    buffer_load_dwordx4 v6, s[20:23], s66 offen offset:0 lds
    buffer_load_dwordx4 v7, s[20:23], s66 offen offset:1024 lds
    s_mov_b32 m0, 155648
    s_add_u32 s66, s59, 16384
    buffer_load_dwordx4 v1, s[28:31], s66 offen offset:0 lds
    buffer_load_dwordx4 v1, s[28:31], s66 offen offset:1024 lds
    buffer_load_dwordx4 v1, s[28:31], s66 offen offset:2048 lds
    buffer_load_dwordx4 v1, s[28:31], s66 offen offset:3072 lds
    s_add_u32 m0, s88, 10240
    s_add_u32 s66, s58, 640
    buffer_load_dwordx4 v6, s[20:23], s66 offen offset:0 lds
    buffer_load_dwordx4 v7, s[20:23], s66 offen offset:1024 lds
    s_mov_b32 m0, 159744
    s_add_u32 s66, s59, 20480
    buffer_load_dwordx4 v1, s[28:31], s66 offen offset:0 lds
    buffer_load_dwordx4 v1, s[28:31], s66 offen offset:1024 lds
    buffer_load_dwordx4 v1, s[28:31], s66 offen offset:2048 lds
    buffer_load_dwordx4 v1, s[28:31], s66 offen offset:3072 lds
    s_waitcnt vmcnt(32)
    s_barrier
    s_add_u32 m0, s88, 16384
    s_add_u32 s66, s58, 1024
    buffer_load_dwordx4 v6, s[20:23], s66 offen offset:0 lds
    buffer_load_dwordx4 v7, s[20:23], s66 offen offset:1024 lds
    s_mov_b32 m0, 40960
    s_add_u32 s66, s59, 32768
    buffer_load_dwordx4 v1, s[28:31], s66 offen offset:0 lds
    buffer_load_dwordx4 v1, s[28:31], s66 offen offset:1024 lds
    buffer_load_dwordx4 v1, s[28:31], s66 offen offset:2048 lds
    buffer_load_dwordx4 v1, s[28:31], s66 offen offset:3072 lds
    s_add_u32 m0, s88, 18432
    s_add_u32 s66, s58, 1152
    buffer_load_dwordx4 v6, s[20:23], s66 offen offset:0 lds
    buffer_load_dwordx4 v7, s[20:23], s66 offen offset:1024 lds
    s_mov_b32 m0, 45056
    s_add_u32 s66, s59, 36864
    buffer_load_dwordx4 v1, s[28:31], s66 offen offset:0 lds
    buffer_load_dwordx4 v1, s[28:31], s66 offen offset:1024 lds
    buffer_load_dwordx4 v1, s[28:31], s66 offen offset:2048 lds
    buffer_load_dwordx4 v1, s[28:31], s66 offen offset:3072 lds
    s_add_u32 m0, s88, 24576
    s_add_u32 s66, s58, 1536
    buffer_load_dwordx4 v6, s[20:23], s66 offen offset:0 lds
    buffer_load_dwordx4 v7, s[20:23], s66 offen offset:1024 lds
    s_mov_b32 m0, 49152
    s_add_u32 s66, s59, 49152
    buffer_load_dwordx4 v1, s[28:31], s66 offen offset:0 lds
    buffer_load_dwordx4 v1, s[28:31], s66 offen offset:1024 lds
    buffer_load_dwordx4 v1, s[28:31], s66 offen offset:2048 lds
    buffer_load_dwordx4 v1, s[28:31], s66 offen offset:3072 lds
    s_add_u32 m0, s88, 26624
    s_add_u32 s66, s58, 1664
    buffer_load_dwordx4 v6, s[20:23], s66 offen offset:0 lds
    buffer_load_dwordx4 v7, s[20:23], s66 offen offset:1024 lds
    s_mov_b32 m0, 53248
    s_add_u32 s66, s59, 53248
    buffer_load_dwordx4 v1, s[28:31], s66 offen offset:0 lds
    buffer_load_dwordx4 v1, s[28:31], s66 offen offset:1024 lds
    buffer_load_dwordx4 v1, s[28:31], s66 offen offset:2048 lds
    buffer_load_dwordx4 v1, s[28:31], s66 offen offset:3072 lds
    s_waitcnt vmcnt(47)
    s_lshl_b32 s71, s56, 7
    s_add_u32 m0, s80, 65536
    s_add_u32 s66, s71, s84
    buffer_load_dwordx4 v6, s[20:23], s66 offen offset:0 lds
    buffer_load_dwordx4 v7, s[20:23], s66 offen offset:1024 lds
    s_add_u32 m0, s81, 65536
    s_add_u32 s66, s71, s85
    buffer_load_dwordx4 v6, s[20:23], s66 offen offset:0 lds
    buffer_load_dwordx4 v7, s[20:23], s66 offen offset:1024 lds
    buffer_load_dwordx4 v8, s[20:23], s66 offen offset:2048 lds
    buffer_load_dwordx4 v9, s[20:23], s66 offen offset:3072 lds
    s_add_u32 m0, s82, 65536
    s_add_u32 s66, s71, s86
    buffer_load_dwordx4 v6, s[20:23], s66 offen offset:0 lds
    buffer_load_dwordx4 v7, s[20:23], s66 offen offset:1024 lds
    buffer_load_dwordx4 v8, s[20:23], s66 offen offset:2048 lds
    buffer_load_dwordx4 v9, s[20:23], s66 offen offset:3072 lds
    s_add_u32 m0, s83, 65536
    s_add_u32 s66, s71, s87
    buffer_load_dwordx4 v6, s[20:23], s66 offen offset:0 lds
    buffer_load_dwordx4 v7, s[20:23], s66 offen offset:1024 lds
    buffer_load_dwordx4 v8, s[20:23], s66 offen offset:2048 lds
    buffer_load_dwordx4 v9, s[20:23], s66 offen offset:3072 lds
    s_add_u32 s56, s55, 1
    s_and_b32 s56, s56, 15
    s_waitcnt vmcnt(55)
    s_lshl_b32 s66, s56, 17
    s_add_u32 s66, s66, s61
    s_mov_b32 m0, 106496
    s_nop 0
    buffer_load_dwordx4 v10, s[24:27], s66 offen offset:0 lds
    buffer_load_dwordx4 v11, s[24:27], s66 offen offset:1024 lds
    buffer_load_dwordx4 v12, s[24:27], s66 offen offset:2048 lds
    buffer_load_dwordx4 v13, s[24:27], s66 offen offset:3072 lds
    s_mov_b32 m0, 110592
    s_add_u32 s66, s66, 65536
    buffer_load_dwordx4 v10, s[24:27], s66 offen offset:0 lds
    buffer_load_dwordx4 v11, s[24:27], s66 offen offset:1024 lds
    buffer_load_dwordx4 v12, s[24:27], s66 offen offset:2048 lds
    buffer_load_dwordx4 v13, s[24:27], s66 offen offset:3072 lds
    s_waitcnt vmcnt(22)
    s_barrier
    s_lshl_b32 s71, s56, 7
    s_add_u32 m0, s80, 90112
    s_add_u32 s66, s71, s84
    buffer_load_dwordx4 v6, s[20:23], s66 offen offset:0 lds
    buffer_load_dwordx4 v7, s[20:23], s66 offen offset:1024 lds
    s_add_u32 m0, s81, 90112
    s_add_u32 s66, s71, s85
    buffer_load_dwordx4 v6, s[20:23], s66 offen offset:0 lds
    buffer_load_dwordx4 v7, s[20:23], s66 offen offset:1024 lds
    buffer_load_dwordx4 v8, s[20:23], s66 offen offset:2048 lds
    buffer_load_dwordx4 v9, s[20:23], s66 offen offset:3072 lds
    s_add_u32 m0, s82, 90112
    s_add_u32 s66, s71, s86
    buffer_load_dwordx4 v6, s[20:23], s66 offen offset:0 lds
    buffer_load_dwordx4 v7, s[20:23], s66 offen offset:1024 lds
    buffer_load_dwordx4 v8, s[20:23], s66 offen offset:2048 lds
    buffer_load_dwordx4 v9, s[20:23], s66 offen offset:3072 lds
    s_add_u32 m0, s83, 90112
    s_add_u32 s66, s71, s87
    buffer_load_dwordx4 v6, s[20:23], s66 offen offset:0 lds
    buffer_load_dwordx4 v7, s[20:23], s66 offen offset:1024 lds
    buffer_load_dwordx4 v8, s[20:23], s66 offen offset:2048 lds
    buffer_load_dwordx4 v9, s[20:23], s66 offen offset:3072 lds
    s_mov_b32 s44, s18
    s_mov_b32 s45, s19
    s_mov_b32 s46, 16777216
    s_mov_b32 s47, 0x20000
    s_mov_b32 s32, s12
    s_mov_b32 s33, s13
    s_mov_b32 s34, 2097152
    s_mov_b32 s35, 0x20000
    s_mov_b32 s40, s16
    s_mov_b32 s41, s17
    s_mov_b32 s42, 256
    s_mov_b32 s43, 0x20000
    v_lshlrev_b32 v14, 1, v3
    v_xor_b32 v14, v4, v14
    v_lshl_add_u32 v24, v14, 4, v2
    v_add_u32 v25, 15360, v24
    v_add_u32 v26, 30720, v24
    v_add_u32 v27, 46080, v24
    v_mov_b32 v20, -1
    v_mov_b32 v21, -1
    v_mov_b32 v22, -1
    v_mov_b32 v23, -1
    s_add_u32 s56, s55, 2
    s_and_b32 s56, s56, 15
    s_lshl_b32 s66, s56, 17
    s_add_u32 s66, s66, s61
    s_mov_b32 m0, 131072
    s_nop 0
    buffer_load_dwordx4 v10, s[24:27], s66 offen offset:0 lds
    buffer_load_dwordx4 v11, s[24:27], s66 offen offset:1024 lds
    buffer_load_dwordx4 v12, s[24:27], s66 offen offset:2048 lds
    buffer_load_dwordx4 v13, s[24:27], s66 offen offset:3072 lds
    s_mov_b32 m0, 135168
    s_add_u32 s66, s66, 65536
    buffer_load_dwordx4 v10, s[24:27], s66 offen offset:0 lds
    buffer_load_dwordx4 v11, s[24:27], s66 offen offset:1024 lds
    buffer_load_dwordx4 v12, s[24:27], s66 offen offset:2048 lds
    buffer_load_dwordx4 v13, s[24:27], s66 offen offset:3072 lds
    s_lshl_b32 s71, s56, 7
    s_add_u32 m0, s80, 114688
    s_add_u32 s66, s71, s84
    buffer_load_dwordx4 v6, s[20:23], s66 offen offset:0 lds
    buffer_load_dwordx4 v7, s[20:23], s66 offen offset:1024 lds
    s_add_u32 m0, s81, 114688
    s_add_u32 s66, s71, s85
    buffer_load_dwordx4 v6, s[20:23], s66 offen offset:0 lds
    buffer_load_dwordx4 v7, s[20:23], s66 offen offset:1024 lds
    buffer_load_dwordx4 v8, s[20:23], s66 offen offset:2048 lds
    buffer_load_dwordx4 v9, s[20:23], s66 offen offset:3072 lds
    s_add_u32 m0, s82, 114688
    s_add_u32 s66, s71, s86
    buffer_load_dwordx4 v6, s[20:23], s66 offen offset:0 lds
    buffer_load_dwordx4 v7, s[20:23], s66 offen offset:1024 lds
    buffer_load_dwordx4 v8, s[20:23], s66 offen offset:2048 lds
    buffer_load_dwordx4 v9, s[20:23], s66 offen offset:3072 lds
    s_add_u32 m0, s83, 114688
    s_add_u32 s66, s71, s87
    buffer_load_dwordx4 v6, s[20:23], s66 offen offset:0 lds
    buffer_load_dwordx4 v7, s[20:23], s66 offen offset:1024 lds
    buffer_load_dwordx4 v8, s[20:23], s66 offen offset:2048 lds
    buffer_load_dwordx4 v9, s[20:23], s66 offen offset:3072 lds
    s_barrier
    s_add_u32 s56, s55, 3
    s_and_b32 s56, s56, 15
    s_lshl_b32 s66, s56, 17
    s_add_u32 s66, s66, s61
    s_mov_b32 m0, 155648
    s_nop 0
    buffer_load_dwordx4 v10, s[24:27], s66 offen offset:0 lds
    buffer_load_dwordx4 v11, s[24:27], s66 offen offset:1024 lds
    buffer_load_dwordx4 v12, s[24:27], s66 offen offset:2048 lds
    buffer_load_dwordx4 v13, s[24:27], s66 offen offset:3072 lds
    s_waitcnt vmcnt(59)
    s_mov_b32 m0, 159744
    s_add_u32 s66, s66, 65536
    buffer_load_dwordx4 v10, s[24:27], s66 offen offset:0 lds
    buffer_load_dwordx4 v11, s[24:27], s66 offen offset:1024 lds
    buffer_load_dwordx4 v12, s[24:27], s66 offen offset:2048 lds
    buffer_load_dwordx4 v13, s[24:27], s66 offen offset:3072 lds
    s_waitcnt vmcnt(59)
    s_lshl_b32 s71, s56, 7
    s_add_u32 m0, s80, 139264
    s_add_u32 s66, s71, s84
    buffer_load_dwordx4 v6, s[20:23], s66 offen offset:0 lds
    buffer_load_dwordx4 v7, s[20:23], s66 offen offset:1024 lds
    s_waitcnt vmcnt(54)
    s_barrier
    s_add_u32 m0, s81, 139264
    s_add_u32 s66, s71, s85
    buffer_load_dwordx4 v6, s[20:23], s66 offen offset:0 lds
    buffer_load_dwordx4 v7, s[20:23], s66 offen offset:1024 lds
    buffer_load_dwordx4 v8, s[20:23], s66 offen offset:2048 lds
    buffer_load_dwordx4 v9, s[20:23], s66 offen offset:3072 lds
    s_add_u32 m0, s82, 139264
    s_add_u32 s66, s71, s86
    buffer_load_dwordx4 v6, s[20:23], s66 offen offset:0 lds
    buffer_load_dwordx4 v7, s[20:23], s66 offen offset:1024 lds
    buffer_load_dwordx4 v8, s[20:23], s66 offen offset:2048 lds
    buffer_load_dwordx4 v9, s[20:23], s66 offen offset:3072 lds
    s_waitcnt vmcnt(59)
    s_add_u32 m0, s83, 139264
    s_add_u32 s66, s71, s87
    buffer_load_dwordx4 v6, s[20:23], s66 offen offset:0 lds
    buffer_load_dwordx4 v7, s[20:23], s66 offen offset:1024 lds
    buffer_load_dwordx4 v8, s[20:23], s66 offen offset:2048 lds
    buffer_load_dwordx4 v9, s[20:23], s66 offen offset:3072 lds
    s_waitcnt vmcnt(59)
    s_add_u32 s56, s55, 4
    s_and_b32 s56, s56, 15
    s_lshl_b32 s66, s56, 17
    s_add_u32 s66, s66, s61
    s_mov_b32 m0, 57344
    s_nop 0
    buffer_load_dwordx4 v10, s[24:27], s66 offen offset:0 lds
    buffer_load_dwordx4 v11, s[24:27], s66 offen offset:1024 lds
    buffer_load_dwordx4 v12, s[24:27], s66 offen offset:2048 lds
    buffer_load_dwordx4 v13, s[24:27], s66 offen offset:3072 lds
    s_waitcnt vmcnt(59)
    s_mov_b32 m0, 61440
    s_add_u32 s66, s66, 65536
    buffer_load_dwordx4 v10, s[24:27], s66 offen offset:0 lds
    buffer_load_dwordx4 v11, s[24:27], s66 offen offset:1024 lds
    buffer_load_dwordx4 v12, s[24:27], s66 offen offset:2048 lds
    buffer_load_dwordx4 v13, s[24:27], s66 offen offset:3072 lds
    s_waitcnt vmcnt(52)
    s_barrier
    s_lshl_b32 s71, s56, 7
    s_add_u32 m0, s80, 40960
    s_add_u32 s66, s71, s84
    buffer_load_dwordx4 v6, s[20:23], s66 offen offset:0 lds
    buffer_load_dwordx4 v7, s[20:23], s66 offen offset:1024 lds
    s_add_u32 m0, s81, 40960
    s_add_u32 s66, s71, s85
    buffer_load_dwordx4 v6, s[20:23], s66 offen offset:0 lds
    buffer_load_dwordx4 v7, s[20:23], s66 offen offset:1024 lds
    buffer_load_dwordx4 v8, s[20:23], s66 offen offset:2048 lds
    buffer_load_dwordx4 v9, s[20:23], s66 offen offset:3072 lds
    s_add_u32 m0, s82, 40960
    s_add_u32 s66, s71, s86
    buffer_load_dwordx4 v6, s[20:23], s66 offen offset:0 lds
    buffer_load_dwordx4 v7, s[20:23], s66 offen offset:1024 lds
    buffer_load_dwordx4 v8, s[20:23], s66 offen offset:2048 lds
    buffer_load_dwordx4 v9, s[20:23], s66 offen offset:3072 lds
    s_waitcnt vmcnt(59)
    s_add_u32 m0, s83, 40960
    s_add_u32 s66, s71, s87
    buffer_load_dwordx4 v6, s[20:23], s66 offen offset:0 lds
    buffer_load_dwordx4 v7, s[20:23], s66 offen offset:1024 lds
    buffer_load_dwordx4 v8, s[20:23], s66 offen offset:2048 lds
    buffer_load_dwordx4 v9, s[20:23], s66 offen offset:3072 lds
    s_waitcnt vmcnt(59)
    s_add_u32 s56, s55, 5
    s_and_b32 s56, s56, 15
    s_lshl_b32 s66, s56, 17
    s_add_u32 s66, s66, s61
    s_mov_b32 m0, 81920
    s_nop 0
    buffer_load_dwordx4 v10, s[24:27], s66 offen offset:0 lds
    buffer_load_dwordx4 v11, s[24:27], s66 offen offset:1024 lds
    buffer_load_dwordx4 v12, s[24:27], s66 offen offset:2048 lds
    buffer_load_dwordx4 v13, s[24:27], s66 offen offset:3072 lds
    s_waitcnt vmcnt(48)
    s_barrier
    s_mov_b32 m0, 86016
    s_add_u32 s66, s66, 65536
    buffer_load_dwordx4 v10, s[24:27], s66 offen offset:0 lds
    buffer_load_dwordx4 v11, s[24:27], s66 offen offset:1024 lds
    buffer_load_dwordx4 v12, s[24:27], s66 offen offset:2048 lds
    buffer_load_dwordx4 v13, s[24:27], s66 offen offset:3072 lds
    s_lshl_b32 s71, s56, 7
    s_add_u32 m0, s80, 65536
    s_add_u32 s66, s71, s84
    buffer_load_dwordx4 v6, s[20:23], s66 offen offset:0 lds
    buffer_load_dwordx4 v7, s[20:23], s66 offen offset:1024 lds
    s_add_u32 m0, s81, 65536
    s_add_u32 s66, s71, s85
    buffer_load_dwordx4 v6, s[20:23], s66 offen offset:0 lds
    buffer_load_dwordx4 v7, s[20:23], s66 offen offset:1024 lds
    buffer_load_dwordx4 v8, s[20:23], s66 offen offset:2048 lds
    buffer_load_dwordx4 v9, s[20:23], s66 offen offset:3072 lds
    s_add_u32 m0, s82, 65536
    s_add_u32 s66, s71, s86
    buffer_load_dwordx4 v6, s[20:23], s66 offen offset:0 lds
    buffer_load_dwordx4 v7, s[20:23], s66 offen offset:1024 lds
    buffer_load_dwordx4 v8, s[20:23], s66 offen offset:2048 lds
    buffer_load_dwordx4 v9, s[20:23], s66 offen offset:3072 lds
    s_waitcnt vmcnt(59)
    s_add_u32 m0, s83, 65536
    s_add_u32 s66, s71, s87
    buffer_load_dwordx4 v6, s[20:23], s66 offen offset:0 lds
    buffer_load_dwordx4 v7, s[20:23], s66 offen offset:1024 lds
    buffer_load_dwordx4 v8, s[20:23], s66 offen offset:2048 lds
    buffer_load_dwordx4 v9, s[20:23], s66 offen offset:3072 lds
    s_waitcnt vmcnt(44)
    s_barrier
    s_lshr_b32 s69, s53, 1
    s_lshl_b32 s69, s69, 2
    s_mov_b32 s57, 1
    s_atomic_add s57, s[16:17], s69
    s_add_u32 s56, s55, 6
    s_and_b32 s56, s56, 15
    s_lshl_b32 s66, s56, 17
    s_add_u32 s66, s66, s61
    s_mov_b32 m0, 106496
    s_nop 0
    buffer_load_dwordx4 v10, s[24:27], s66 offen offset:0 lds
    buffer_load_dwordx4 v11, s[24:27], s66 offen offset:1024 lds
    buffer_load_dwordx4 v12, s[24:27], s66 offen offset:2048 lds
    buffer_load_dwordx4 v13, s[24:27], s66 offen offset:3072 lds
    s_mov_b32 m0, 110592
    s_add_u32 s66, s66, 65536
    buffer_load_dwordx4 v10, s[24:27], s66 offen offset:0 lds
    buffer_load_dwordx4 v11, s[24:27], s66 offen offset:1024 lds
    buffer_load_dwordx4 v12, s[24:27], s66 offen offset:2048 lds
    buffer_load_dwordx4 v13, s[24:27], s66 offen offset:3072 lds
    s_lshl_b32 s71, s56, 7
    s_add_u32 m0, s80, 90112
    s_add_u32 s66, s71, s84
    buffer_load_dwordx4 v6, s[20:23], s66 offen offset:0 lds
    buffer_load_dwordx4 v7, s[20:23], s66 offen offset:1024 lds
    s_add_u32 m0, s81, 90112
    s_add_u32 s66, s71, s85
    buffer_load_dwordx4 v6, s[20:23], s66 offen offset:0 lds
    buffer_load_dwordx4 v7, s[20:23], s66 offen offset:1024 lds
    buffer_load_dwordx4 v8, s[20:23], s66 offen offset:2048 lds
    buffer_load_dwordx4 v9, s[20:23], s66 offen offset:3072 lds
    s_add_u32 m0, s82, 90112
    s_add_u32 s66, s71, s86
    buffer_load_dwordx4 v6, s[20:23], s66 offen offset:0 lds
    buffer_load_dwordx4 v7, s[20:23], s66 offen offset:1024 lds
    buffer_load_dwordx4 v8, s[20:23], s66 offen offset:2048 lds
    buffer_load_dwordx4 v9, s[20:23], s66 offen offset:3072 lds
    s_waitcnt vmcnt(40)
    s_barrier
    s_add_u32 m0, s83, 90112
    s_add_u32 s66, s71, s87
    buffer_load_dwordx4 v6, s[20:23], s66 offen offset:0 lds
    buffer_load_dwordx4 v7, s[20:23], s66 offen offset:1024 lds
    buffer_load_dwordx4 v8, s[20:23], s66 offen offset:2048 lds
    buffer_load_dwordx4 v9, s[20:23], s66 offen offset:3072 lds
    s_add_u32 s56, s55, 7
    s_and_b32 s56, s56, 15
    s_lshl_b32 s66, s56, 17
    s_add_u32 s66, s66, s61
    s_mov_b32 m0, 131072
    s_nop 0
    buffer_load_dwordx4 v10, s[24:27], s66 offen offset:0 lds
    buffer_load_dwordx4 v11, s[24:27], s66 offen offset:1024 lds
    buffer_load_dwordx4 v12, s[24:27], s66 offen offset:2048 lds
    buffer_load_dwordx4 v13, s[24:27], s66 offen offset:3072 lds
    s_mov_b32 m0, 135168
    s_add_u32 s66, s66, 65536
    buffer_load_dwordx4 v10, s[24:27], s66 offen offset:0 lds
    buffer_load_dwordx4 v11, s[24:27], s66 offen offset:1024 lds
    buffer_load_dwordx4 v12, s[24:27], s66 offen offset:2048 lds
    buffer_load_dwordx4 v13, s[24:27], s66 offen offset:3072 lds
    s_lshl_b32 s71, s56, 7
    s_add_u32 m0, s80, 114688
    s_add_u32 s66, s71, s84
    buffer_load_dwordx4 v6, s[20:23], s66 offen offset:0 lds
    buffer_load_dwordx4 v7, s[20:23], s66 offen offset:1024 lds
    s_add_u32 m0, s81, 114688
    s_add_u32 s66, s71, s85
    buffer_load_dwordx4 v6, s[20:23], s66 offen offset:0 lds
    buffer_load_dwordx4 v7, s[20:23], s66 offen offset:1024 lds
    buffer_load_dwordx4 v8, s[20:23], s66 offen offset:2048 lds
    buffer_load_dwordx4 v9, s[20:23], s66 offen offset:3072 lds
    s_waitcnt vmcnt(36)
    s_barrier
    s_add_u32 m0, s82, 114688
    s_add_u32 s66, s71, s86
    buffer_load_dwordx4 v6, s[20:23], s66 offen offset:0 lds
    buffer_load_dwordx4 v7, s[20:23], s66 offen offset:1024 lds
    buffer_load_dwordx4 v8, s[20:23], s66 offen offset:2048 lds
    buffer_load_dwordx4 v9, s[20:23], s66 offen offset:3072 lds
    s_add_u32 m0, s83, 114688
    s_add_u32 s66, s71, s87
    buffer_load_dwordx4 v6, s[20:23], s66 offen offset:0 lds
    buffer_load_dwordx4 v7, s[20:23], s66 offen offset:1024 lds
    buffer_load_dwordx4 v8, s[20:23], s66 offen offset:2048 lds
    buffer_load_dwordx4 v9, s[20:23], s66 offen offset:3072 lds
    s_add_u32 s56, s55, 8
    s_and_b32 s56, s56, 15
    s_lshl_b32 s66, s56, 17
    s_add_u32 s66, s66, s61
    s_mov_b32 m0, 155648
    s_nop 0
    buffer_load_dwordx4 v10, s[24:27], s66 offen offset:0 lds
    buffer_load_dwordx4 v11, s[24:27], s66 offen offset:1024 lds
    buffer_load_dwordx4 v12, s[24:27], s66 offen offset:2048 lds
    buffer_load_dwordx4 v13, s[24:27], s66 offen offset:3072 lds
    s_mov_b32 m0, 159744
    s_add_u32 s66, s66, 65536
    buffer_load_dwordx4 v10, s[24:27], s66 offen offset:0 lds
    buffer_load_dwordx4 v11, s[24:27], s66 offen offset:1024 lds
    buffer_load_dwordx4 v12, s[24:27], s66 offen offset:2048 lds
    buffer_load_dwordx4 v13, s[24:27], s66 offen offset:3072 lds
    s_lshl_b32 s71, s56, 7
    s_add_u32 m0, s80, 139264
    s_add_u32 s66, s71, s84
    buffer_load_dwordx4 v6, s[20:23], s66 offen offset:0 lds
    buffer_load_dwordx4 v7, s[20:23], s66 offen offset:1024 lds
    s_waitcnt vmcnt(32)
    s_barrier
    s_add_u32 m0, s81, 139264
    s_add_u32 s66, s71, s85
    buffer_load_dwordx4 v6, s[20:23], s66 offen offset:0 lds
    buffer_load_dwordx4 v7, s[20:23], s66 offen offset:1024 lds
    buffer_load_dwordx4 v8, s[20:23], s66 offen offset:2048 lds
    buffer_load_dwordx4 v9, s[20:23], s66 offen offset:3072 lds
    s_add_u32 m0, s82, 139264
    s_add_u32 s66, s71, s86
    buffer_load_dwordx4 v6, s[20:23], s66 offen offset:0 lds
    buffer_load_dwordx4 v7, s[20:23], s66 offen offset:1024 lds
    buffer_load_dwordx4 v8, s[20:23], s66 offen offset:2048 lds
    buffer_load_dwordx4 v9, s[20:23], s66 offen offset:3072 lds
    s_add_u32 m0, s83, 139264
    s_add_u32 s66, s71, s87
    buffer_load_dwordx4 v6, s[20:23], s66 offen offset:0 lds
    buffer_load_dwordx4 v7, s[20:23], s66 offen offset:1024 lds
    buffer_load_dwordx4 v8, s[20:23], s66 offen offset:2048 lds
    buffer_load_dwordx4 v9, s[20:23], s66 offen offset:3072 lds
    s_add_u32 s56, s55, 9
    s_and_b32 s56, s56, 15
    s_lshl_b32 s66, s56, 17
    s_add_u32 s66, s66, s61
    s_mov_b32 m0, 57344
    s_nop 0
    buffer_load_dwordx4 v10, s[24:27], s66 offen offset:0 lds
    buffer_load_dwordx4 v11, s[24:27], s66 offen offset:1024 lds
    buffer_load_dwordx4 v12, s[24:27], s66 offen offset:2048 lds
    buffer_load_dwordx4 v13, s[24:27], s66 offen offset:3072 lds
    s_mov_b32 m0, 61440
    s_add_u32 s66, s66, 65536
    buffer_load_dwordx4 v10, s[24:27], s66 offen offset:0 lds
    buffer_load_dwordx4 v11, s[24:27], s66 offen offset:1024 lds
    buffer_load_dwordx4 v12, s[24:27], s66 offen offset:2048 lds
    buffer_load_dwordx4 v13, s[24:27], s66 offen offset:3072 lds
    s_waitcnt vmcnt(30)
    s_barrier
    s_lshl_b32 s71, s56, 7
    s_add_u32 m0, s80, 40960
    s_add_u32 s66, s71, s84
    buffer_load_dwordx4 v6, s[20:23], s66 offen offset:0 lds
    buffer_load_dwordx4 v7, s[20:23], s66 offen offset:1024 lds
    s_add_u32 m0, s81, 40960
    s_add_u32 s66, s71, s85
    buffer_load_dwordx4 v6, s[20:23], s66 offen offset:0 lds
    buffer_load_dwordx4 v7, s[20:23], s66 offen offset:1024 lds
    buffer_load_dwordx4 v8, s[20:23], s66 offen offset:2048 lds
    buffer_load_dwordx4 v9, s[20:23], s66 offen offset:3072 lds
    s_add_u32 m0, s82, 40960
    s_add_u32 s66, s71, s86
    buffer_load_dwordx4 v6, s[20:23], s66 offen offset:0 lds
    buffer_load_dwordx4 v7, s[20:23], s66 offen offset:1024 lds
    buffer_load_dwordx4 v8, s[20:23], s66 offen offset:2048 lds
    buffer_load_dwordx4 v9, s[20:23], s66 offen offset:3072 lds
    s_add_u32 m0, s83, 40960
    s_add_u32 s66, s71, s87
    buffer_load_dwordx4 v6, s[20:23], s66 offen offset:0 lds
    buffer_load_dwordx4 v7, s[20:23], s66 offen offset:1024 lds
    buffer_load_dwordx4 v8, s[20:23], s66 offen offset:2048 lds
    buffer_load_dwordx4 v9, s[20:23], s66 offen offset:3072 lds
    s_add_u32 s56, s55, 10
    s_and_b32 s56, s56, 15
    s_lshl_b32 s66, s56, 17
    s_add_u32 s66, s66, s61
    s_mov_b32 m0, 81920
    s_nop 0
    buffer_load_dwordx4 v10, s[24:27], s66 offen offset:0 lds
    buffer_load_dwordx4 v11, s[24:27], s66 offen offset:1024 lds
    buffer_load_dwordx4 v12, s[24:27], s66 offen offset:2048 lds
    buffer_load_dwordx4 v13, s[24:27], s66 offen offset:3072 lds
    s_waitcnt vmcnt(26)
    s_barrier
    s_mov_b32 m0, 86016
    s_add_u32 s66, s66, 65536
    buffer_load_dwordx4 v10, s[24:27], s66 offen offset:0 lds
    buffer_load_dwordx4 v11, s[24:27], s66 offen offset:1024 lds
    buffer_load_dwordx4 v12, s[24:27], s66 offen offset:2048 lds
    buffer_load_dwordx4 v13, s[24:27], s66 offen offset:3072 lds
    s_lshl_b32 s71, s56, 7
    s_add_u32 m0, s80, 65536
    s_add_u32 s66, s71, s84
    buffer_load_dwordx4 v6, s[20:23], s66 offen offset:0 lds
    buffer_load_dwordx4 v7, s[20:23], s66 offen offset:1024 lds
    s_add_u32 m0, s81, 65536
    s_add_u32 s66, s71, s85
    buffer_load_dwordx4 v6, s[20:23], s66 offen offset:0 lds
    buffer_load_dwordx4 v7, s[20:23], s66 offen offset:1024 lds
    buffer_load_dwordx4 v8, s[20:23], s66 offen offset:2048 lds
    buffer_load_dwordx4 v9, s[20:23], s66 offen offset:3072 lds
    s_add_u32 m0, s82, 65536
    s_add_u32 s66, s71, s86
    buffer_load_dwordx4 v6, s[20:23], s66 offen offset:0 lds
    buffer_load_dwordx4 v7, s[20:23], s66 offen offset:1024 lds
    buffer_load_dwordx4 v8, s[20:23], s66 offen offset:2048 lds
    buffer_load_dwordx4 v9, s[20:23], s66 offen offset:3072 lds
    s_add_u32 m0, s83, 65536
    s_add_u32 s66, s71, s87
    buffer_load_dwordx4 v6, s[20:23], s66 offen offset:0 lds
    buffer_load_dwordx4 v7, s[20:23], s66 offen offset:1024 lds
    buffer_load_dwordx4 v8, s[20:23], s66 offen offset:2048 lds
    buffer_load_dwordx4 v9, s[20:23], s66 offen offset:3072 lds
    s_waitcnt vmcnt(22)
    s_barrier
    s_add_u32 s56, s55, 11
    s_and_b32 s56, s56, 15
    s_lshl_b32 s66, s56, 17
    s_add_u32 s66, s66, s61
    s_mov_b32 m0, 106496
    s_nop 0
    buffer_load_dwordx4 v10, s[24:27], s66 offen offset:0 lds
    buffer_load_dwordx4 v11, s[24:27], s66 offen offset:1024 lds
    buffer_load_dwordx4 v12, s[24:27], s66 offen offset:2048 lds
    buffer_load_dwordx4 v13, s[24:27], s66 offen offset:3072 lds
    s_mov_b32 m0, 110592
    s_add_u32 s66, s66, 65536
    buffer_load_dwordx4 v10, s[24:27], s66 offen offset:0 lds
    buffer_load_dwordx4 v11, s[24:27], s66 offen offset:1024 lds
    buffer_load_dwordx4 v12, s[24:27], s66 offen offset:2048 lds
    buffer_load_dwordx4 v13, s[24:27], s66 offen offset:3072 lds
    s_lshl_b32 s71, s56, 7
    s_add_u32 m0, s80, 90112
    s_add_u32 s66, s71, s84
    buffer_load_dwordx4 v6, s[20:23], s66 offen offset:0 lds
    buffer_load_dwordx4 v7, s[20:23], s66 offen offset:1024 lds
    s_add_u32 m0, s81, 90112
    s_add_u32 s66, s71, s85
    buffer_load_dwordx4 v6, s[20:23], s66 offen offset:0 lds
    buffer_load_dwordx4 v7, s[20:23], s66 offen offset:1024 lds
    buffer_load_dwordx4 v8, s[20:23], s66 offen offset:2048 lds
    buffer_load_dwordx4 v9, s[20:23], s66 offen offset:3072 lds
    s_add_u32 m0, s82, 90112
    s_add_u32 s66, s71, s86
    buffer_load_dwordx4 v6, s[20:23], s66 offen offset:0 lds
    buffer_load_dwordx4 v7, s[20:23], s66 offen offset:1024 lds
    buffer_load_dwordx4 v8, s[20:23], s66 offen offset:2048 lds
    buffer_load_dwordx4 v9, s[20:23], s66 offen offset:3072 lds
    s_add_u32 m0, s83, 90112
    s_add_u32 s66, s71, s87
    buffer_load_dwordx4 v6, s[20:23], s66 offen offset:0 lds
    buffer_load_dwordx4 v7, s[20:23], s66 offen offset:1024 lds
    buffer_load_dwordx4 v8, s[20:23], s66 offen offset:2048 lds
    buffer_load_dwordx4 v9, s[20:23], s66 offen offset:3072 lds
    s_waitcnt vmcnt(22)
    s_barrier
    s_add_u32 s56, s55, 12
    s_and_b32 s56, s56, 15
    s_lshl_b32 s66, s56, 17
    s_add_u32 s66, s66, s61
    s_mov_b32 m0, 131072
    s_nop 0
    buffer_load_dwordx4 v10, s[24:27], s66 offen offset:0 lds
    buffer_load_dwordx4 v11, s[24:27], s66 offen offset:1024 lds
    buffer_load_dwordx4 v12, s[24:27], s66 offen offset:2048 lds
    buffer_load_dwordx4 v13, s[24:27], s66 offen offset:3072 lds
    s_mov_b32 m0, 135168
    s_add_u32 s66, s66, 65536
    buffer_load_dwordx4 v10, s[24:27], s66 offen offset:0 lds
    buffer_load_dwordx4 v11, s[24:27], s66 offen offset:1024 lds
    buffer_load_dwordx4 v12, s[24:27], s66 offen offset:2048 lds
    buffer_load_dwordx4 v13, s[24:27], s66 offen offset:3072 lds
    s_lshl_b32 s71, s56, 7
    s_add_u32 m0, s80, 114688
    s_add_u32 s66, s71, s84
    buffer_load_dwordx4 v6, s[20:23], s66 offen offset:0 lds
    buffer_load_dwordx4 v7, s[20:23], s66 offen offset:1024 lds
    s_add_u32 m0, s81, 114688
    s_add_u32 s66, s71, s85
    buffer_load_dwordx4 v6, s[20:23], s66 offen offset:0 lds
    buffer_load_dwordx4 v7, s[20:23], s66 offen offset:1024 lds
    buffer_load_dwordx4 v8, s[20:23], s66 offen offset:2048 lds
    buffer_load_dwordx4 v9, s[20:23], s66 offen offset:3072 lds
    s_add_u32 m0, s82, 114688
    s_add_u32 s66, s71, s86
    buffer_load_dwordx4 v6, s[20:23], s66 offen offset:0 lds
    buffer_load_dwordx4 v7, s[20:23], s66 offen offset:1024 lds
    buffer_load_dwordx4 v8, s[20:23], s66 offen offset:2048 lds
    buffer_load_dwordx4 v9, s[20:23], s66 offen offset:3072 lds
    s_add_u32 m0, s83, 114688
    s_add_u32 s66, s71, s87
    buffer_load_dwordx4 v6, s[20:23], s66 offen offset:0 lds
    buffer_load_dwordx4 v7, s[20:23], s66 offen offset:1024 lds
    buffer_load_dwordx4 v8, s[20:23], s66 offen offset:2048 lds
    buffer_load_dwordx4 v9, s[20:23], s66 offen offset:3072 lds
    s_waitcnt vmcnt(22)
    s_barrier
    s_add_u32 s56, s55, 13
    s_and_b32 s56, s56, 15
    s_lshl_b32 s66, s56, 17
    s_add_u32 s66, s66, s61
    s_mov_b32 m0, 155648
    s_nop 0
    buffer_load_dwordx4 v10, s[24:27], s66 offen offset:0 lds
    buffer_load_dwordx4 v11, s[24:27], s66 offen offset:1024 lds
    buffer_load_dwordx4 v12, s[24:27], s66 offen offset:2048 lds
    buffer_load_dwordx4 v13, s[24:27], s66 offen offset:3072 lds
    s_mov_b32 m0, 159744
    s_add_u32 s66, s66, 65536
    buffer_load_dwordx4 v10, s[24:27], s66 offen offset:0 lds
    buffer_load_dwordx4 v11, s[24:27], s66 offen offset:1024 lds
    buffer_load_dwordx4 v12, s[24:27], s66 offen offset:2048 lds
    buffer_load_dwordx4 v13, s[24:27], s66 offen offset:3072 lds
    s_lshl_b32 s71, s56, 7
    s_add_u32 m0, s80, 139264
    s_add_u32 s66, s71, s84
    buffer_load_dwordx4 v6, s[20:23], s66 offen offset:0 lds
    buffer_load_dwordx4 v7, s[20:23], s66 offen offset:1024 lds
    s_add_u32 m0, s81, 139264
    s_add_u32 s66, s71, s85
    buffer_load_dwordx4 v6, s[20:23], s66 offen offset:0 lds
    buffer_load_dwordx4 v7, s[20:23], s66 offen offset:1024 lds
    buffer_load_dwordx4 v8, s[20:23], s66 offen offset:2048 lds
    buffer_load_dwordx4 v9, s[20:23], s66 offen offset:3072 lds
    s_add_u32 m0, s82, 139264
    s_add_u32 s66, s71, s86
    buffer_load_dwordx4 v6, s[20:23], s66 offen offset:0 lds
    buffer_load_dwordx4 v7, s[20:23], s66 offen offset:1024 lds
    buffer_load_dwordx4 v8, s[20:23], s66 offen offset:2048 lds
    buffer_load_dwordx4 v9, s[20:23], s66 offen offset:3072 lds
    s_add_u32 m0, s83, 139264
    s_add_u32 s66, s71, s87
    buffer_load_dwordx4 v6, s[20:23], s66 offen offset:0 lds
    buffer_load_dwordx4 v7, s[20:23], s66 offen offset:1024 lds
    buffer_load_dwordx4 v8, s[20:23], s66 offen offset:2048 lds
    buffer_load_dwordx4 v9, s[20:23], s66 offen offset:3072 lds
    s_waitcnt vmcnt(22)
    s_barrier
    s_add_u32 s56, s55, 14
    s_and_b32 s56, s56, 15
    s_lshl_b32 s66, s56, 17
    s_add_u32 s66, s66, s61
    s_mov_b32 m0, 57344
    s_nop 0
    buffer_load_dwordx4 v10, s[24:27], s66 offen offset:0 lds
    buffer_load_dwordx4 v11, s[24:27], s66 offen offset:1024 lds
    buffer_load_dwordx4 v12, s[24:27], s66 offen offset:2048 lds
    buffer_load_dwordx4 v13, s[24:27], s66 offen offset:3072 lds
    s_mov_b32 m0, 61440
    s_add_u32 s66, s66, 65536
    buffer_load_dwordx4 v10, s[24:27], s66 offen offset:0 lds
    buffer_load_dwordx4 v11, s[24:27], s66 offen offset:1024 lds
    buffer_load_dwordx4 v12, s[24:27], s66 offen offset:2048 lds
    buffer_load_dwordx4 v13, s[24:27], s66 offen offset:3072 lds
    s_lshl_b32 s71, s56, 7
    s_add_u32 m0, s80, 40960
    s_add_u32 s66, s71, s84
    buffer_load_dwordx4 v6, s[20:23], s66 offen offset:0 lds
    buffer_load_dwordx4 v7, s[20:23], s66 offen offset:1024 lds
    s_add_u32 m0, s81, 40960
    s_add_u32 s66, s71, s85
    buffer_load_dwordx4 v6, s[20:23], s66 offen offset:0 lds
    buffer_load_dwordx4 v7, s[20:23], s66 offen offset:1024 lds
    buffer_load_dwordx4 v8, s[20:23], s66 offen offset:2048 lds
    buffer_load_dwordx4 v9, s[20:23], s66 offen offset:3072 lds
    s_add_u32 m0, s82, 40960
    s_add_u32 s66, s71, s86
    buffer_load_dwordx4 v6, s[20:23], s66 offen offset:0 lds
    buffer_load_dwordx4 v7, s[20:23], s66 offen offset:1024 lds
    buffer_load_dwordx4 v8, s[20:23], s66 offen offset:2048 lds
    buffer_load_dwordx4 v9, s[20:23], s66 offen offset:3072 lds
    s_add_u32 m0, s83, 40960
    s_add_u32 s66, s71, s87
    buffer_load_dwordx4 v6, s[20:23], s66 offen offset:0 lds
    buffer_load_dwordx4 v7, s[20:23], s66 offen offset:1024 lds
    buffer_load_dwordx4 v8, s[20:23], s66 offen offset:2048 lds
    buffer_load_dwordx4 v9, s[20:23], s66 offen offset:3072 lds
    s_waitcnt vmcnt(22)
    s_barrier
    s_mov_b32 m0, 98304
    s_mov_b32 s66, 0
    buffer_load_dwordx4 v1, s[44:47], s66 offen offset:0 sc1 lds
    buffer_load_dwordx4 v1, s[44:47], s66 offen offset:1024 sc1 lds
    buffer_load_dwordx4 v1, s[44:47], s66 offen offset:2048 sc1 lds
    buffer_load_dwordx4 v1, s[44:47], s66 offen offset:3072 sc1 lds
    s_mov_b32 m0, 102400
    s_mov_b32 s66, 4096
    buffer_load_dwordx4 v1, s[44:47], s66 offen offset:0 sc1 lds
    buffer_load_dwordx4 v1, s[44:47], s66 offen offset:1024 sc1 lds
    buffer_load_dwordx4 v1, s[44:47], s66 offen offset:2048 sc1 lds
    buffer_load_dwordx4 v1, s[44:47], s66 offen offset:3072 sc1 lds
    s_add_u32 s56, s55, 15
    s_and_b32 s56, s56, 15
    s_lshl_b32 s66, s56, 17
    s_add_u32 s66, s66, s61
    s_mov_b32 m0, 81920
    s_nop 0
    buffer_load_dwordx4 v10, s[24:27], s66 offen offset:0 lds
    buffer_load_dwordx4 v11, s[24:27], s66 offen offset:1024 lds
    buffer_load_dwordx4 v12, s[24:27], s66 offen offset:2048 lds
    buffer_load_dwordx4 v13, s[24:27], s66 offen offset:3072 lds
    s_mov_b32 m0, 86016
    s_add_u32 s66, s66, 65536
    buffer_load_dwordx4 v10, s[24:27], s66 offen offset:0 lds
    buffer_load_dwordx4 v11, s[24:27], s66 offen offset:1024 lds
    buffer_load_dwordx4 v12, s[24:27], s66 offen offset:2048 lds
    buffer_load_dwordx4 v13, s[24:27], s66 offen offset:3072 lds
    s_lshl_b32 s71, s56, 7
    s_add_u32 m0, s80, 65536
    s_add_u32 s66, s71, s84
    buffer_load_dwordx4 v6, s[20:23], s66 offen offset:0 lds
    buffer_load_dwordx4 v7, s[20:23], s66 offen offset:1024 lds
    s_add_u32 m0, s81, 65536
    s_add_u32 s66, s71, s85
    buffer_load_dwordx4 v6, s[20:23], s66 offen offset:0 lds
    buffer_load_dwordx4 v7, s[20:23], s66 offen offset:1024 lds
    buffer_load_dwordx4 v8, s[20:23], s66 offen offset:2048 lds
    buffer_load_dwordx4 v9, s[20:23], s66 offen offset:3072 lds
    s_waitcnt vmcnt(22)
    s_barrier
    s_add_u32 m0, s82, 65536
    s_add_u32 s66, s71, s86
    buffer_load_dwordx4 v6, s[20:23], s66 offen offset:0 lds
    buffer_load_dwordx4 v7, s[20:23], s66 offen offset:1024 lds
    buffer_load_dwordx4 v8, s[20:23], s66 offen offset:2048 lds
    buffer_load_dwordx4 v9, s[20:23], s66 offen offset:3072 lds
    s_add_u32 m0, s83, 65536
    s_add_u32 s66, s71, s87
    buffer_load_dwordx4 v6, s[20:23], s66 offen offset:0 lds
    buffer_load_dwordx4 v7, s[20:23], s66 offen offset:1024 lds
    buffer_load_dwordx4 v8, s[20:23], s66 offen offset:2048 lds
    buffer_load_dwordx4 v9, s[20:23], s66 offen offset:3072 lds
    s_mov_b32 m0, 106496
    s_mov_b32 s66, 8192
    buffer_load_dwordx4 v1, s[44:47], s66 offen offset:0 sc1 lds
    buffer_load_dwordx4 v1, s[44:47], s66 offen offset:1024 sc1 lds
    buffer_load_dwordx4 v1, s[44:47], s66 offen offset:2048 sc1 lds
    buffer_load_dwordx4 v1, s[44:47], s66 offen offset:3072 sc1 lds
    s_mov_b32 m0, 110592
    s_mov_b32 s66, 12288
    buffer_load_dwordx4 v1, s[44:47], s66 offen offset:0 sc1 lds
    buffer_load_dwordx4 v1, s[44:47], s66 offen offset:1024 sc1 lds
    buffer_load_dwordx4 v1, s[44:47], s66 offen offset:2048 sc1 lds
    buffer_load_dwordx4 v1, s[44:47], s66 offen offset:3072 sc1 lds
    s_mov_b32 m0, 114688
    s_mov_b32 s66, 16384
    buffer_load_dwordx4 v1, s[44:47], s66 offen offset:0 sc1 lds
    buffer_load_dwordx4 v1, s[44:47], s66 offen offset:1024 sc1 lds
    buffer_load_dwordx4 v1, s[44:47], s66 offen offset:2048 sc1 lds
    buffer_load_dwordx4 v1, s[44:47], s66 offen offset:3072 sc1 lds
    s_mov_b32 m0, 118784
    s_mov_b32 s66, 20480
    buffer_load_dwordx4 v1, s[44:47], s66 offen offset:0 sc1 lds
    buffer_load_dwordx4 v1, s[44:47], s66 offen offset:1024 sc1 lds
    buffer_load_dwordx4 v1, s[44:47], s66 offen offset:2048 sc1 lds
    buffer_load_dwordx4 v1, s[44:47], s66 offen offset:3072 sc1 lds
    s_mov_b32 m0, 122880
    s_mov_b32 s66, 24576
    buffer_load_dwordx4 v1, s[44:47], s66 offen offset:0 sc1 lds
    buffer_load_dwordx4 v1, s[44:47], s66 offen offset:1024 sc1 lds
    buffer_load_dwordx4 v1, s[44:47], s66 offen offset:2048 sc1 lds
    buffer_load_dwordx4 v1, s[44:47], s66 offen offset:3072 sc1 lds
    s_mov_b32 m0, 126976
    s_mov_b32 s66, 28672
    buffer_load_dwordx4 v1, s[44:47], s66 offen offset:0 sc1 lds
    buffer_load_dwordx4 v1, s[44:47], s66 offen offset:1024 sc1 lds
    buffer_load_dwordx4 v1, s[44:47], s66 offen offset:2048 sc1 lds
    buffer_load_dwordx4 v1, s[44:47], s66 offen offset:3072 sc1 lds
    s_waitcnt vmcnt(24)
    s_barrier
    s_waitcnt vmcnt(0)
    s_barrier
    s_mov_b32 m0, 131072
    s_mov_b32 s66, 32768
    buffer_load_dwordx4 v1, s[44:47], s66 offen offset:0 sc1 lds
    buffer_load_dwordx4 v1, s[44:47], s66 offen offset:1024 sc1 lds
    buffer_load_dwordx4 v1, s[44:47], s66 offen offset:2048 sc1 lds
    buffer_load_dwordx4 v1, s[44:47], s66 offen offset:3072 sc1 lds
    s_mov_b32 m0, 135168
    s_mov_b32 s66, 36864
    buffer_load_dwordx4 v1, s[44:47], s66 offen offset:0 sc1 lds
    buffer_load_dwordx4 v1, s[44:47], s66 offen offset:1024 sc1 lds
    buffer_load_dwordx4 v1, s[44:47], s66 offen offset:2048 sc1 lds
    buffer_load_dwordx4 v1, s[44:47], s66 offen offset:3072 sc1 lds
    s_mov_b32 m0, 139264
    s_mov_b32 s66, 40960
    buffer_load_dwordx4 v1, s[44:47], s66 offen offset:0 sc1 lds
    buffer_load_dwordx4 v1, s[44:47], s66 offen offset:1024 sc1 lds
    buffer_load_dwordx4 v1, s[44:47], s66 offen offset:2048 sc1 lds
    buffer_load_dwordx4 v1, s[44:47], s66 offen offset:3072 sc1 lds
    s_mov_b32 m0, 143360
    s_mov_b32 s66, 45056
    buffer_load_dwordx4 v1, s[44:47], s66 offen offset:0 sc1 lds
    buffer_load_dwordx4 v1, s[44:47], s66 offen offset:1024 sc1 lds
    buffer_load_dwordx4 v1, s[44:47], s66 offen offset:2048 sc1 lds
    buffer_load_dwordx4 v1, s[44:47], s66 offen offset:3072 sc1 lds
    s_mov_b32 m0, 147456
    s_mov_b32 s66, 49152
    buffer_load_dwordx4 v1, s[44:47], s66 offen offset:0 sc1 lds
    buffer_load_dwordx4 v1, s[44:47], s66 offen offset:1024 sc1 lds
    buffer_load_dwordx4 v1, s[44:47], s66 offen offset:2048 sc1 lds
    buffer_load_dwordx4 v1, s[44:47], s66 offen offset:3072 sc1 lds
    s_mov_b32 m0, 151552
    s_mov_b32 s66, 53248
    buffer_load_dwordx4 v1, s[44:47], s66 offen offset:0 sc1 lds
    buffer_load_dwordx4 v1, s[44:47], s66 offen offset:1024 sc1 lds
    buffer_load_dwordx4 v1, s[44:47], s66 offen offset:2048 sc1 lds
    buffer_load_dwordx4 v1, s[44:47], s66 offen offset:3072 sc1 lds
    s_mov_b32 m0, 155648
    s_mov_b32 s66, 57344
    buffer_load_dwordx4 v1, s[44:47], s66 offen offset:0 sc1 lds
    buffer_load_dwordx4 v1, s[44:47], s66 offen offset:1024 sc1 lds
    buffer_load_dwordx4 v1, s[44:47], s66 offen offset:2048 sc1 lds
    buffer_load_dwordx4 v1, s[44:47], s66 offen offset:3072 sc1 lds
    s_mov_b32 m0, 159744
    s_mov_b32 s66, 61440
    buffer_load_dwordx4 v1, s[44:47], s66 offen offset:0 sc1 lds
    buffer_load_dwordx4 v1, s[44:47], s66 offen offset:1024 sc1 lds
    buffer_load_dwordx4 v1, s[44:47], s66 offen offset:2048 sc1 lds
    buffer_load_dwordx4 v1, s[44:47], s66 offen offset:3072 sc1 lds
    s_waitcnt lgkmcnt(0)
    s_lshl_b32 s57, s51, 11
    s_add_u32 s57, s57, 524288
    s_add_u32 s69, s57, s61
    v_and_b32 v14, 15, v0
    v_lshlrev_b32 v14, 7, v14
    v_mov_b32 v5, 1
    s_waitcnt vmcnt(31)
    s_mov_b32 m0, 0
    s_mov_b32 s66, 65536
    buffer_load_dwordx4 v1, s[44:47], s66 offen offset:0 sc1 lds
    buffer_load_dwordx4 v1, s[44:47], s66 offen offset:1024 sc1 lds
    buffer_load_dwordx4 v1, s[44:47], s66 offen offset:2048 sc1 lds
    buffer_load_dwordx4 v1, s[44:47], s66 offen offset:3072 sc1 lds
    s_mov_b32 m0, 4096
    s_mov_b32 s66, 69632
    buffer_load_dwordx4 v1, s[44:47], s66 offen offset:0 sc1 lds
    buffer_load_dwordx4 v1, s[44:47], s66 offen offset:1024 sc1 lds
    buffer_load_dwordx4 v1, s[44:47], s66 offen offset:2048 sc1 lds
    buffer_load_dwordx4 v1, s[44:47], s66 offen offset:3072 sc1 lds
    s_mov_b32 m0, 8192
    s_mov_b32 s66, 73728
    buffer_load_dwordx4 v1, s[44:47], s66 offen offset:0 sc1 lds
    buffer_load_dwordx4 v1, s[44:47], s66 offen offset:1024 sc1 lds
    buffer_load_dwordx4 v1, s[44:47], s66 offen offset:2048 sc1 lds
    buffer_load_dwordx4 v1, s[44:47], s66 offen offset:3072 sc1 lds
    s_mov_b32 m0, 12288
    s_mov_b32 s66, 77824
    buffer_load_dwordx4 v1, s[44:47], s66 offen offset:0 sc1 lds
    buffer_load_dwordx4 v1, s[44:47], s66 offen offset:1024 sc1 lds
    buffer_load_dwordx4 v1, s[44:47], s66 offen offset:2048 sc1 lds
    buffer_load_dwordx4 v1, s[44:47], s66 offen offset:3072 sc1 lds
    s_mov_b32 m0, 16384
    s_mov_b32 s66, 81920
    buffer_load_dwordx4 v1, s[44:47], s66 offen offset:0 sc1 lds
    buffer_load_dwordx4 v1, s[44:47], s66 offen offset:1024 sc1 lds
    buffer_load_dwordx4 v1, s[44:47], s66 offen offset:2048 sc1 lds
    buffer_load_dwordx4 v1, s[44:47], s66 offen offset:3072 sc1 lds
    s_mov_b32 m0, 20480
    s_mov_b32 s66, 86016
    buffer_load_dwordx4 v1, s[44:47], s66 offen offset:0 sc1 lds
    buffer_load_dwordx4 v1, s[44:47], s66 offen offset:1024 sc1 lds
    buffer_load_dwordx4 v1, s[44:47], s66 offen offset:2048 sc1 lds
    buffer_load_dwordx4 v1, s[44:47], s66 offen offset:3072 sc1 lds
    s_mov_b32 m0, 24576
    s_mov_b32 s66, 90112
    buffer_load_dwordx4 v1, s[44:47], s66 offen offset:0 sc1 lds
    buffer_load_dwordx4 v1, s[44:47], s66 offen offset:1024 sc1 lds
    buffer_load_dwordx4 v1, s[44:47], s66 offen offset:2048 sc1 lds
    buffer_load_dwordx4 v1, s[44:47], s66 offen offset:3072 sc1 lds
    s_mov_b32 m0, 28672
    s_mov_b32 s66, 94208
    buffer_load_dwordx4 v1, s[44:47], s66 offen offset:0 sc1 lds
    buffer_load_dwordx4 v1, s[44:47], s66 offen offset:1024 sc1 lds
    buffer_load_dwordx4 v1, s[44:47], s66 offen offset:2048 sc1 lds
    buffer_load_dwordx4 v1, s[44:47], s66 offen offset:3072 sc1 lds
    s_waitcnt vmcnt(32)
    s_barrier
    s_lshl_b32 s63, s52, 12
    s_add_u32 s63, s63, s60
    s_add_u32 s63, s63, 1048576
    buffer_store_dwordx4 v[20:23], v1, s[44:47], s63 offen offset:0 sc1
    buffer_store_dwordx4 v[20:23], v1, s[44:47], s63 offen offset:1024 sc1
    buffer_store_dwordx4 v[20:23], v1, s[44:47], s63 offen offset:2048 sc1
    buffer_store_dwordx4 v[20:23], v1, s[44:47], s63 offen offset:3072 sc1
    s_add_u32 s63, s63, 65536
    buffer_store_dwordx4 v[20:23], v1, s[44:47], s63 offen offset:0 sc1
    buffer_store_dwordx4 v[20:23], v1, s[44:47], s63 offen offset:1024 sc1
    buffer_store_dwordx4 v[20:23], v1, s[44:47], s63 offen offset:2048 sc1
    buffer_store_dwordx4 v[20:23], v1, s[44:47], s63 offen offset:3072 sc1
    s_add_u32 s63, s63, 65536
    buffer_store_dwordx4 v[20:23], v1, s[44:47], s63 offen offset:0 sc1
    buffer_store_dwordx4 v[20:23], v1, s[44:47], s63 offen offset:1024 sc1
    buffer_store_dwordx4 v[20:23], v1, s[44:47], s63 offen offset:2048 sc1
    buffer_store_dwordx4 v[20:23], v1, s[44:47], s63 offen offset:3072 sc1
    s_add_u32 s63, s63, 65536
    buffer_store_dwordx4 v[20:23], v1, s[44:47], s63 offen offset:0 sc1
    buffer_store_dwordx4 v[20:23], v1, s[44:47], s63 offen offset:1024 sc1
    buffer_store_dwordx4 v[20:23], v1, s[44:47], s63 offen offset:2048 sc1
    buffer_store_dwordx4 v[20:23], v1, s[44:47], s63 offen offset:3072 sc1
    s_waitcnt vmcnt(31)
    s_mov_b32 m0, 32768
    s_mov_b32 s66, 98304
    buffer_load_dwordx4 v1, s[44:47], s66 offen offset:0 sc1 lds
    buffer_load_dwordx4 v1, s[44:47], s66 offen offset:1024 sc1 lds
    buffer_load_dwordx4 v1, s[44:47], s66 offen offset:2048 sc1 lds
    buffer_load_dwordx4 v1, s[44:47], s66 offen offset:3072 sc1 lds
    s_mov_b32 m0, 36864
    s_mov_b32 s66, 102400
    buffer_load_dwordx4 v1, s[44:47], s66 offen offset:0 sc1 lds
    buffer_load_dwordx4 v1, s[44:47], s66 offen offset:1024 sc1 lds
    buffer_load_dwordx4 v1, s[44:47], s66 offen offset:2048 sc1 lds
    buffer_load_dwordx4 v1, s[44:47], s66 offen offset:3072 sc1 lds
    s_mov_b32 m0, 40960
    s_mov_b32 s66, 106496
    buffer_load_dwordx4 v1, s[44:47], s66 offen offset:0 sc1 lds
    buffer_load_dwordx4 v1, s[44:47], s66 offen offset:1024 sc1 lds
    buffer_load_dwordx4 v1, s[44:47], s66 offen offset:2048 sc1 lds
    buffer_load_dwordx4 v1, s[44:47], s66 offen offset:3072 sc1 lds
    s_mov_b32 m0, 45056
    s_mov_b32 s66, 110592
    buffer_load_dwordx4 v1, s[44:47], s66 offen offset:0 sc1 lds
    buffer_load_dwordx4 v1, s[44:47], s66 offen offset:1024 sc1 lds
    buffer_load_dwordx4 v1, s[44:47], s66 offen offset:2048 sc1 lds
    buffer_load_dwordx4 v1, s[44:47], s66 offen offset:3072 sc1 lds
    s_mov_b32 m0, 49152
    s_mov_b32 s66, 114688
    buffer_load_dwordx4 v1, s[44:47], s66 offen offset:0 sc1 lds
    buffer_load_dwordx4 v1, s[44:47], s66 offen offset:1024 sc1 lds
    buffer_load_dwordx4 v1, s[44:47], s66 offen offset:2048 sc1 lds
    buffer_load_dwordx4 v1, s[44:47], s66 offen offset:3072 sc1 lds
    s_mov_b32 m0, 53248
    s_mov_b32 s66, 118784
    buffer_load_dwordx4 v1, s[44:47], s66 offen offset:0 sc1 lds
    buffer_load_dwordx4 v1, s[44:47], s66 offen offset:1024 sc1 lds
    buffer_load_dwordx4 v1, s[44:47], s66 offen offset:2048 sc1 lds
    buffer_load_dwordx4 v1, s[44:47], s66 offen offset:3072 sc1 lds
    s_mov_b32 m0, 57344
    s_mov_b32 s66, 122880
    buffer_load_dwordx4 v1, s[44:47], s66 offen offset:0 sc1 lds
    buffer_load_dwordx4 v1, s[44:47], s66 offen offset:1024 sc1 lds
    buffer_load_dwordx4 v1, s[44:47], s66 offen offset:2048 sc1 lds
    buffer_load_dwordx4 v1, s[44:47], s66 offen offset:3072 sc1 lds
    s_mov_b32 m0, 61440
    s_mov_b32 s66, 126976
    buffer_load_dwordx4 v1, s[44:47], s66 offen offset:0 sc1 lds
    buffer_load_dwordx4 v1, s[44:47], s66 offen offset:1024 sc1 lds
    buffer_load_dwordx4 v1, s[44:47], s66 offen offset:2048 sc1 lds
    buffer_load_dwordx4 v1, s[44:47], s66 offen offset:3072 sc1 lds
    s_waitcnt vmcnt(48)
    s_barrier
    s_waitcnt vmcnt(32)
    s_mov_b64 exec, 1
    buffer_store_dword v5, v14, s[44:47], s69 offen sc1
    s_mov_b64 exec, -1
    s_waitcnt vmcnt(31)
    s_mov_b32 m0, 65536
    s_mov_b32 s66, 131072
    buffer_load_dwordx4 v1, s[44:47], s66 offen offset:0 sc1 lds
    buffer_load_dwordx4 v1, s[44:47], s66 offen offset:1024 sc1 lds
    buffer_load_dwordx4 v1, s[44:47], s66 offen offset:2048 sc1 lds
    buffer_load_dwordx4 v1, s[44:47], s66 offen offset:3072 sc1 lds
    s_mov_b32 m0, 69632
    s_mov_b32 s66, 135168
    buffer_load_dwordx4 v1, s[44:47], s66 offen offset:0 sc1 lds
    buffer_load_dwordx4 v1, s[44:47], s66 offen offset:1024 sc1 lds
    buffer_load_dwordx4 v1, s[44:47], s66 offen offset:2048 sc1 lds
    buffer_load_dwordx4 v1, s[44:47], s66 offen offset:3072 sc1 lds
    s_mov_b32 m0, 73728
    s_mov_b32 s66, 139264
    buffer_load_dwordx4 v1, s[44:47], s66 offen offset:0 sc1 lds
    buffer_load_dwordx4 v1, s[44:47], s66 offen offset:1024 sc1 lds
    buffer_load_dwordx4 v1, s[44:47], s66 offen offset:2048 sc1 lds
    buffer_load_dwordx4 v1, s[44:47], s66 offen offset:3072 sc1 lds
    s_mov_b32 m0, 77824
    s_mov_b32 s66, 143360
    buffer_load_dwordx4 v1, s[44:47], s66 offen offset:0 sc1 lds
    buffer_load_dwordx4 v1, s[44:47], s66 offen offset:1024 sc1 lds
    buffer_load_dwordx4 v1, s[44:47], s66 offen offset:2048 sc1 lds
    buffer_load_dwordx4 v1, s[44:47], s66 offen offset:3072 sc1 lds
    s_mov_b32 m0, 81920
    s_mov_b32 s66, 147456
    buffer_load_dwordx4 v1, s[44:47], s66 offen offset:0 sc1 lds
    buffer_load_dwordx4 v1, s[44:47], s66 offen offset:1024 sc1 lds
    buffer_load_dwordx4 v1, s[44:47], s66 offen offset:2048 sc1 lds
    buffer_load_dwordx4 v1, s[44:47], s66 offen offset:3072 sc1 lds
    s_mov_b32 m0, 86016
    s_mov_b32 s66, 151552
    buffer_load_dwordx4 v1, s[44:47], s66 offen offset:0 sc1 lds
    buffer_load_dwordx4 v1, s[44:47], s66 offen offset:1024 sc1 lds
    buffer_load_dwordx4 v1, s[44:47], s66 offen offset:2048 sc1 lds
    buffer_load_dwordx4 v1, s[44:47], s66 offen offset:3072 sc1 lds
    s_mov_b32 m0, 90112
    s_mov_b32 s66, 155648
    buffer_load_dwordx4 v1, s[44:47], s66 offen offset:0 sc1 lds
    buffer_load_dwordx4 v1, s[44:47], s66 offen offset:1024 sc1 lds
    buffer_load_dwordx4 v1, s[44:47], s66 offen offset:2048 sc1 lds
    buffer_load_dwordx4 v1, s[44:47], s66 offen offset:3072 sc1 lds
    s_mov_b32 m0, 94208
    s_mov_b32 s66, 159744
    buffer_load_dwordx4 v1, s[44:47], s66 offen offset:0 sc1 lds
    buffer_load_dwordx4 v1, s[44:47], s66 offen offset:1024 sc1 lds
    buffer_load_dwordx4 v1, s[44:47], s66 offen offset:2048 sc1 lds
    buffer_load_dwordx4 v1, s[44:47], s66 offen offset:3072 sc1 lds
    s_waitcnt vmcnt(31)
    s_mov_b32 m0, 98304
    s_mov_b32 s66, 163840
    buffer_load_dwordx4 v1, s[44:47], s66 offen offset:0 sc1 lds
    buffer_load_dwordx4 v1, s[44:47], s66 offen offset:1024 sc1 lds
    buffer_load_dwordx4 v1, s[44:47], s66 offen offset:2048 sc1 lds
    buffer_load_dwordx4 v1, s[44:47], s66 offen offset:3072 sc1 lds
    s_mov_b32 m0, 102400
    s_mov_b32 s66, 167936
    buffer_load_dwordx4 v1, s[44:47], s66 offen offset:0 sc1 lds
    buffer_load_dwordx4 v1, s[44:47], s66 offen offset:1024 sc1 lds
    buffer_load_dwordx4 v1, s[44:47], s66 offen offset:2048 sc1 lds
    buffer_load_dwordx4 v1, s[44:47], s66 offen offset:3072 sc1 lds
    s_mov_b32 m0, 106496
    s_mov_b32 s66, 172032
    buffer_load_dwordx4 v1, s[44:47], s66 offen offset:0 sc1 lds
    buffer_load_dwordx4 v1, s[44:47], s66 offen offset:1024 sc1 lds
    buffer_load_dwordx4 v1, s[44:47], s66 offen offset:2048 sc1 lds
    buffer_load_dwordx4 v1, s[44:47], s66 offen offset:3072 sc1 lds
    s_mov_b32 m0, 110592
    s_mov_b32 s66, 176128
    buffer_load_dwordx4 v1, s[44:47], s66 offen offset:0 sc1 lds
    buffer_load_dwordx4 v1, s[44:47], s66 offen offset:1024 sc1 lds
    buffer_load_dwordx4 v1, s[44:47], s66 offen offset:2048 sc1 lds
    buffer_load_dwordx4 v1, s[44:47], s66 offen offset:3072 sc1 lds
    s_mov_b32 m0, 114688
    s_mov_b32 s66, 180224
    buffer_load_dwordx4 v1, s[44:47], s66 offen offset:0 sc1 lds
    buffer_load_dwordx4 v1, s[44:47], s66 offen offset:1024 sc1 lds
    buffer_load_dwordx4 v1, s[44:47], s66 offen offset:2048 sc1 lds
    buffer_load_dwordx4 v1, s[44:47], s66 offen offset:3072 sc1 lds
    s_mov_b32 m0, 118784
    s_mov_b32 s66, 184320
    buffer_load_dwordx4 v1, s[44:47], s66 offen offset:0 sc1 lds
    buffer_load_dwordx4 v1, s[44:47], s66 offen offset:1024 sc1 lds
    buffer_load_dwordx4 v1, s[44:47], s66 offen offset:2048 sc1 lds
    buffer_load_dwordx4 v1, s[44:47], s66 offen offset:3072 sc1 lds
    s_mov_b32 m0, 122880
    s_mov_b32 s66, 188416
    buffer_load_dwordx4 v1, s[44:47], s66 offen offset:0 sc1 lds
    buffer_load_dwordx4 v1, s[44:47], s66 offen offset:1024 sc1 lds
    buffer_load_dwordx4 v1, s[44:47], s66 offen offset:2048 sc1 lds
    buffer_load_dwordx4 v1, s[44:47], s66 offen offset:3072 sc1 lds
    s_mov_b32 m0, 126976
    s_mov_b32 s66, 192512
    buffer_load_dwordx4 v1, s[44:47], s66 offen offset:0 sc1 lds
    buffer_load_dwordx4 v1, s[44:47], s66 offen offset:1024 sc1 lds
    buffer_load_dwordx4 v1, s[44:47], s66 offen offset:2048 sc1 lds
    buffer_load_dwordx4 v1, s[44:47], s66 offen offset:3072 sc1 lds
    s_barrier
    s_waitcnt vmcnt(31)
    s_mov_b32 m0, 131072
    s_mov_b32 s66, 196608
    buffer_load_dwordx4 v1, s[44:47], s66 offen offset:0 sc1 lds
    buffer_load_dwordx4 v1, s[44:47], s66 offen offset:1024 sc1 lds
    buffer_load_dwordx4 v1, s[44:47], s66 offen offset:2048 sc1 lds
    buffer_load_dwordx4 v1, s[44:47], s66 offen offset:3072 sc1 lds
    s_mov_b32 m0, 135168
    s_mov_b32 s66, 200704
    buffer_load_dwordx4 v1, s[44:47], s66 offen offset:0 sc1 lds
    buffer_load_dwordx4 v1, s[44:47], s66 offen offset:1024 sc1 lds
    buffer_load_dwordx4 v1, s[44:47], s66 offen offset:2048 sc1 lds
    buffer_load_dwordx4 v1, s[44:47], s66 offen offset:3072 sc1 lds
    s_mov_b32 m0, 139264
    s_mov_b32 s66, 204800
    buffer_load_dwordx4 v1, s[44:47], s66 offen offset:0 sc1 lds
    buffer_load_dwordx4 v1, s[44:47], s66 offen offset:1024 sc1 lds
    buffer_load_dwordx4 v1, s[44:47], s66 offen offset:2048 sc1 lds
    buffer_load_dwordx4 v1, s[44:47], s66 offen offset:3072 sc1 lds
    s_mov_b32 m0, 143360
    s_mov_b32 s66, 208896
    buffer_load_dwordx4 v1, s[44:47], s66 offen offset:0 sc1 lds
    buffer_load_dwordx4 v1, s[44:47], s66 offen offset:1024 sc1 lds
    buffer_load_dwordx4 v1, s[44:47], s66 offen offset:2048 sc1 lds
    buffer_load_dwordx4 v1, s[44:47], s66 offen offset:3072 sc1 lds
    s_mov_b32 m0, 147456
    s_mov_b32 s66, 212992
    buffer_load_dwordx4 v1, s[44:47], s66 offen offset:0 sc1 lds
    buffer_load_dwordx4 v1, s[44:47], s66 offen offset:1024 sc1 lds
    buffer_load_dwordx4 v1, s[44:47], s66 offen offset:2048 sc1 lds
    buffer_load_dwordx4 v1, s[44:47], s66 offen offset:3072 sc1 lds
    s_mov_b32 m0, 151552
    s_mov_b32 s66, 217088
    buffer_load_dwordx4 v1, s[44:47], s66 offen offset:0 sc1 lds
    buffer_load_dwordx4 v1, s[44:47], s66 offen offset:1024 sc1 lds
    buffer_load_dwordx4 v1, s[44:47], s66 offen offset:2048 sc1 lds
    buffer_load_dwordx4 v1, s[44:47], s66 offen offset:3072 sc1 lds
    s_mov_b32 m0, 155648
    s_mov_b32 s66, 221184
    buffer_load_dwordx4 v1, s[44:47], s66 offen offset:0 sc1 lds
    buffer_load_dwordx4 v1, s[44:47], s66 offen offset:1024 sc1 lds
    buffer_load_dwordx4 v1, s[44:47], s66 offen offset:2048 sc1 lds
    buffer_load_dwordx4 v1, s[44:47], s66 offen offset:3072 sc1 lds
    s_mov_b32 m0, 159744
    s_mov_b32 s66, 225280
    buffer_load_dwordx4 v1, s[44:47], s66 offen offset:0 sc1 lds
    buffer_load_dwordx4 v1, s[44:47], s66 offen offset:1024 sc1 lds
    buffer_load_dwordx4 v1, s[44:47], s66 offen offset:2048 sc1 lds
    buffer_load_dwordx4 v1, s[44:47], s66 offen offset:3072 sc1 lds
    s_waitcnt vmcnt(31)
    s_mov_b32 m0, 0
    s_mov_b32 s66, 229376
    buffer_load_dwordx4 v1, s[44:47], s66 offen offset:0 sc1 lds
    buffer_load_dwordx4 v1, s[44:47], s66 offen offset:1024 sc1 lds
    buffer_load_dwordx4 v1, s[44:47], s66 offen offset:2048 sc1 lds
    buffer_load_dwordx4 v1, s[44:47], s66 offen offset:3072 sc1 lds
    s_mov_b32 m0, 4096
    s_mov_b32 s66, 233472
    buffer_load_dwordx4 v1, s[44:47], s66 offen offset:0 sc1 lds
    buffer_load_dwordx4 v1, s[44:47], s66 offen offset:1024 sc1 lds
    buffer_load_dwordx4 v1, s[44:47], s66 offen offset:2048 sc1 lds
    buffer_load_dwordx4 v1, s[44:47], s66 offen offset:3072 sc1 lds
    s_mov_b32 m0, 8192
    s_mov_b32 s66, 237568
    buffer_load_dwordx4 v1, s[44:47], s66 offen offset:0 sc1 lds
    buffer_load_dwordx4 v1, s[44:47], s66 offen offset:1024 sc1 lds
    buffer_load_dwordx4 v1, s[44:47], s66 offen offset:2048 sc1 lds
    buffer_load_dwordx4 v1, s[44:47], s66 offen offset:3072 sc1 lds
    s_mov_b32 m0, 12288
    s_mov_b32 s66, 241664
    buffer_load_dwordx4 v1, s[44:47], s66 offen offset:0 sc1 lds
    buffer_load_dwordx4 v1, s[44:47], s66 offen offset:1024 sc1 lds
    buffer_load_dwordx4 v1, s[44:47], s66 offen offset:2048 sc1 lds
    buffer_load_dwordx4 v1, s[44:47], s66 offen offset:3072 sc1 lds
    s_mov_b32 m0, 16384
    s_mov_b32 s66, 245760
    buffer_load_dwordx4 v1, s[44:47], s66 offen offset:0 sc1 lds
    buffer_load_dwordx4 v1, s[44:47], s66 offen offset:1024 sc1 lds
    buffer_load_dwordx4 v1, s[44:47], s66 offen offset:2048 sc1 lds
    buffer_load_dwordx4 v1, s[44:47], s66 offen offset:3072 sc1 lds
    s_mov_b32 m0, 20480
    s_mov_b32 s66, 249856
    buffer_load_dwordx4 v1, s[44:47], s66 offen offset:0 sc1 lds
    buffer_load_dwordx4 v1, s[44:47], s66 offen offset:1024 sc1 lds
    buffer_load_dwordx4 v1, s[44:47], s66 offen offset:2048 sc1 lds
    buffer_load_dwordx4 v1, s[44:47], s66 offen offset:3072 sc1 lds
    s_mov_b32 m0, 24576
    s_mov_b32 s66, 253952
    buffer_load_dwordx4 v1, s[44:47], s66 offen offset:0 sc1 lds
    buffer_load_dwordx4 v1, s[44:47], s66 offen offset:1024 sc1 lds
    buffer_load_dwordx4 v1, s[44:47], s66 offen offset:2048 sc1 lds
    buffer_load_dwordx4 v1, s[44:47], s66 offen offset:3072 sc1 lds
    s_mov_b32 m0, 28672
    s_mov_b32 s66, 258048
    buffer_load_dwordx4 v1, s[44:47], s66 offen offset:0 sc1 lds
    buffer_load_dwordx4 v1, s[44:47], s66 offen offset:1024 sc1 lds
    buffer_load_dwordx4 v1, s[44:47], s66 offen offset:2048 sc1 lds
    buffer_load_dwordx4 v1, s[44:47], s66 offen offset:3072 sc1 lds
    s_barrier
    s_waitcnt vmcnt(31)
    s_xor_b32 s68, s52, 0
    s_lshl_b32 s68, s68, 17
    s_add_u32 s68, s68, s61
    s_mov_b32 m0, 32768
    s_nop 0
    buffer_load_dwordx4 v24, s[32:35], s68 offen offset:0 lds
    buffer_load_dwordx4 v25, s[32:35], s68 offen offset:1024 lds
    buffer_load_dwordx4 v26, s[32:35], s68 offen offset:2048 lds
    buffer_load_dwordx4 v27, s[32:35], s68 offen offset:3072 lds
    s_mov_b32 m0, 36864
    s_add_u32 s68, s68, 65536
    buffer_load_dwordx4 v24, s[32:35], s68 offen offset:0 lds
    buffer_load_dwordx4 v25, s[32:35], s68 offen offset:1024 lds
    buffer_load_dwordx4 v26, s[32:35], s68 offen offset:2048 lds
    buffer_load_dwordx4 v27, s[32:35], s68 offen offset:3072 lds
    s_xor_b32 s68, s52, 1
    s_lshl_b32 s68, s68, 17
    s_add_u32 s68, s68, s61
    s_mov_b32 m0, 40960
    s_nop 0
    buffer_load_dwordx4 v24, s[32:35], s68 offen offset:0 lds
    buffer_load_dwordx4 v25, s[32:35], s68 offen offset:1024 lds
    buffer_load_dwordx4 v26, s[32:35], s68 offen offset:2048 lds
    buffer_load_dwordx4 v27, s[32:35], s68 offen offset:3072 lds
    s_mov_b32 m0, 45056
    s_add_u32 s68, s68, 65536
    buffer_load_dwordx4 v24, s[32:35], s68 offen offset:0 lds
    buffer_load_dwordx4 v25, s[32:35], s68 offen offset:1024 lds
    buffer_load_dwordx4 v26, s[32:35], s68 offen offset:2048 lds
    buffer_load_dwordx4 v27, s[32:35], s68 offen offset:3072 lds
    s_xor_b32 s68, s52, 2
    s_lshl_b32 s68, s68, 17
    s_add_u32 s68, s68, s61
    s_mov_b32 m0, 49152
    s_nop 0
    buffer_load_dwordx4 v24, s[32:35], s68 offen offset:0 lds
    buffer_load_dwordx4 v25, s[32:35], s68 offen offset:1024 lds
    buffer_load_dwordx4 v26, s[32:35], s68 offen offset:2048 lds
    buffer_load_dwordx4 v27, s[32:35], s68 offen offset:3072 lds
    s_mov_b32 m0, 53248
    s_add_u32 s68, s68, 65536
    buffer_load_dwordx4 v24, s[32:35], s68 offen offset:0 lds
    buffer_load_dwordx4 v25, s[32:35], s68 offen offset:1024 lds
    buffer_load_dwordx4 v26, s[32:35], s68 offen offset:2048 lds
    buffer_load_dwordx4 v27, s[32:35], s68 offen offset:3072 lds
    s_xor_b32 s68, s52, 3
    s_lshl_b32 s68, s68, 17
    s_add_u32 s68, s68, s61
    s_mov_b32 m0, 57344
    s_nop 0
    buffer_load_dwordx4 v24, s[32:35], s68 offen offset:0 lds
    buffer_load_dwordx4 v25, s[32:35], s68 offen offset:1024 lds
    buffer_load_dwordx4 v26, s[32:35], s68 offen offset:2048 lds
    buffer_load_dwordx4 v27, s[32:35], s68 offen offset:3072 lds
    s_mov_b32 m0, 61440
    s_add_u32 s68, s68, 65536
    buffer_load_dwordx4 v24, s[32:35], s68 offen offset:0 lds
    buffer_load_dwordx4 v25, s[32:35], s68 offen offset:1024 lds
    buffer_load_dwordx4 v26, s[32:35], s68 offen offset:2048 lds
    buffer_load_dwordx4 v27, s[32:35], s68 offen offset:3072 lds
    s_waitcnt vmcnt(32)
    s_barrier
    s_waitcnt vmcnt(31)
    s_xor_b32 s68, s52, 4
    s_lshl_b32 s68, s68, 17
    s_add_u32 s68, s68, s61
    s_mov_b32 m0, 65536
    s_nop 0
    buffer_load_dwordx4 v24, s[32:35], s68 offen offset:0 lds
    buffer_load_dwordx4 v25, s[32:35], s68 offen offset:1024 lds
    buffer_load_dwordx4 v26, s[32:35], s68 offen offset:2048 lds
    buffer_load_dwordx4 v27, s[32:35], s68 offen offset:3072 lds
    s_mov_b32 m0, 69632
    s_add_u32 s68, s68, 65536
    buffer_load_dwordx4 v24, s[32:35], s68 offen offset:0 lds
    buffer_load_dwordx4 v25, s[32:35], s68 offen offset:1024 lds
    buffer_load_dwordx4 v26, s[32:35], s68 offen offset:2048 lds
    buffer_load_dwordx4 v27, s[32:35], s68 offen offset:3072 lds
    s_xor_b32 s68, s52, 5
    s_lshl_b32 s68, s68, 17
    s_add_u32 s68, s68, s61
    s_mov_b32 m0, 73728
    s_nop 0
    buffer_load_dwordx4 v24, s[32:35], s68 offen offset:0 lds
    buffer_load_dwordx4 v25, s[32:35], s68 offen offset:1024 lds
    buffer_load_dwordx4 v26, s[32:35], s68 offen offset:2048 lds
    buffer_load_dwordx4 v27, s[32:35], s68 offen offset:3072 lds
    s_mov_b32 m0, 77824
    s_add_u32 s68, s68, 65536
    buffer_load_dwordx4 v24, s[32:35], s68 offen offset:0 lds
    buffer_load_dwordx4 v25, s[32:35], s68 offen offset:1024 lds
    buffer_load_dwordx4 v26, s[32:35], s68 offen offset:2048 lds
    buffer_load_dwordx4 v27, s[32:35], s68 offen offset:3072 lds
    s_xor_b32 s68, s52, 6
    s_lshl_b32 s68, s68, 17
    s_add_u32 s68, s68, s61
    s_mov_b32 m0, 81920
    s_nop 0
    buffer_load_dwordx4 v24, s[32:35], s68 offen offset:0 lds
    buffer_load_dwordx4 v25, s[32:35], s68 offen offset:1024 lds
    buffer_load_dwordx4 v26, s[32:35], s68 offen offset:2048 lds
    buffer_load_dwordx4 v27, s[32:35], s68 offen offset:3072 lds
    s_mov_b32 m0, 86016
    s_add_u32 s68, s68, 65536
    buffer_load_dwordx4 v24, s[32:35], s68 offen offset:0 lds
    buffer_load_dwordx4 v25, s[32:35], s68 offen offset:1024 lds
    buffer_load_dwordx4 v26, s[32:35], s68 offen offset:2048 lds
    buffer_load_dwordx4 v27, s[32:35], s68 offen offset:3072 lds
    s_xor_b32 s68, s52, 7
    s_lshl_b32 s68, s68, 17
    s_add_u32 s68, s68, s61
    s_mov_b32 m0, 90112
    s_nop 0
    buffer_load_dwordx4 v24, s[32:35], s68 offen offset:0 lds
    buffer_load_dwordx4 v25, s[32:35], s68 offen offset:1024 lds
    buffer_load_dwordx4 v26, s[32:35], s68 offen offset:2048 lds
    buffer_load_dwordx4 v27, s[32:35], s68 offen offset:3072 lds
    s_mov_b32 m0, 94208
    s_add_u32 s68, s68, 65536
    buffer_load_dwordx4 v24, s[32:35], s68 offen offset:0 lds
    buffer_load_dwordx4 v25, s[32:35], s68 offen offset:1024 lds
    buffer_load_dwordx4 v26, s[32:35], s68 offen offset:2048 lds
    buffer_load_dwordx4 v27, s[32:35], s68 offen offset:3072 lds
    s_waitcnt vmcnt(32)
    s_barrier
    s_waitcnt vmcnt(31)
    s_xor_b32 s68, s52, 8
    s_lshl_b32 s68, s68, 17
    s_add_u32 s68, s68, s61
    s_mov_b32 m0, 98304
    s_nop 0
    buffer_load_dwordx4 v24, s[32:35], s68 offen offset:0 lds
    buffer_load_dwordx4 v25, s[32:35], s68 offen offset:1024 lds
    buffer_load_dwordx4 v26, s[32:35], s68 offen offset:2048 lds
    buffer_load_dwordx4 v27, s[32:35], s68 offen offset:3072 lds
    s_mov_b32 m0, 102400
    s_add_u32 s68, s68, 65536
    buffer_load_dwordx4 v24, s[32:35], s68 offen offset:0 lds
    buffer_load_dwordx4 v25, s[32:35], s68 offen offset:1024 lds
    buffer_load_dwordx4 v26, s[32:35], s68 offen offset:2048 lds
    buffer_load_dwordx4 v27, s[32:35], s68 offen offset:3072 lds
    s_xor_b32 s68, s52, 9
    s_lshl_b32 s68, s68, 17
    s_add_u32 s68, s68, s61
    s_mov_b32 m0, 106496
    s_nop 0
    buffer_load_dwordx4 v24, s[32:35], s68 offen offset:0 lds
    buffer_load_dwordx4 v25, s[32:35], s68 offen offset:1024 lds
    buffer_load_dwordx4 v26, s[32:35], s68 offen offset:2048 lds
    buffer_load_dwordx4 v27, s[32:35], s68 offen offset:3072 lds
    s_mov_b32 m0, 110592
    s_add_u32 s68, s68, 65536
    buffer_load_dwordx4 v24, s[32:35], s68 offen offset:0 lds
    buffer_load_dwordx4 v25, s[32:35], s68 offen offset:1024 lds
    buffer_load_dwordx4 v26, s[32:35], s68 offen offset:2048 lds
    buffer_load_dwordx4 v27, s[32:35], s68 offen offset:3072 lds
    s_xor_b32 s68, s52, 10
    s_lshl_b32 s68, s68, 17
    s_add_u32 s68, s68, s61
    s_mov_b32 m0, 114688
    s_nop 0
    buffer_load_dwordx4 v24, s[32:35], s68 offen offset:0 lds
    buffer_load_dwordx4 v25, s[32:35], s68 offen offset:1024 lds
    buffer_load_dwordx4 v26, s[32:35], s68 offen offset:2048 lds
    buffer_load_dwordx4 v27, s[32:35], s68 offen offset:3072 lds
    s_mov_b32 m0, 118784
    s_add_u32 s68, s68, 65536
    buffer_load_dwordx4 v24, s[32:35], s68 offen offset:0 lds
    buffer_load_dwordx4 v25, s[32:35], s68 offen offset:1024 lds
    buffer_load_dwordx4 v26, s[32:35], s68 offen offset:2048 lds
    buffer_load_dwordx4 v27, s[32:35], s68 offen offset:3072 lds
    s_xor_b32 s68, s52, 11
    s_lshl_b32 s68, s68, 17
    s_add_u32 s68, s68, s61
    s_mov_b32 m0, 122880
    s_nop 0
    buffer_load_dwordx4 v24, s[32:35], s68 offen offset:0 lds
    buffer_load_dwordx4 v25, s[32:35], s68 offen offset:1024 lds
    buffer_load_dwordx4 v26, s[32:35], s68 offen offset:2048 lds
    buffer_load_dwordx4 v27, s[32:35], s68 offen offset:3072 lds
    s_mov_b32 m0, 126976
    s_add_u32 s68, s68, 65536
    buffer_load_dwordx4 v24, s[32:35], s68 offen offset:0 lds
    buffer_load_dwordx4 v25, s[32:35], s68 offen offset:1024 lds
    buffer_load_dwordx4 v26, s[32:35], s68 offen offset:2048 lds
    buffer_load_dwordx4 v27, s[32:35], s68 offen offset:3072 lds
    v_lshlrev_b32 v16, 11, v0
    s_xor_b32 s68, s52, 12
    s_lshl_b32 s68, s68, 17
    s_add_u32 s68, s68, s61
    buffer_load_dword v17, v16, s[32:35], s68 offen
    s_xor_b32 s68, s52, 13
    s_lshl_b32 s68, s68, 17
    s_add_u32 s68, s68, s61
    buffer_load_dword v18, v16, s[32:35], s68 offen
    s_xor_b32 s68, s52, 14
    s_lshl_b32 s68, s68, 17
    s_add_u32 s68, s68, s61
    buffer_load_dword v19, v16, s[32:35], s68 offen
    s_xor_b32 s68, s52, 15
    s_lshl_b32 s68, s68, 17
    s_add_u32 s68, s68, s61
    buffer_load_dword v20, v16, s[32:35], s68 offen
L_poll2:
    buffer_load_dword v5, v14, s[44:47], s57 offen sc1
    s_add_u32 s67, s67, 1
    s_cmp_gt_u32 s67, 0x400000
    s_waitcnt vmcnt(0)
    s_cbranch_scc1 L_poll2x
    v_cmp_ne_u32 vcc, 1, v5
    s_cbranch_vccnz L_poll2
L_poll2x:
    s_waitcnt vmcnt(0)
    s_barrier
    s_xor_b32 s68, s52, 12
    s_lshl_b32 s68, s68, 17
    s_add_u32 s68, s68, s61
    s_mov_b32 m0, 131072
    s_nop 0
    buffer_load_dwordx4 v24, s[32:35], s68 offen offset:0 lds
    buffer_load_dwordx4 v25, s[32:35], s68 offen offset:1024 lds
    buffer_load_dwordx4 v26, s[32:35], s68 offen offset:2048 lds
    buffer_load_dwordx4 v27, s[32:35], s68 offen offset:3072 lds
    s_mov_b32 m0, 135168
    s_add_u32 s68, s68, 65536
    buffer_load_dwordx4 v24, s[32:35], s68 offen offset:0 lds
    buffer_load_dwordx4 v25, s[32:35], s68 offen offset:1024 lds
    buffer_load_dwordx4 v26, s[32:35], s68 offen offset:2048 lds
    buffer_load_dwordx4 v27, s[32:35], s68 offen offset:3072 lds
    s_xor_b32 s68, s52, 13
    s_lshl_b32 s68, s68, 17
    s_add_u32 s68, s68, s61
    s_mov_b32 m0, 139264
    s_nop 0
    buffer_load_dwordx4 v24, s[32:35], s68 offen offset:0 lds
    buffer_load_dwordx4 v25, s[32:35], s68 offen offset:1024 lds
    buffer_load_dwordx4 v26, s[32:35], s68 offen offset:2048 lds
    buffer_load_dwordx4 v27, s[32:35], s68 offen offset:3072 lds
    s_mov_b32 m0, 143360
    s_add_u32 s68, s68, 65536
    buffer_load_dwordx4 v24, s[32:35], s68 offen offset:0 lds
    buffer_load_dwordx4 v25, s[32:35], s68 offen offset:1024 lds
    buffer_load_dwordx4 v26, s[32:35], s68 offen offset:2048 lds
    buffer_load_dwordx4 v27, s[32:35], s68 offen offset:3072 lds
    s_xor_b32 s68, s52, 14
    s_lshl_b32 s68, s68, 17
    s_add_u32 s68, s68, s61
    s_mov_b32 m0, 147456
    s_nop 0
    buffer_load_dwordx4 v24, s[32:35], s68 offen offset:0 lds
    buffer_load_dwordx4 v25, s[32:35], s68 offen offset:1024 lds
    buffer_load_dwordx4 v26, s[32:35], s68 offen offset:2048 lds
    buffer_load_dwordx4 v27, s[32:35], s68 offen offset:3072 lds
    s_mov_b32 m0, 151552
    s_add_u32 s68, s68, 65536
    buffer_load_dwordx4 v24, s[32:35], s68 offen offset:0 lds
    buffer_load_dwordx4 v25, s[32:35], s68 offen offset:1024 lds
    buffer_load_dwordx4 v26, s[32:35], s68 offen offset:2048 lds
    buffer_load_dwordx4 v27, s[32:35], s68 offen offset:3072 lds
    s_xor_b32 s68, s52, 15
    s_lshl_b32 s68, s68, 17
    s_add_u32 s68, s68, s61
    s_mov_b32 m0, 155648
    s_nop 0
    buffer_load_dwordx4 v24, s[32:35], s68 offen offset:0 lds
    buffer_load_dwordx4 v25, s[32:35], s68 offen offset:1024 lds
    buffer_load_dwordx4 v26, s[32:35], s68 offen offset:2048 lds
    buffer_load_dwordx4 v27, s[32:35], s68 offen offset:3072 lds
    s_mov_b32 m0, 159744
    s_add_u32 s68, s68, 65536
    buffer_load_dwordx4 v24, s[32:35], s68 offen offset:0 lds
    buffer_load_dwordx4 v25, s[32:35], s68 offen offset:1024 lds
    buffer_load_dwordx4 v26, s[32:35], s68 offen offset:2048 lds
    buffer_load_dwordx4 v27, s[32:35], s68 offen offset:3072 lds
    s_waitcnt vmcnt(0)
    s_barrier
    s_endpgm
.p2align 12
L_compute:
    s_mov_b32 s44, s18
    s_mov_b32 s45, s19
    s_mov_b32 s46, 16777216
    s_mov_b32 s47, 0x20000
    s_mov_b32 s40, s16
    s_mov_b32 s41, s17
    s_mov_b32 s42, 256
    s_mov_b32 s43, 0x20000
    s_mov_b32 s36, s14
    s_mov_b32 s37, s15
    s_mov_b32 s38, 4194304
    s_mov_b32 s39, 0x20000
    s_lshl_b32 s60, s51, 2
    s_add_u32 s60, s60, s48
    s_lshl_b32 s60, s60, 16
    s_lshl_b32 s56, s52, 7
    s_add_u32 s65, s60, s56
    s_add_u32 s64, s60, 1048576
    s_xor_b32 s56, s52, 0
    s_lshl_b32 s56, s56, 12
    s_add_u32 s80, s56, s64
    s_xor_b32 s56, s52, 1
    s_lshl_b32 s56, s56, 12
    s_add_u32 s81, s56, s64
    s_xor_b32 s56, s52, 2
    s_lshl_b32 s56, s56, 12
    s_add_u32 s82, s56, s64
    s_xor_b32 s56, s52, 3
    s_lshl_b32 s56, s56, 12
    s_add_u32 s83, s56, s64
    s_xor_b32 s56, s52, 4
    s_lshl_b32 s56, s56, 12
    s_add_u32 s84, s56, s64
    s_xor_b32 s56, s52, 5
    s_lshl_b32 s56, s56, 12
    s_add_u32 s85, s56, s64
    s_xor_b32 s56, s52, 6
    s_lshl_b32 s56, s56, 12
    s_add_u32 s86, s56, s64
    s_xor_b32 s56, s52, 7
    s_lshl_b32 s56, s56, 12
    s_add_u32 s87, s56, s64
    s_xor_b32 s56, s52, 8
    s_lshl_b32 s56, s56, 12
    s_add_u32 s88, s56, s64
    s_xor_b32 s56, s52, 9
    s_lshl_b32 s56, s56, 12
    s_add_u32 s89, s56, s64
    s_xor_b32 s56, s52, 10
    s_lshl_b32 s56, s56, 12
    s_add_u32 s90, s56, s64
    s_xor_b32 s56, s52, 11
    s_lshl_b32 s56, s56, 12
    s_add_u32 s91, s56, s64
    s_xor_b32 s56, s52, 12
    s_lshl_b32 s56, s56, 12
    s_add_u32 s92, s56, s64
    s_xor_b32 s56, s52, 13
    s_lshl_b32 s56, s56, 12
    s_add_u32 s93, s56, s64
    s_xor_b32 s56, s52, 14
    s_lshl_b32 s56, s56, 12
    s_add_u32 s94, s56, s64
    s_xor_b32 s56, s52, 15
    s_lshl_b32 s56, s56, 12
    s_add_u32 s95, s56, s64
    s_lshr_b32 s56, s51, 1
    s_mul_i32 s55, s56, 8
    s_lshr_b32 s56, s51, 2
    s_mul_i32 s56, s56, 2
    s_add_u32 s55, s55, s56
    s_and_b32 s56, s51, 1
    s_mul_i32 s56, s56, 1
    s_add_u32 s55, s55, s56
    s_mul_i32 s56, s52, 8
    s_add_u32 s55, s55, s56
    s_lshl_b32 s57, s48, 13
    s_lshl_b32 s56, s54, 12
    s_add_u32 s57, s57, s56
    v_lshrrev_b32 v3, 4, v0
    v_and_b32 v2, 15, v0
    v_lshrrev_b32 v4, 1, v2
    v_xor_b32 v4, v4, v3
    v_lshlrev_b32 v4, 4, v4
    v_lshl_add_u32 v4, v2, 7, v4
    v_mov_b32 v224, v4
    v_xor_b32 v225, 64, v4
    v_add_u32 v182, s57, v4
    v_xor_b32 v183, 64, v182
    v_lshrrev_b32 v4, 2, v2
    v_lshl_add_u32 v5, v3, 3, v4
    v_lshlrev_b32 v5, 6, v5
    v_and_b32 v2, 3, v0
    v_lshl_add_u32 v5, v2, 3, v5
    s_lshl_b32 s56, s48, 13
    s_add_u32 s58, s56, 114688
    v_add_u32 v184, s58, v5
    s_cmp_lt_u32 s48, 2
    s_cselect_b32 s58, 147456, 0
    s_cselect_b32 s59, 0, 24576
    s_add_u32 s58, s58, s59
    s_add_u32 s58, s58, s56
    v_add_u32 v188, s58, v5
    v_lshrrev_b32 v16, 5, v0
    v_lshl_add_u32 v5, v3, 3, v4
    v_lshlrev_b32 v5, 7, v5
    v_lshl_add_u32 v5, v2, 3, v5
    v_and_b32 v17, 1, v3
    v_lshl_add_u32 v5, v17, 6, v5
    v_lshrrev_b32 v18, 1, v4
    v_lshl_add_u32 v5, v18, 5, v5
    v_add_u32 v228, 57344, v5
    v_xor_b32 v229, 32, v228
    v_xor_b32 v230, 64, v228
    v_xor_b32 v231, 96, v228
    v_add_u32 v232, 131072, v5
    v_xor_b32 v233, 32, v232
    v_xor_b32 v234, 64, v232
    v_xor_b32 v235, 96, v232
    v_lshl_add_u32 v5, v17, 2, v4
    v_lshrrev_b32 v21, 1, v5
    v_lshl_add_u32 v5, v16, 4, v5
    v_lshlrev_b32 v5, 7, v5
    v_lshl_add_u32 v5, v2, 3, v5
    v_lshl_add_u32 v5, v21, 5, v5
    v_add_u32 v6, 32768, v5
    v_xor_b32 v7, 32, v6
    v_xor_b32 v8, 64, v6
    v_xor_b32 v9, 96, v6
    v_and_b32 v19, 1, v2
    v_lshrrev_b32 v20, 1, v2
    s_lshl_b32 s71, s48, 12
    s_and_b32 s96, s53, 7
    s_lshl_b32 s56, s48, 1
    s_sub_u32 s96, s96, s56
    s_add_u32 s56, s71, 2048
    s_cmp_eq_u32 s96, 1
    s_cselect_b32 s56, 0, s56
    v_add_u32 v226, s56, v224
    v_add_u32 v227, s56, v225
    s_add_u32 s56, s71, 0
    s_cmp_eq_u32 s96, 0
    s_cselect_b32 s56, 0, s56
    v_add_u32 v224, s56, v224
    v_add_u32 v225, s56, v225
    s_and_b32 s97, s55, 15
    s_lshl_b32 s97, s97, 11
    v_and_b32 v5, 31, v0
    v_bfe_u32 v21, v0, 1, 2
    v_xor_b32 v22, v16, v21
    v_lshlrev_b32 v22, 4, v22
    v_lshl_add_u32 v22, v17, 3, v22
    v_and_b32 v5, 15, v0
    v_lshl_add_u32 v22, v5, 6, v22
    v_add_u32 v11, s71, v22
    v_xor_b32 v12, 32, v11
    v_lshrrev_b32 v22, 2, v0
    v_bfe_u32 v21, v0, 3, 2
    v_xor_b32 v23, v2, v21
    v_lshlrev_b32 v23, 4, v23
    v_lshl_add_u32 v23, v22, 6, v23
    v_add_u32 v13, s71, v23
    v_lshlrev_b32 v22, 11, v22
    v_lshl_add_u32 v10, v2, 4, v22
    s_lshr_b32 s56, s48, 1
    s_and_b32 s58, s48, 1
    s_lshr_b32 s69, s53, 1
    s_lshl_b32 s62, s69, 12
    s_and_b32 s59, s53, 1
    s_cmp_eq_u32 s54, 0
    s_cselect_b32 s66, s56, s58
    s_cselect_b32 s68, s58, s56
    s_cselect_b32 s56, 8, 9
    s_cselect_b32 s58, 9, 8
    s_cselect_b32 s71, 8, 10
    s_cselect_b32 s61, 0, 2048
    s_cselect_b32 s70, 0x3e8293ee, 1.0
    s_lshl_b32 s66, s66, 10
    s_lshl_b32 s68, s68, s56
    s_add_u32 s66, s66, s68
    s_add_u32 s66, s66, 32768
    v_lshrrev_b32 v4, 2, v0
    v_lshlrev_b32 v4, 4, v4
    v_lshl_add_u32 v4, v19, 3, v4
    v_lshlrev_b32 v5, s58, v20
    v_add3_u32 v185, v4, v5, s66
    s_lshl_b32 s56, s48, s58
    s_lshl_b32 s59, s59, s71
    s_add_u32 s62, s62, s61
    s_add_u32 s62, s62, s56
    s_add_u32 s62, s62, s59
    v_lshlrev_b32 v186, 2, v0
    s_lshl_b32 s69, s69, 2
    s_lshl_b32 s58, s48, 11
    s_add_u32 s58, s58, 32768
    v_add_u32 v187, s58, v1
    v_mov_b32 v132, 0xdddddddd
    v_mov_b32 v133, v1
    v_add_u32 v134, 65536, v1
    v_add_u32 v135, 131072, v1
    v_bfe_u32 v4, v0, 2, 1
    v_mov_b32 v5, 0x3f803f80
    v_and_b32 v2, 11, v0
    v_cmp_eq_u32 vcc, 0, v2
    s_nop 1
    v_cndmask_b32 v5, 0, v5, vcc
    v_mul_lo_u32 v130, v4, v5
    v_mov_b32 v131, v130
    v_sub_u32 v128, v5, v130
    v_mov_b32 v129, v128
    v_mov_b32 v136, 0
    v_mov_b32 v137, 0
    v_mov_b32 v138, 0
    v_mov_b32 v139, 0
    v_mov_b32 v140, 0
    v_mov_b32 v141, 0
    v_mov_b32 v142, 0
    v_mov_b32 v143, 0
    v_mov_b32 v144, 0
    v_mov_b32 v145, 0
    v_mov_b32 v146, 0
    v_mov_b32 v147, 0
    v_mov_b32 v148, 0
    v_mov_b32 v149, 0
    v_mov_b32 v150, 0
    v_mov_b32 v151, 0
    v_mov_b32 v152, 0
    v_mov_b32 v153, 0
    v_mov_b32 v154, 0
    v_mov_b32 v155, 0
    v_mov_b32 v156, 0
    v_mov_b32 v157, 0
    v_mov_b32 v158, 0
    v_mov_b32 v159, 0
    v_mov_b32 v160, 0
    v_mov_b32 v161, 0
    v_mov_b32 v162, 0
    v_mov_b32 v163, 0
    v_mov_b32 v164, 0
    v_mov_b32 v165, 0
    v_mov_b32 v166, 0
    v_mov_b32 v167, 0
    v_mov_b32 v168, 0
    v_mov_b32 v169, 0
    v_mov_b32 v170, 0
    v_mov_b32 v171, 0
    v_mov_b32 v172, 0
    v_mov_b32 v173, 0
    v_mov_b32 v174, 0
    v_mov_b32 v175, 0
    s_waitcnt vmcnt(0)
    s_sub_u32 s71, s48, 4
    s_mov_b64 exec, 0
L_pgret:
    s_add_u32 s71, s71, 4
    s_cmp_eq_u32 s71, 0
    s_cbranch_scc1 L_pg0
    s_cmp_eq_u32 s71, 1
    s_cbranch_scc1 L_pg1
    s_cmp_eq_u32 s71, 2
    s_cbranch_scc1 L_pg2
    s_cmp_eq_u32 s71, 3
    s_cbranch_scc1 L_pg3
    s_cmp_eq_u32 s71, 4
    s_cbranch_scc1 L_pg4
    s_cmp_eq_u32 s71, 5
    s_cbranch_scc1 L_pg5
    s_cmp_eq_u32 s71, 6
    s_cbranch_scc1 L_pg6
    s_cmp_eq_u32 s71, 7
    s_cbranch_scc1 L_pg7
    s_cmp_eq_u32 s71, 8
    s_nop 0
    s_cmp_eq_u32 s71, 9
    s_nop 0
    s_cmp_eq_u32 s71, 10
    s_nop 0
    s_cmp_eq_u32 s71, 11
    s_nop 0
    s_mov_b64 exec, -1
    s_cmp_eq_u32 s54, 0
    s_cbranch_scc0 L_vmat
    s_barrier
    ds_read_b128 v[16:19], v182 offset:0
    ds_read_b64_tr_b16 v[48:49], v184 offset:0
    ds_read_b64_tr_b16 v[50:51], v184 offset:256
    ds_read_b64_tr_b16 v[52:53], v184 offset:32
    ds_read_b64_tr_b16 v[54:55], v184 offset:288
    ds_read_b128 v[20:23], v183 offset:0
    ds_read_b64_tr_b16 v[56:57], v184 offset:2048
    ds_read_b64_tr_b16 v[58:59], v184 offset:2304
    ds_read_b64_tr_b16 v[60:61], v184 offset:2080
    ds_read_b64_tr_b16 v[62:63], v184 offset:2336
    ds_read_b128 v[24:27], v182 offset:2048
    ds_read_b64_tr_b16 v[64:65], v184 offset:4096
    ds_read_b64_tr_b16 v[66:67], v184 offset:4352
    ds_read_b64_tr_b16 v[68:69], v184 offset:4128
    ds_read_b64_tr_b16 v[70:71], v184 offset:4384
    s_waitcnt lgkmcnt(10)
    v_mfma_f32_16x16x32_bf16 v[112:115], v[48:51], v[16:19], 0
    v_mfma_f32_16x16x32_bf16 v[116:119], v[52:55], v[16:19], 0
    ds_read_b128 v[28:31], v183 offset:2048
    ds_read_b64_tr_b16 v[72:73], v184 offset:6144
    ds_read_b64_tr_b16 v[74:75], v184 offset:6400
    ds_read_b64_tr_b16 v[76:77], v184 offset:6176
    ds_read_b64_tr_b16 v[78:79], v184 offset:6432
    v_xor_b32 v182, 4096, v182
    v_xor_b32 v183, 4096, v183
    s_waitcnt lgkmcnt(10)
    v_mfma_f32_16x16x32_bf16 v[112:115], v[56:59], v[20:23], v[112:115]
    v_mfma_f32_16x16x32_bf16 v[116:119], v[60:63], v[20:23], v[116:119]
    s_waitcnt lgkmcnt(5)
    v_mfma_f32_16x16x32_bf16 v[112:115], v[64:67], v[24:27], v[112:115]
    v_mfma_f32_16x16x32_bf16 v[116:119], v[68:71], v[24:27], v[116:119]
    s_waitcnt lgkmcnt(0)
    v_mfma_f32_16x16x32_bf16 v[112:115], v[72:75], v[28:31], v[112:115]
    v_mfma_f32_16x16x32_bf16 v[116:119], v[76:79], v[28:31], v[116:119]
    s_barrier
    ds_read_b128 v[32:35], v182 offset:0
    ds_read_b64_tr_b16 v[80:81], v188 offset:0
    ds_read_b64_tr_b16 v[82:83], v188 offset:256
    ds_read_b64_tr_b16 v[84:85], v188 offset:32
    ds_read_b64_tr_b16 v[86:87], v188 offset:288
    ds_read_b128 v[36:39], v183 offset:0
    ds_read_b64_tr_b16 v[88:89], v188 offset:2048
    ds_read_b64_tr_b16 v[90:91], v188 offset:2304
    ds_read_b64_tr_b16 v[92:93], v188 offset:2080
    ds_read_b64_tr_b16 v[94:95], v188 offset:2336
    ds_read_b128 v[40:43], v182 offset:2048
    ds_read_b64_tr_b16 v[96:97], v188 offset:4096
    ds_read_b64_tr_b16 v[98:99], v188 offset:4352
    ds_read_b64_tr_b16 v[100:101], v188 offset:4128
    ds_read_b64_tr_b16 v[102:103], v188 offset:4384
    s_waitcnt lgkmcnt(10)
    v_mfma_f32_16x16x32_bf16 v[112:115], v[80:83], v[32:35], v[112:115]
    v_mfma_f32_16x16x32_bf16 v[116:119], v[84:87], v[32:35], v[116:119]
    ds_read_b128 v[44:47], v183 offset:2048
    ds_read_b64_tr_b16 v[104:105], v188 offset:6144
    ds_read_b64_tr_b16 v[106:107], v188 offset:6400
    ds_read_b64_tr_b16 v[108:109], v188 offset:6176
    ds_read_b64_tr_b16 v[110:111], v188 offset:6432
    s_waitcnt lgkmcnt(10)
    v_mfma_f32_16x16x32_bf16 v[112:115], v[88:91], v[36:39], v[112:115]
    v_mfma_f32_16x16x32_bf16 v[116:119], v[92:95], v[36:39], v[116:119]
    s_waitcnt lgkmcnt(5)
    v_mfma_f32_16x16x32_bf16 v[112:115], v[96:99], v[40:43], v[112:115]
    v_mfma_f32_16x16x32_bf16 v[116:119], v[100:103], v[40:43], v[116:119]
    s_waitcnt lgkmcnt(0)
    v_mfma_f32_16x16x32_bf16 v[112:115], v[104:107], v[44:47], v[112:115]
    v_mfma_f32_16x16x32_bf16 v[116:119], v[108:111], v[44:47], v[116:119]
    s_branch L_kvdone
L_vmat:
    s_barrier
    ds_read_b128 v[16:19], v182 offset:0
    ds_read_b64_tr_b16 v[48:49], v184 offset:0
    ds_read_b64_tr_b16 v[50:51], v184 offset:256
    ds_read_b64_tr_b16 v[52:53], v184 offset:32
    ds_read_b64_tr_b16 v[54:55], v184 offset:288
    ds_read_b128 v[20:23], v183 offset:0
    ds_read_b64_tr_b16 v[56:57], v184 offset:2048
    ds_read_b64_tr_b16 v[58:59], v184 offset:2304
    ds_read_b64_tr_b16 v[60:61], v184 offset:2080
    ds_read_b64_tr_b16 v[62:63], v184 offset:2336
    ds_read_b128 v[24:27], v182 offset:2048
    ds_read_b64_tr_b16 v[64:65], v184 offset:4096
    ds_read_b64_tr_b16 v[66:67], v184 offset:4352
    ds_read_b64_tr_b16 v[68:69], v184 offset:4128
    ds_read_b64_tr_b16 v[70:71], v184 offset:4384
    s_waitcnt lgkmcnt(10)
    v_mfma_f32_16x16x32_bf16 v[112:115], v[16:19], v[48:51], 0
    v_mfma_f32_16x16x32_bf16 v[116:119], v[16:19], v[52:55], 0
    ds_read_b128 v[28:31], v183 offset:2048
    ds_read_b64_tr_b16 v[72:73], v184 offset:6144
    ds_read_b64_tr_b16 v[74:75], v184 offset:6400
    ds_read_b64_tr_b16 v[76:77], v184 offset:6176
    ds_read_b64_tr_b16 v[78:79], v184 offset:6432
    v_xor_b32 v182, 4096, v182
    v_xor_b32 v183, 4096, v183
    s_waitcnt lgkmcnt(10)
    v_mfma_f32_16x16x32_bf16 v[112:115], v[20:23], v[56:59], v[112:115]
    v_mfma_f32_16x16x32_bf16 v[116:119], v[20:23], v[60:63], v[116:119]
    s_waitcnt lgkmcnt(5)
    v_mfma_f32_16x16x32_bf16 v[112:115], v[24:27], v[64:67], v[112:115]
    v_mfma_f32_16x16x32_bf16 v[116:119], v[24:27], v[68:71], v[116:119]
    s_waitcnt lgkmcnt(0)
    v_mfma_f32_16x16x32_bf16 v[112:115], v[28:31], v[72:75], v[112:115]
    v_mfma_f32_16x16x32_bf16 v[116:119], v[28:31], v[76:79], v[116:119]
    s_barrier
    ds_read_b128 v[32:35], v182 offset:0
    ds_read_b64_tr_b16 v[80:81], v188 offset:0
    ds_read_b64_tr_b16 v[82:83], v188 offset:256
    ds_read_b64_tr_b16 v[84:85], v188 offset:32
    ds_read_b64_tr_b16 v[86:87], v188 offset:288
    ds_read_b128 v[36:39], v183 offset:0
    ds_read_b64_tr_b16 v[88:89], v188 offset:2048
    ds_read_b64_tr_b16 v[90:91], v188 offset:2304
    ds_read_b64_tr_b16 v[92:93], v188 offset:2080
    ds_read_b64_tr_b16 v[94:95], v188 offset:2336
    ds_read_b128 v[40:43], v182 offset:2048
    ds_read_b64_tr_b16 v[96:97], v188 offset:4096
    ds_read_b64_tr_b16 v[98:99], v188 offset:4352
    ds_read_b64_tr_b16 v[100:101], v188 offset:4128
    ds_read_b64_tr_b16 v[102:103], v188 offset:4384
    s_waitcnt lgkmcnt(10)
    v_mfma_f32_16x16x32_bf16 v[112:115], v[32:35], v[80:83], v[112:115]
    v_mfma_f32_16x16x32_bf16 v[116:119], v[32:35], v[84:87], v[116:119]
    ds_read_b128 v[44:47], v183 offset:2048
    ds_read_b64_tr_b16 v[104:105], v188 offset:6144
    ds_read_b64_tr_b16 v[106:107], v188 offset:6400
    ds_read_b64_tr_b16 v[108:109], v188 offset:6176
    ds_read_b64_tr_b16 v[110:111], v188 offset:6432
    s_waitcnt lgkmcnt(10)
    v_mfma_f32_16x16x32_bf16 v[112:115], v[36:39], v[88:91], v[112:115]
    v_mfma_f32_16x16x32_bf16 v[116:119], v[36:39], v[92:95], v[116:119]
    s_waitcnt lgkmcnt(5)
    v_mfma_f32_16x16x32_bf16 v[112:115], v[40:43], v[96:99], v[112:115]
    v_mfma_f32_16x16x32_bf16 v[116:119], v[40:43], v[100:103], v[116:119]
    s_waitcnt lgkmcnt(0)
    v_mfma_f32_16x16x32_bf16 v[112:115], v[44:47], v[104:107], v[112:115]
    v_mfma_f32_16x16x32_bf16 v[116:119], v[44:47], v[108:111], v[116:119]
L_kvdone:
    s_nop 6
    ds_write_b128 v187, v[112:115]
    ds_write_b128 v187, v[116:119] offset:1024
    s_waitcnt lgkmcnt(0)
    s_barrier
    ds_read_b64 v[112:113], v185 offset:0
    ds_read_b64 v[114:115], v185 offset:2048
    ds_read_b64 v[116:117], v185 offset:4096
    ds_read_b64 v[118:119], v185 offset:6144
    s_waitcnt lgkmcnt(2)
    v_add_f32 v112, v112, v114
    v_add_f32 v113, v113, v115
    s_waitcnt lgkmcnt(0)
    v_add_f32 v116, v116, v118
    v_add_f32 v117, v117, v119
    v_add_f32 v112, v112, v116
    v_add_f32 v113, v113, v117
    v_mul_f32 v112, s70, v112
    v_mul_f32 v113, s70, v113
    v_cvt_pk_bf16_f32 v4, v112, v113
    buffer_store_dword v4, v186, s[44:47], s62 offen sc1
    s_cmp_lg_u32 s48, 0
    s_cbranch_scc1 L_nrst
    s_lshl_b32 s56, s51, 4
    s_add_u32 s56, s56, s52
    s_lshl_b32 s56, s56, 7
    s_add_u32 s56, s56, 524288
    s_mov_b64 exec, 1
    buffer_store_dword v186, v186, s[44:47], s56 offen sc1
    s_mov_b64 exec, -1
L_nrst:
    s_cmp_eq_u32 s96, 0
    s_cselect_b32 s58, s97, 65536
    s_cmp_eq_u32 s96, 1
    s_cselect_b32 s59, s97, 65536
    v_add_u32 v176, s58, v224
    v_add_u32 v177, s58, v225
    v_add_u32 v178, s59, v226
    v_add_u32 v179, s59, v227
    s_waitcnt lgkmcnt(0)
    s_barrier
    ds_read_b128 v[16:19], v176
    ds_read_b128 v[20:23], v178
    ds_read_b64_tr_b16 v[32:33], v228 offset:24576
    ds_read_b64_tr_b16 v[34:35], v228 offset:25088
    ds_read_b64_tr_b16 v[36:37], v229 offset:24576
    ds_read_b64_tr_b16 v[38:39], v229 offset:25088
    ds_read_b64_tr_b16 v[40:41], v230 offset:24576
    ds_read_b64_tr_b16 v[42:43], v230 offset:25088
    ds_read_b64_tr_b16 v[44:45], v231 offset:24576
    ds_read_b64_tr_b16 v[46:47], v231 offset:25088
    s_waitcnt lgkmcnt(6)
    v_mfma_f32_16x16x32_bf16 v[192:195], v[32:35], v[16:19], 0
    s_add_u32 s97, s97, 2048
    ds_read_b128 v[24:27], v177
    ds_read_b128 v[28:31], v179
    v_mfma_f32_16x16x32_bf16 v[196:199], v[32:35], v[20:23], 0
    s_and_b32 s97, s97, 32767
    ds_read_b64_tr_b16 v[48:49], v228 offset:28672
    ds_read_b64_tr_b16 v[50:51], v228 offset:29184
    s_waitcnt lgkmcnt(8)
    v_mfma_f32_16x16x32_bf16 v[200:203], v[36:39], v[16:19], 0
    s_cmp_eq_u32 s96, 0
    ds_read_b64_tr_b16 v[52:53], v229 offset:28672
    ds_read_b64_tr_b16 v[54:55], v229 offset:29184
    v_mfma_f32_16x16x32_bf16 v[204:207], v[36:39], v[20:23], 0
    s_cselect_b32 s58, s97, 90112
    ds_read_b64_tr_b16 v[56:57], v230 offset:28672
    ds_read_b64_tr_b16 v[58:59], v230 offset:29184
    s_waitcnt lgkmcnt(10)
    v_mfma_f32_16x16x32_bf16 v[208:211], v[40:43], v[16:19], 0
    s_cmp_eq_u32 s96, 1
    ds_read_b64_tr_b16 v[60:61], v231 offset:28672
    ds_read_b64_tr_b16 v[62:63], v231 offset:29184
    v_mfma_f32_16x16x32_bf16 v[212:215], v[40:43], v[20:23], 0
    s_cselect_b32 s59, s97, 90112
    v_add_u32 v176, s58, v224
    v_add_u32 v177, s58, v225
    s_waitcnt lgkmcnt(10)
    v_mfma_f32_16x16x32_bf16 v[216:219], v[44:47], v[16:19], 0
    v_add_u32 v178, s59, v226
    v_add_u32 v179, s59, v227
    v_mfma_f32_16x16x32_bf16 v[220:223], v[44:47], v[20:23], 0
    s_waitcnt lgkmcnt(6)
    v_mfma_f32_16x16x32_bf16 v[192:195], v[48:51], v[24:27], v[192:195]
    v_mfma_f32_16x16x32_bf16 v[196:199], v[48:51], v[28:31], v[196:199]
    s_waitcnt lgkmcnt(0)
    s_barrier
    ds_read_b128 v[64:67], v176
    ds_read_b128 v[68:71], v178
    v_mfma_f32_16x16x32_bf16 v[200:203], v[52:55], v[24:27], v[200:203]
    s_add_u32 s97, s97, 2048
    ds_read_b64_tr_b16 v[80:81], v228 offset:49152
    ds_read_b64_tr_b16 v[82:83], v228 offset:49664
    v_mfma_f32_16x16x32_bf16 v[204:207], v[52:55], v[28:31], v[204:207]
    s_and_b32 s97, s97, 32767
    ds_read_b64_tr_b16 v[84:85], v229 offset:49152
    ds_read_b64_tr_b16 v[86:87], v229 offset:49664
    v_mfma_f32_16x16x32_bf16 v[208:211], v[56:59], v[24:27], v[208:211]
    s_cmp_eq_u32 s96, 0
    ds_read_b64_tr_b16 v[88:89], v230 offset:49152
    ds_read_b64_tr_b16 v[90:91], v230 offset:49664
    v_mfma_f32_16x16x32_bf16 v[212:215], v[56:59], v[28:31], v[212:215]
    s_cselect_b32 s58, s97, 114688
    ds_read_b64_tr_b16 v[92:93], v231 offset:49152
    ds_read_b64_tr_b16 v[94:95], v231 offset:49664
    v_mfma_f32_16x16x32_bf16 v[216:219], v[60:63], v[24:27], v[216:219]
    s_cmp_eq_u32 s96, 1
    ds_read_b128 v[72:75], v177
    ds_read_b128 v[76:79], v179
    v_mfma_f32_16x16x32_bf16 v[220:223], v[60:63], v[28:31], v[220:223]
    s_cselect_b32 s59, s97, 114688
    ds_read_b64_tr_b16 v[96:97], v228 offset:53248
    ds_read_b64_tr_b16 v[98:99], v228 offset:53760
    s_waitcnt lgkmcnt(10)
    v_mfma_f32_16x16x32_bf16 v[192:195], v[80:83], v[64:67], v[192:195]
    ds_read_b64_tr_b16 v[100:101], v229 offset:53248
    ds_read_b64_tr_b16 v[102:103], v229 offset:53760
    v_mfma_f32_16x16x32_bf16 v[196:199], v[80:83], v[68:71], v[196:199]
    ds_read_b64_tr_b16 v[104:105], v230 offset:53248
    ds_read_b64_tr_b16 v[106:107], v230 offset:53760
    s_waitcnt lgkmcnt(12)
    v_mfma_f32_16x16x32_bf16 v[200:203], v[84:87], v[64:67], v[200:203]
    ds_read_b64_tr_b16 v[108:109], v231 offset:53248
    ds_read_b64_tr_b16 v[110:111], v231 offset:53760
    v_mfma_f32_16x16x32_bf16 v[204:207], v[84:87], v[68:71], v[204:207]
    v_add_u32 v176, s58, v224
    v_add_u32 v177, s58, v225
    s_waitcnt lgkmcnt(12)
    v_mfma_f32_16x16x32_bf16 v[208:211], v[88:91], v[64:67], v[208:211]
    v_add_u32 v178, s59, v226
    v_add_u32 v179, s59, v227
    v_mfma_f32_16x16x32_bf16 v[212:215], v[88:91], v[68:71], v[212:215]
    s_waitcnt lgkmcnt(10)
    v_mfma_f32_16x16x32_bf16 v[216:219], v[92:95], v[64:67], v[216:219]
    v_mfma_f32_16x16x32_bf16 v[220:223], v[92:95], v[68:71], v[220:223]
    s_waitcnt lgkmcnt(6)
    v_mfma_f32_16x16x32_bf16 v[192:195], v[96:99], v[72:75], v[192:195]
    v_mfma_f32_16x16x32_bf16 v[196:199], v[96:99], v[76:79], v[196:199]
    s_waitcnt lgkmcnt(0)
    s_barrier
    ds_read_b128 v[16:19], v176
    ds_read_b128 v[20:23], v178
    v_mfma_f32_16x16x32_bf16 v[200:203], v[100:103], v[72:75], v[200:203]
    s_add_u32 s97, s97, 2048
    ds_read_b64_tr_b16 v[32:33], v232 offset:0
    ds_read_b64_tr_b16 v[34:35], v232 offset:512
    v_mfma_f32_16x16x32_bf16 v[204:207], v[100:103], v[76:79], v[204:207]
    s_and_b32 s97, s97, 32767
    ds_read_b64_tr_b16 v[36:37], v233 offset:0
    ds_read_b64_tr_b16 v[38:39], v233 offset:512
    v_mfma_f32_16x16x32_bf16 v[208:211], v[104:107], v[72:75], v[208:211]
    s_cmp_eq_u32 s96, 0
    ds_read_b64_tr_b16 v[40:41], v234 offset:0
    ds_read_b64_tr_b16 v[42:43], v234 offset:512
    v_mfma_f32_16x16x32_bf16 v[212:215], v[104:107], v[76:79], v[212:215]
    s_cselect_b32 s58, s97, 139264
    ds_read_b64_tr_b16 v[44:45], v235 offset:0
    ds_read_b64_tr_b16 v[46:47], v235 offset:512
    v_mfma_f32_16x16x32_bf16 v[216:219], v[108:111], v[72:75], v[216:219]
    s_cmp_eq_u32 s96, 1
    ds_read_b128 v[24:27], v177
    ds_read_b128 v[28:31], v179
    v_mfma_f32_16x16x32_bf16 v[220:223], v[108:111], v[76:79], v[220:223]
    s_cselect_b32 s59, s97, 139264
    ds_read_b64_tr_b16 v[48:49], v232 offset:4096
    ds_read_b64_tr_b16 v[50:51], v232 offset:4608
    s_waitcnt lgkmcnt(10)
    v_mfma_f32_16x16x32_bf16 v[192:195], v[32:35], v[16:19], v[192:195]
    ds_read_b64_tr_b16 v[52:53], v233 offset:4096
    ds_read_b64_tr_b16 v[54:55], v233 offset:4608
    v_mfma_f32_16x16x32_bf16 v[196:199], v[32:35], v[20:23], v[196:199]
    ds_read_b64_tr_b16 v[56:57], v234 offset:4096
    ds_read_b64_tr_b16 v[58:59], v234 offset:4608
    s_waitcnt lgkmcnt(12)
    v_mfma_f32_16x16x32_bf16 v[200:203], v[36:39], v[16:19], v[200:203]
    ds_read_b64_tr_b16 v[60:61], v235 offset:4096
    ds_read_b64_tr_b16 v[62:63], v235 offset:4608
    v_mfma_f32_16x16x32_bf16 v[204:207], v[36:39], v[20:23], v[204:207]
    v_add_u32 v176, s58, v224
    v_add_u32 v177, s58, v225
    s_waitcnt lgkmcnt(12)
    v_mfma_f32_16x16x32_bf16 v[208:211], v[40:43], v[16:19], v[208:211]
    v_add_u32 v178, s59, v226
    v_add_u32 v179, s59, v227
    v_mfma_f32_16x16x32_bf16 v[212:215], v[40:43], v[20:23], v[212:215]
    s_waitcnt lgkmcnt(10)
    v_mfma_f32_16x16x32_bf16 v[216:219], v[44:47], v[16:19], v[216:219]
    v_mfma_f32_16x16x32_bf16 v[220:223], v[44:47], v[20:23], v[220:223]
    s_waitcnt lgkmcnt(6)
    v_mfma_f32_16x16x32_bf16 v[192:195], v[48:51], v[24:27], v[192:195]
    v_mfma_f32_16x16x32_bf16 v[196:199], v[48:51], v[28:31], v[196:199]
    s_waitcnt vmcnt(0) lgkmcnt(0)
    s_barrier
    ds_read_b128 v[64:67], v176
    ds_read_b128 v[68:71], v178
    v_mfma_f32_16x16x32_bf16 v[200:203], v[52:55], v[24:27], v[200:203]
    s_add_u32 s97, s97, 2048
    ds_read_b64_tr_b16 v[80:81], v232 offset:24576
    ds_read_b64_tr_b16 v[82:83], v232 offset:25088
    v_mfma_f32_16x16x32_bf16 v[204:207], v[52:55], v[28:31], v[204:207]
    s_and_b32 s97, s97, 32767
    ds_read_b64_tr_b16 v[84:85], v233 offset:24576
    ds_read_b64_tr_b16 v[86:87], v233 offset:25088
    v_mfma_f32_16x16x32_bf16 v[208:211], v[56:59], v[24:27], v[208:211]
    s_cmp_eq_u32 s96, 0
    ds_read_b64_tr_b16 v[88:89], v234 offset:24576
    ds_read_b64_tr_b16 v[90:91], v234 offset:25088
    v_mfma_f32_16x16x32_bf16 v[212:215], v[56:59], v[28:31], v[212:215]
    s_cselect_b32 s58, s97, 40960
    ds_read_b64_tr_b16 v[92:93], v235 offset:24576
    ds_read_b64_tr_b16 v[94:95], v235 offset:25088
    v_mfma_f32_16x16x32_bf16 v[216:219], v[60:63], v[24:27], v[216:219]
    s_cmp_eq_u32 s96, 1
    ds_read_b128 v[72:75], v177
    ds_read_b128 v[76:79], v179
    v_mfma_f32_16x16x32_bf16 v[220:223], v[60:63], v[28:31], v[220:223]
    s_cselect_b32 s59, s97, 40960
    ds_read_b64_tr_b16 v[96:97], v232 offset:28672
    ds_read_b64_tr_b16 v[98:99], v232 offset:29184
    s_waitcnt lgkmcnt(10)
    v_mfma_f32_16x16x32_bf16 v[192:195], v[80:83], v[64:67], v[192:195]
    ds_read_b64_tr_b16 v[100:101], v233 offset:28672
    ds_read_b64_tr_b16 v[102:103], v233 offset:29184
    v_mfma_f32_16x16x32_bf16 v[196:199], v[80:83], v[68:71], v[196:199]
    ds_read_b64_tr_b16 v[104:105], v234 offset:28672
    ds_read_b64_tr_b16 v[106:107], v234 offset:29184
    s_waitcnt lgkmcnt(12)
    v_mfma_f32_16x16x32_bf16 v[200:203], v[84:87], v[64:67], v[200:203]
    ds_read_b64_tr_b16 v[108:109], v235 offset:28672
    ds_read_b64_tr_b16 v[110:111], v235 offset:29184
    v_mfma_f32_16x16x32_bf16 v[204:207], v[84:87], v[68:71], v[204:207]
    v_add_u32 v176, s58, v224
    v_add_u32 v177, s58, v225
    s_waitcnt lgkmcnt(12)
    v_mfma_f32_16x16x32_bf16 v[208:211], v[88:91], v[64:67], v[208:211]
    v_add_u32 v178, s59, v226
    v_add_u32 v179, s59, v227
    v_mfma_f32_16x16x32_bf16 v[212:215], v[88:91], v[68:71], v[212:215]
    s_waitcnt lgkmcnt(10)
    v_mfma_f32_16x16x32_bf16 v[216:219], v[92:95], v[64:67], v[216:219]
    v_mfma_f32_16x16x32_bf16 v[220:223], v[92:95], v[68:71], v[220:223]
    s_waitcnt lgkmcnt(6)
    v_mfma_f32_16x16x32_bf16 v[192:195], v[96:99], v[72:75], v[192:195]
    v_mfma_f32_16x16x32_bf16 v[196:199], v[96:99], v[76:79], v[196:199]
    s_cmp_lg_u32 s48, 0
    s_cbranch_scc1 L_nf3
    s_mov_b64 exec, 1
    v_mov_b32 v2, s69
    v_mov_b32 v3, 1
    s_mov_b64 exec, -1
L_nf3:
    s_waitcnt lgkmcnt(0)
    s_barrier
    ds_read_b128 v[16:19], v176
    ds_read_b128 v[20:23], v178
    v_mfma_f32_16x16x32_bf16 v[200:203], v[100:103], v[72:75], v[200:203]
    s_add_u32 s97, s97, 2048
    ds_read_b64_tr_b16 v[32:33], v228 offset:0
    ds_read_b64_tr_b16 v[34:35], v228 offset:512
    v_mfma_f32_16x16x32_bf16 v[204:207], v[100:103], v[76:79], v[204:207]
    s_and_b32 s97, s97, 32767
    ds_read_b64_tr_b16 v[36:37], v229 offset:0
    ds_read_b64_tr_b16 v[38:39], v229 offset:512
    v_mfma_f32_16x16x32_bf16 v[208:211], v[104:107], v[72:75], v[208:211]
    s_cmp_eq_u32 s96, 0
    ds_read_b64_tr_b16 v[40:41], v230 offset:0
    ds_read_b64_tr_b16 v[42:43], v230 offset:512
L_pg0:
    s_cbranch_execz L_pgret
    v_mfma_f32_16x16x32_bf16 v[212:215], v[104:107], v[76:79], v[212:215]
    s_cselect_b32 s58, s97, 65536
    ds_read_b64_tr_b16 v[44:45], v231 offset:0
    ds_read_b64_tr_b16 v[46:47], v231 offset:512
    v_mfma_f32_16x16x32_bf16 v[216:219], v[108:111], v[72:75], v[216:219]
    s_cmp_eq_u32 s96, 1
    ds_read_b128 v[24:27], v177
    ds_read_b128 v[28:31], v179
    v_mfma_f32_16x16x32_bf16 v[220:223], v[108:111], v[76:79], v[220:223]
    s_cselect_b32 s59, s97, 65536
    ds_read_b64_tr_b16 v[48:49], v228 offset:4096
    ds_read_b64_tr_b16 v[50:51], v228 offset:4608
    s_waitcnt lgkmcnt(10)
    v_mfma_f32_16x16x32_bf16 v[192:195], v[32:35], v[16:19], v[192:195]
    ds_read_b64_tr_b16 v[52:53], v229 offset:4096
    ds_read_b64_tr_b16 v[54:55], v229 offset:4608
    v_mfma_f32_16x16x32_bf16 v[196:199], v[32:35], v[20:23], v[196:199]
    ds_read_b64_tr_b16 v[56:57], v230 offset:4096
    ds_read_b64_tr_b16 v[58:59], v230 offset:4608
    s_waitcnt lgkmcnt(12)
    v_mfma_f32_16x16x32_bf16 v[200:203], v[36:39], v[16:19], v[200:203]
    ds_read_b64_tr_b16 v[60:61], v231 offset:4096
    ds_read_b64_tr_b16 v[62:63], v231 offset:4608
    v_mfma_f32_16x16x32_bf16 v[204:207], v[36:39], v[20:23], v[204:207]
    v_add_u32 v176, s58, v224
    v_add_u32 v177, s58, v225
    s_waitcnt lgkmcnt(12)
    v_mfma_f32_16x16x32_bf16 v[208:211], v[40:43], v[16:19], v[208:211]
    v_add_u32 v178, s59, v226
    v_add_u32 v179, s59, v227
    v_mfma_f32_16x16x32_bf16 v[212:215], v[40:43], v[20:23], v[212:215]
    s_waitcnt lgkmcnt(10)
    v_mfma_f32_16x16x32_bf16 v[216:219], v[44:47], v[16:19], v[216:219]
    v_mfma_f32_16x16x32_bf16 v[220:223], v[44:47], v[20:23], v[220:223]
    s_waitcnt lgkmcnt(6)
    v_mfma_f32_16x16x32_bf16 v[192:195], v[48:51], v[24:27], v[192:195]
    v_mfma_f32_16x16x32_bf16 v[196:199], v[48:51], v[28:31], v[196:199]
    s_waitcnt lgkmcnt(0)
    s_barrier
    ds_read_b128 v[64:67], v176
    ds_read_b128 v[68:71], v178
    v_mfma_f32_16x16x32_bf16 v[200:203], v[52:55], v[24:27], v[200:203]
    s_add_u32 s97, s97, 2048
    ds_read_b64_tr_b16 v[80:81], v228 offset:24576
    ds_read_b64_tr_b16 v[82:83], v228 offset:25088
    v_mfma_f32_16x16x32_bf16 v[204:207], v[52:55], v[28:31], v[204:207]
    s_and_b32 s97, s97, 32767
    ds_read_b64_tr_b16 v[84:85], v229 offset:24576
    ds_read_b64_tr_b16 v[86:87], v229 offset:25088
    v_mfma_f32_16x16x32_bf16 v[208:211], v[56:59], v[24:27], v[208:211]
    s_cmp_eq_u32 s96, 0
    ds_read_b64_tr_b16 v[88:89], v230 offset:24576
    ds_read_b64_tr_b16 v[90:91], v230 offset:25088
    v_mfma_f32_16x16x32_bf16 v[212:215], v[56:59], v[28:31], v[212:215]
    s_cselect_b32 s58, s97, 90112
    ds_read_b64_tr_b16 v[92:93], v231 offset:24576
    ds_read_b64_tr_b16 v[94:95], v231 offset:25088
    v_mfma_f32_16x16x32_bf16 v[216:219], v[60:63], v[24:27], v[216:219]
    s_cmp_eq_u32 s96, 1
    ds_read_b128 v[72:75], v177
    ds_read_b128 v[76:79], v179
    v_mfma_f32_16x16x32_bf16 v[220:223], v[60:63], v[28:31], v[220:223]
    s_cselect_b32 s59, s97, 90112
    ds_read_b64_tr_b16 v[96:97], v228 offset:28672
    ds_read_b64_tr_b16 v[98:99], v228 offset:29184
    s_waitcnt lgkmcnt(10)
    v_mfma_f32_16x16x32_bf16 v[192:195], v[80:83], v[64:67], v[192:195]
    ds_read_b64_tr_b16 v[100:101], v229 offset:28672
    ds_read_b64_tr_b16 v[102:103], v229 offset:29184
    v_mfma_f32_16x16x32_bf16 v[196:199], v[80:83], v[68:71], v[196:199]
    ds_read_b64_tr_b16 v[104:105], v230 offset:28672
    ds_read_b64_tr_b16 v[106:107], v230 offset:29184
    s_waitcnt lgkmcnt(12)
    v_mfma_f32_16x16x32_bf16 v[200:203], v[84:87], v[64:67], v[200:203]
    ds_read_b64_tr_b16 v[108:109], v231 offset:28672
    ds_read_b64_tr_b16 v[110:111], v231 offset:29184
    v_mfma_f32_16x16x32_bf16 v[204:207], v[84:87], v[68:71], v[204:207]
    v_add_u32 v176, s58, v224
    v_add_u32 v177, s58, v225
    s_waitcnt lgkmcnt(12)
    v_mfma_f32_16x16x32_bf16 v[208:211], v[88:91], v[64:67], v[208:211]
    v_add_u32 v178, s59, v226
    v_add_u32 v179, s59, v227
    v_mfma_f32_16x16x32_bf16 v[212:215], v[88:91], v[68:71], v[212:215]
    s_waitcnt lgkmcnt(10)
    v_mfma_f32_16x16x32_bf16 v[216:219], v[92:95], v[64:67], v[216:219]
    v_mfma_f32_16x16x32_bf16 v[220:223], v[92:95], v[68:71], v[220:223]
    s_waitcnt lgkmcnt(6)
    v_mfma_f32_16x16x32_bf16 v[192:195], v[96:99], v[72:75], v[192:195]
    v_mfma_f32_16x16x32_bf16 v[196:199], v[96:99], v[76:79], v[196:199]
    s_waitcnt lgkmcnt(0)
    s_barrier
    ds_read_b128 v[16:19], v176
    ds_read_b128 v[20:23], v178
    v_mfma_f32_16x16x32_bf16 v[200:203], v[100:103], v[72:75], v[200:203]
    s_add_u32 s97, s97, 2048
    ds_read_b64_tr_b16 v[32:33], v228 offset:49152
    ds_read_b64_tr_b16 v[34:35], v228 offset:49664
    v_mfma_f32_16x16x32_bf16 v[204:207], v[100:103], v[76:79], v[204:207]
    s_and_b32 s97, s97, 32767
    ds_read_b64_tr_b16 v[36:37], v229 offset:49152
    ds_read_b64_tr_b16 v[38:39], v229 offset:49664
    v_mfma_f32_16x16x32_bf16 v[208:211], v[104:107], v[72:75], v[208:211]
    s_cmp_eq_u32 s96, 0
    ds_read_b64_tr_b16 v[40:41], v230 offset:49152
    ds_read_b64_tr_b16 v[42:43], v230 offset:49664
    v_mfma_f32_16x16x32_bf16 v[212:215], v[104:107], v[76:79], v[212:215]
    s_cselect_b32 s58, s97, 114688
    ds_read_b64_tr_b16 v[44:45], v231 offset:49152
    ds_read_b64_tr_b16 v[46:47], v231 offset:49664
    v_mfma_f32_16x16x32_bf16 v[216:219], v[108:111], v[72:75], v[216:219]
    s_cmp_eq_u32 s96, 1
    ds_read_b128 v[24:27], v177
    ds_read_b128 v[28:31], v179
    v_mfma_f32_16x16x32_bf16 v[220:223], v[108:111], v[76:79], v[220:223]
    s_cselect_b32 s59, s97, 114688
    ds_read_b64_tr_b16 v[48:49], v228 offset:53248
    ds_read_b64_tr_b16 v[50:51], v228 offset:53760
    s_waitcnt lgkmcnt(10)
    v_mfma_f32_16x16x32_bf16 v[192:195], v[32:35], v[16:19], v[192:195]
    ds_read_b64_tr_b16 v[52:53], v229 offset:53248
    ds_read_b64_tr_b16 v[54:55], v229 offset:53760
    v_mfma_f32_16x16x32_bf16 v[196:199], v[32:35], v[20:23], v[196:199]
    ds_read_b64_tr_b16 v[56:57], v230 offset:53248
    ds_read_b64_tr_b16 v[58:59], v230 offset:53760
    s_waitcnt lgkmcnt(12)
    v_mfma_f32_16x16x32_bf16 v[200:203], v[36:39], v[16:19], v[200:203]
    ds_read_b64_tr_b16 v[60:61], v231 offset:53248
    ds_read_b64_tr_b16 v[62:63], v231 offset:53760
    v_mfma_f32_16x16x32_bf16 v[204:207], v[36:39], v[20:23], v[204:207]
    v_add_u32 v176, s58, v224
    v_add_u32 v177, s58, v225
    s_waitcnt lgkmcnt(12)
    v_mfma_f32_16x16x32_bf16 v[208:211], v[40:43], v[16:19], v[208:211]
    v_add_u32 v178, s59, v226
    v_add_u32 v179, s59, v227
    v_mfma_f32_16x16x32_bf16 v[212:215], v[40:43], v[20:23], v[212:215]
    s_waitcnt lgkmcnt(10)
    v_mfma_f32_16x16x32_bf16 v[216:219], v[44:47], v[16:19], v[216:219]
    v_mfma_f32_16x16x32_bf16 v[220:223], v[44:47], v[20:23], v[220:223]
    s_waitcnt lgkmcnt(6)
    v_mfma_f32_16x16x32_bf16 v[192:195], v[48:51], v[24:27], v[192:195]
    v_mfma_f32_16x16x32_bf16 v[196:199], v[48:51], v[28:31], v[196:199]
    s_waitcnt lgkmcnt(0)
    s_barrier
    ds_read_b128 v[64:67], v176
    ds_read_b128 v[68:71], v178
    v_mfma_f32_16x16x32_bf16 v[200:203], v[52:55], v[24:27], v[200:203]
    s_add_u32 s97, s97, 2048
    ds_read_b64_tr_b16 v[80:81], v232 offset:0
    ds_read_b64_tr_b16 v[82:83], v232 offset:512
    v_mfma_f32_16x16x32_bf16 v[204:207], v[52:55], v[28:31], v[204:207]
    s_and_b32 s97, s97, 32767
    ds_read_b64_tr_b16 v[84:85], v233 offset:0
    ds_read_b64_tr_b16 v[86:87], v233 offset:512
    v_mfma_f32_16x16x32_bf16 v[208:211], v[56:59], v[24:27], v[208:211]
    s_cmp_eq_u32 s96, 0
    ds_read_b64_tr_b16 v[88:89], v234 offset:0
    ds_read_b64_tr_b16 v[90:91], v234 offset:512
    v_mfma_f32_16x16x32_bf16 v[212:215], v[56:59], v[28:31], v[212:215]
    s_cselect_b32 s58, s97, 139264
    ds_read_b64_tr_b16 v[92:93], v235 offset:0
    ds_read_b64_tr_b16 v[94:95], v235 offset:512
    v_mfma_f32_16x16x32_bf16 v[216:219], v[60:63], v[24:27], v[216:219]
    s_cmp_eq_u32 s96, 1
    ds_read_b128 v[72:75], v177
    ds_read_b128 v[76:79], v179
    v_mfma_f32_16x16x32_bf16 v[220:223], v[60:63], v[28:31], v[220:223]
    s_cselect_b32 s59, s97, 139264
    ds_read_b64_tr_b16 v[96:97], v232 offset:4096
    ds_read_b64_tr_b16 v[98:99], v232 offset:4608
    s_waitcnt lgkmcnt(10)
    v_mfma_f32_16x16x32_bf16 v[192:195], v[80:83], v[64:67], v[192:195]
    ds_read_b64_tr_b16 v[100:101], v233 offset:4096
    ds_read_b64_tr_b16 v[102:103], v233 offset:4608
    v_mfma_f32_16x16x32_bf16 v[196:199], v[80:83], v[68:71], v[196:199]
    ds_read_b64_tr_b16 v[104:105], v234 offset:4096
    ds_read_b64_tr_b16 v[106:107], v234 offset:4608
    s_waitcnt lgkmcnt(12)
    v_mfma_f32_16x16x32_bf16 v[200:203], v[84:87], v[64:67], v[200:203]
    ds_read_b64_tr_b16 v[108:109], v235 offset:4096
    ds_read_b64_tr_b16 v[110:111], v235 offset:4608
    v_mfma_f32_16x16x32_bf16 v[204:207], v[84:87], v[68:71], v[204:207]
    v_add_u32 v176, s58, v224
    v_add_u32 v177, s58, v225
    s_waitcnt lgkmcnt(12)
    v_mfma_f32_16x16x32_bf16 v[208:211], v[88:91], v[64:67], v[208:211]
    v_add_u32 v178, s59, v226
    v_add_u32 v179, s59, v227
    v_mfma_f32_16x16x32_bf16 v[212:215], v[88:91], v[68:71], v[212:215]
    s_waitcnt lgkmcnt(10)
    v_mfma_f32_16x16x32_bf16 v[216:219], v[92:95], v[64:67], v[216:219]
    v_mfma_f32_16x16x32_bf16 v[220:223], v[92:95], v[68:71], v[220:223]
    s_waitcnt lgkmcnt(6)
    v_mfma_f32_16x16x32_bf16 v[192:195], v[96:99], v[72:75], v[192:195]
    v_mfma_f32_16x16x32_bf16 v[196:199], v[96:99], v[76:79], v[196:199]
    s_waitcnt lgkmcnt(0)
    s_barrier
    ds_read_b128 v[16:19], v176
    ds_read_b128 v[20:23], v178
    v_mfma_f32_16x16x32_bf16 v[200:203], v[100:103], v[72:75], v[200:203]
    s_add_u32 s97, s97, 2048
    ds_read_b64_tr_b16 v[32:33], v232 offset:24576
    ds_read_b64_tr_b16 v[34:35], v232 offset:25088
    v_mfma_f32_16x16x32_bf16 v[204:207], v[100:103], v[76:79], v[204:207]
    s_and_b32 s97, s97, 32767
    ds_read_b64_tr_b16 v[36:37], v233 offset:24576
    ds_read_b64_tr_b16 v[38:39], v233 offset:25088
    v_mfma_f32_16x16x32_bf16 v[208:211], v[104:107], v[72:75], v[208:211]
    s_cmp_eq_u32 s96, 0
    ds_read_b64_tr_b16 v[40:41], v234 offset:24576
    ds_read_b64_tr_b16 v[42:43], v234 offset:25088
    v_mfma_f32_16x16x32_bf16 v[212:215], v[104:107], v[76:79], v[212:215]
    s_cselect_b32 s58, s97, 40960
    ds_read_b64_tr_b16 v[44:45], v235 offset:24576
    ds_read_b64_tr_b16 v[46:47], v235 offset:25088
    v_mfma_f32_16x16x32_bf16 v[216:219], v[108:111], v[72:75], v[216:219]
    s_cmp_eq_u32 s96, 1
    ds_read_b128 v[24:27], v177
    ds_read_b128 v[28:31], v179
    v_mfma_f32_16x16x32_bf16 v[220:223], v[108:111], v[76:79], v[220:223]
    s_cselect_b32 s59, s97, 40960
    ds_read_b64_tr_b16 v[48:49], v232 offset:28672
    ds_read_b64_tr_b16 v[50:51], v232 offset:29184
    s_waitcnt lgkmcnt(10)
    v_mfma_f32_16x16x32_bf16 v[192:195], v[32:35], v[16:19], v[192:195]
    ds_read_b64_tr_b16 v[52:53], v233 offset:28672
    ds_read_b64_tr_b16 v[54:55], v233 offset:29184
    v_mfma_f32_16x16x32_bf16 v[196:199], v[32:35], v[20:23], v[196:199]
    ds_read_b64_tr_b16 v[56:57], v234 offset:28672
    ds_read_b64_tr_b16 v[58:59], v234 offset:29184
    s_waitcnt lgkmcnt(12)
    v_mfma_f32_16x16x32_bf16 v[200:203], v[36:39], v[16:19], v[200:203]
    ds_read_b64_tr_b16 v[60:61], v235 offset:28672
    ds_read_b64_tr_b16 v[62:63], v235 offset:29184
    v_mfma_f32_16x16x32_bf16 v[204:207], v[36:39], v[20:23], v[204:207]
    v_add_u32 v176, s58, v224
    v_add_u32 v177, s58, v225
    s_waitcnt lgkmcnt(12)
    v_mfma_f32_16x16x32_bf16 v[208:211], v[40:43], v[16:19], v[208:211]
    v_add_u32 v178, s59, v226
    v_add_u32 v179, s59, v227
    v_mfma_f32_16x16x32_bf16 v[212:215], v[40:43], v[20:23], v[212:215]
    s_waitcnt lgkmcnt(10)
    v_mfma_f32_16x16x32_bf16 v[216:219], v[44:47], v[16:19], v[216:219]
    v_mfma_f32_16x16x32_bf16 v[220:223], v[44:47], v[20:23], v[220:223]
    s_waitcnt lgkmcnt(6)
    v_mfma_f32_16x16x32_bf16 v[192:195], v[48:51], v[24:27], v[192:195]
    v_mfma_f32_16x16x32_bf16 v[196:199], v[48:51], v[28:31], v[196:199]
    s_waitcnt lgkmcnt(0)
    s_barrier
    ds_read_b128 v[64:67], v176
    ds_read_b128 v[68:71], v178
    v_mfma_f32_16x16x32_bf16 v[200:203], v[52:55], v[24:27], v[200:203]
    s_add_u32 s97, s97, 2048
    ds_read_b64_tr_b16 v[80:81], v228 offset:0
    ds_read_b64_tr_b16 v[82:83], v228 offset:512
    v_mfma_f32_16x16x32_bf16 v[204:207], v[52:55], v[28:31], v[204:207]
    s_and_b32 s97, s97, 32767
    ds_read_b64_tr_b16 v[84:85], v229 offset:0
    ds_read_b64_tr_b16 v[86:87], v229 offset:512
    v_mfma_f32_16x16x32_bf16 v[208:211], v[56:59], v[24:27], v[208:211]
    s_cmp_eq_u32 s96, 0
    ds_read_b64_tr_b16 v[88:89], v230 offset:0
    ds_read_b64_tr_b16 v[90:91], v230 offset:512
    v_mfma_f32_16x16x32_bf16 v[212:215], v[56:59], v[28:31], v[212:215]
    s_cselect_b32 s58, s97, 65536
    ds_read_b64_tr_b16 v[92:93], v231 offset:0
    ds_read_b64_tr_b16 v[94:95], v231 offset:512
    v_mfma_f32_16x16x32_bf16 v[216:219], v[60:63], v[24:27], v[216:219]
    s_cmp_eq_u32 s96, 1
    ds_read_b128 v[72:75], v177
    ds_read_b128 v[76:79], v179
    v_mfma_f32_16x16x32_bf16 v[220:223], v[60:63], v[28:31], v[220:223]
    s_cselect_b32 s59, s97, 65536
    ds_read_b64_tr_b16 v[96:97], v228 offset:4096
    ds_read_b64_tr_b16 v[98:99], v228 offset:4608
    s_waitcnt lgkmcnt(10)
    v_mfma_f32_16x16x32_bf16 v[192:195], v[80:83], v[64:67], v[192:195]
    ds_read_b64_tr_b16 v[100:101], v229 offset:4096
    ds_read_b64_tr_b16 v[102:103], v229 offset:4608
    v_mfma_f32_16x16x32_bf16 v[196:199], v[80:83], v[68:71], v[196:199]
    ds_read_b64_tr_b16 v[104:105], v230 offset:4096
    ds_read_b64_tr_b16 v[106:107], v230 offset:4608
    s_waitcnt lgkmcnt(12)
    v_mfma_f32_16x16x32_bf16 v[200:203], v[84:87], v[64:67], v[200:203]
    ds_read_b64_tr_b16 v[108:109], v231 offset:4096
    ds_read_b64_tr_b16 v[110:111], v231 offset:4608
    v_mfma_f32_16x16x32_bf16 v[204:207], v[84:87], v[68:71], v[204:207]
    v_add_u32 v176, s58, v224
    v_add_u32 v177, s58, v225
    s_waitcnt lgkmcnt(12)
    v_mfma_f32_16x16x32_bf16 v[208:211], v[88:91], v[64:67], v[208:211]
    v_add_u32 v178, s59, v226
    v_add_u32 v179, s59, v227
    v_mfma_f32_16x16x32_bf16 v[212:215], v[88:91], v[68:71], v[212:215]
    s_waitcnt lgkmcnt(10)
    v_mfma_f32_16x16x32_bf16 v[216:219], v[92:95], v[64:67], v[216:219]
    v_mfma_f32_16x16x32_bf16 v[220:223], v[92:95], v[68:71], v[220:223]
    s_waitcnt lgkmcnt(6)
    v_mfma_f32_16x16x32_bf16 v[192:195], v[96:99], v[72:75], v[192:195]
    v_mfma_f32_16x16x32_bf16 v[196:199], v[96:99], v[76:79], v[196:199]
    s_waitcnt lgkmcnt(0)
    s_barrier
    ds_read_b128 v[16:19], v176
    ds_read_b128 v[20:23], v178
    v_mfma_f32_16x16x32_bf16 v[200:203], v[100:103], v[72:75], v[200:203]
    s_add_u32 s97, s97, 2048
    ds_read_b64_tr_b16 v[32:33], v228 offset:24576
    ds_read_b64_tr_b16 v[34:35], v228 offset:25088
    v_mfma_f32_16x16x32_bf16 v[204:207], v[100:103], v[76:79], v[204:207]
    s_and_b32 s97, s97, 32767
    ds_read_b64_tr_b16 v[36:37], v229 offset:24576
    ds_read_b64_tr_b16 v[38:39], v229 offset:25088
    v_mfma_f32_16x16x32_bf16 v[208:211], v[104:107], v[72:75], v[208:211]
    s_cmp_eq_u32 s96, 0
    ds_read_b64_tr_b16 v[40:41], v230 offset:24576
    ds_read_b64_tr_b16 v[42:43], v230 offset:25088
    v_mfma_f32_16x16x32_bf16 v[212:215], v[104:107], v[76:79], v[212:215]
    s_cselect_b32 s58, s97, 90112
    ds_read_b64_tr_b16 v[44:45], v231 offset:24576
    ds_read_b64_tr_b16 v[46:47], v231 offset:25088
    v_mfma_f32_16x16x32_bf16 v[216:219], v[108:111], v[72:75], v[216:219]
    s_cmp_eq_u32 s96, 1
    ds_read_b128 v[24:27], v177
    ds_read_b128 v[28:31], v179
    v_mfma_f32_16x16x32_bf16 v[220:223], v[108:111], v[76:79], v[220:223]
    s_cselect_b32 s59, s97, 90112
    ds_read_b64_tr_b16 v[48:49], v228 offset:28672
    ds_read_b64_tr_b16 v[50:51], v228 offset:29184
    s_waitcnt lgkmcnt(10)
    v_mfma_f32_16x16x32_bf16 v[192:195], v[32:35], v[16:19], v[192:195]
    ds_read_b64_tr_b16 v[52:53], v229 offset:28672
    ds_read_b64_tr_b16 v[54:55], v229 offset:29184
    v_mfma_f32_16x16x32_bf16 v[196:199], v[32:35], v[20:23], v[196:199]
    ds_read_b64_tr_b16 v[56:57], v230 offset:28672
    ds_read_b64_tr_b16 v[58:59], v230 offset:29184
    s_waitcnt lgkmcnt(12)
    v_mfma_f32_16x16x32_bf16 v[200:203], v[36:39], v[16:19], v[200:203]
    ds_read_b64_tr_b16 v[60:61], v231 offset:28672
    ds_read_b64_tr_b16 v[62:63], v231 offset:29184
    v_mfma_f32_16x16x32_bf16 v[204:207], v[36:39], v[20:23], v[204:207]
    v_add_u32 v176, s58, v224
    v_add_u32 v177, s58, v225
    s_waitcnt lgkmcnt(12)
    v_mfma_f32_16x16x32_bf16 v[208:211], v[40:43], v[16:19], v[208:211]
    v_add_u32 v178, s59, v226
    v_add_u32 v179, s59, v227
    v_mfma_f32_16x16x32_bf16 v[212:215], v[40:43], v[20:23], v[212:215]
    s_waitcnt lgkmcnt(10)
    v_mfma_f32_16x16x32_bf16 v[216:219], v[44:47], v[16:19], v[216:219]
    v_mfma_f32_16x16x32_bf16 v[220:223], v[44:47], v[20:23], v[220:223]
    s_waitcnt lgkmcnt(6)
    v_mfma_f32_16x16x32_bf16 v[192:195], v[48:51], v[24:27], v[192:195]
    v_mfma_f32_16x16x32_bf16 v[196:199], v[48:51], v[28:31], v[196:199]
    s_waitcnt lgkmcnt(0)
    s_barrier
    ds_read_b128 v[64:67], v176
    ds_read_b128 v[68:71], v178
    v_mfma_f32_16x16x32_bf16 v[200:203], v[52:55], v[24:27], v[200:203]
    s_add_u32 s97, s97, 2048
    ds_read_b64_tr_b16 v[80:81], v228 offset:49152
    ds_read_b64_tr_b16 v[82:83], v228 offset:49664
    v_mfma_f32_16x16x32_bf16 v[204:207], v[52:55], v[28:31], v[204:207]
    s_and_b32 s97, s97, 32767
    ds_read_b64_tr_b16 v[84:85], v229 offset:49152
    ds_read_b64_tr_b16 v[86:87], v229 offset:49664
    v_mfma_f32_16x16x32_bf16 v[208:211], v[56:59], v[24:27], v[208:211]
    s_cmp_eq_u32 s96, 0
    ds_read_b64_tr_b16 v[88:89], v230 offset:49152
    ds_read_b64_tr_b16 v[90:91], v230 offset:49664
    v_mfma_f32_16x16x32_bf16 v[212:215], v[56:59], v[28:31], v[212:215]
    s_cselect_b32 s58, s97, 114688
    ds_read_b64_tr_b16 v[92:93], v231 offset:49152
    ds_read_b64_tr_b16 v[94:95], v231 offset:49664
    v_mfma_f32_16x16x32_bf16 v[216:219], v[60:63], v[24:27], v[216:219]
    s_cmp_eq_u32 s96, 1
    ds_read_b128 v[72:75], v177
    ds_read_b128 v[76:79], v179
    v_mfma_f32_16x16x32_bf16 v[220:223], v[60:63], v[28:31], v[220:223]
    s_cselect_b32 s59, s97, 114688
    ds_read_b64_tr_b16 v[96:97], v228 offset:53248
    ds_read_b64_tr_b16 v[98:99], v228 offset:53760
    s_waitcnt lgkmcnt(10)
    v_mfma_f32_16x16x32_bf16 v[192:195], v[80:83], v[64:67], v[192:195]
    ds_read_b64_tr_b16 v[100:101], v229 offset:53248
    ds_read_b64_tr_b16 v[102:103], v229 offset:53760
    v_mfma_f32_16x16x32_bf16 v[196:199], v[80:83], v[68:71], v[196:199]
    ds_read_b64_tr_b16 v[104:105], v230 offset:53248
    ds_read_b64_tr_b16 v[106:107], v230 offset:53760
    s_waitcnt lgkmcnt(12)
    v_mfma_f32_16x16x32_bf16 v[200:203], v[84:87], v[64:67], v[200:203]
    ds_read_b64_tr_b16 v[108:109], v231 offset:53248
    ds_read_b64_tr_b16 v[110:111], v231 offset:53760
    v_mfma_f32_16x16x32_bf16 v[204:207], v[84:87], v[68:71], v[204:207]
    v_add_u32 v176, s58, v224
    v_add_u32 v177, s58, v225
    s_waitcnt lgkmcnt(12)
    v_mfma_f32_16x16x32_bf16 v[208:211], v[88:91], v[64:67], v[208:211]
    v_add_u32 v178, s59, v226
    v_add_u32 v179, s59, v227
    v_mfma_f32_16x16x32_bf16 v[212:215], v[88:91], v[68:71], v[212:215]
    s_waitcnt lgkmcnt(10)
    v_mfma_f32_16x16x32_bf16 v[216:219], v[92:95], v[64:67], v[216:219]
    v_mfma_f32_16x16x32_bf16 v[220:223], v[92:95], v[68:71], v[220:223]
    s_waitcnt lgkmcnt(6)
    v_mfma_f32_16x16x32_bf16 v[192:195], v[96:99], v[72:75], v[192:195]
    v_mfma_f32_16x16x32_bf16 v[196:199], v[96:99], v[76:79], v[196:199]
    s_cmp_lg_u32 s48, 0
    s_cbranch_scc1 L_nf11
    buffer_load_dword v14, v186, s[40:43], 0 offen sc1
L_nf11:
    s_waitcnt lgkmcnt(0)
    s_barrier
    ds_read_b128 v[16:19], v176
    ds_read_b128 v[20:23], v178
    v_mfma_f32_16x16x32_bf16 v[200:203], v[100:103], v[72:75], v[200:203]
    s_add_u32 s97, s97, 2048
    ds_read_b64_tr_b16 v[32:33], v232 offset:0
    ds_read_b64_tr_b16 v[34:35], v232 offset:512
    v_mfma_f32_16x16x32_bf16 v[204:207], v[100:103], v[76:79], v[204:207]
    s_and_b32 s97, s97, 32767
    ds_read_b64_tr_b16 v[36:37], v233 offset:0
    ds_read_b64_tr_b16 v[38:39], v233 offset:512
    v_mfma_f32_16x16x32_bf16 v[208:211], v[104:107], v[72:75], v[208:211]
    s_cmp_eq_u32 s96, 0
    ds_read_b64_tr_b16 v[40:41], v234 offset:0
    ds_read_b64_tr_b16 v[42:43], v234 offset:512
    v_mfma_f32_16x16x32_bf16 v[212:215], v[104:107], v[76:79], v[212:215]
    s_cselect_b32 s58, s97, 139264
    ds_read_b64_tr_b16 v[44:45], v235 offset:0
    ds_read_b64_tr_b16 v[46:47], v235 offset:512
    v_mfma_f32_16x16x32_bf16 v[216:219], v[108:111], v[72:75], v[216:219]
    s_cmp_eq_u32 s96, 1
    ds_read_b128 v[24:27], v177
    ds_read_b128 v[28:31], v179
    v_mfma_f32_16x16x32_bf16 v[220:223], v[108:111], v[76:79], v[220:223]
    s_cselect_b32 s59, s97, 139264
    ds_read_b64_tr_b16 v[48:49], v232 offset:4096
    ds_read_b64_tr_b16 v[50:51], v232 offset:4608
    s_waitcnt lgkmcnt(10)
    v_mfma_f32_16x16x32_bf16 v[192:195], v[32:35], v[16:19], v[192:195]
    ds_read_b64_tr_b16 v[52:53], v233 offset:4096
    ds_read_b64_tr_b16 v[54:55], v233 offset:4608
    v_mfma_f32_16x16x32_bf16 v[196:199], v[32:35], v[20:23], v[196:199]
    ds_read_b64_tr_b16 v[56:57], v234 offset:4096
    ds_read_b64_tr_b16 v[58:59], v234 offset:4608
    s_waitcnt lgkmcnt(12)
    v_mfma_f32_16x16x32_bf16 v[200:203], v[36:39], v[16:19], v[200:203]
    ds_read_b64_tr_b16 v[60:61], v235 offset:4096
    ds_read_b64_tr_b16 v[62:63], v235 offset:4608
    v_mfma_f32_16x16x32_bf16 v[204:207], v[36:39], v[20:23], v[204:207]
    v_add_u32 v176, s58, v224
    v_add_u32 v177, s58, v225
    s_waitcnt lgkmcnt(12)
    v_mfma_f32_16x16x32_bf16 v[208:211], v[40:43], v[16:19], v[208:211]
    v_add_u32 v178, s59, v226
    v_add_u32 v179, s59, v227
    v_mfma_f32_16x16x32_bf16 v[212:215], v[40:43], v[20:23], v[212:215]
    s_waitcnt lgkmcnt(10)
    v_mfma_f32_16x16x32_bf16 v[216:219], v[44:47], v[16:19], v[216:219]
    v_mfma_f32_16x16x32_bf16 v[220:223], v[44:47], v[20:23], v[220:223]
    s_waitcnt lgkmcnt(6)
    v_mfma_f32_16x16x32_bf16 v[192:195], v[48:51], v[24:27], v[192:195]
    v_mfma_f32_16x16x32_bf16 v[196:199], v[48:51], v[28:31], v[196:199]
    s_cmp_lg_u32 s48, 0
    s_cbranch_scc1 L_spun
    s_waitcnt vmcnt(0)
    v_cmp_gt_u32 vcc, 4, v14
    s_cbranch_vccnz L_spin
L_spun:
    s_waitcnt lgkmcnt(0)
    s_barrier
    ds_read_b128 v[64:67], v176
    ds_read_b128 v[68:71], v178
    v_mfma_f32_16x16x32_bf16 v[200:203], v[52:55], v[24:27], v[200:203]
    s_add_u32 s97, s97, 2048
    ds_read_b64_tr_b16 v[80:81], v232 offset:24576
    ds_read_b64_tr_b16 v[82:83], v232 offset:25088
    v_mfma_f32_16x16x32_bf16 v[204:207], v[52:55], v[28:31], v[204:207]
    s_and_b32 s97, s97, 32767
    ds_read_b64_tr_b16 v[84:85], v233 offset:24576
    ds_read_b64_tr_b16 v[86:87], v233 offset:25088
    v_mfma_f32_16x16x32_bf16 v[208:211], v[56:59], v[24:27], v[208:211]
    s_cmp_eq_u32 s96, 0
    ds_read_b64_tr_b16 v[88:89], v234 offset:24576
    ds_read_b64_tr_b16 v[90:91], v234 offset:25088
    v_mfma_f32_16x16x32_bf16 v[212:215], v[56:59], v[28:31], v[212:215]
    s_cselect_b32 s58, s97, 40960
    ds_read_b64_tr_b16 v[92:93], v235 offset:24576
    ds_read_b64_tr_b16 v[94:95], v235 offset:25088
    v_mfma_f32_16x16x32_bf16 v[216:219], v[60:63], v[24:27], v[216:219]
    s_cmp_eq_u32 s96, 1
    ds_read_b128 v[72:75], v177
    ds_read_b128 v[76:79], v179
    v_mfma_f32_16x16x32_bf16 v[220:223], v[60:63], v[28:31], v[220:223]
    s_cselect_b32 s59, s97, 40960
    ds_read_b64_tr_b16 v[96:97], v232 offset:28672
    ds_read_b64_tr_b16 v[98:99], v232 offset:29184
    s_waitcnt lgkmcnt(10)
    v_mfma_f32_16x16x32_bf16 v[192:195], v[80:83], v[64:67], v[192:195]
    ds_read_b64_tr_b16 v[100:101], v233 offset:28672
    ds_read_b64_tr_b16 v[102:103], v233 offset:29184
    v_mfma_f32_16x16x32_bf16 v[196:199], v[80:83], v[68:71], v[196:199]
    ds_read_b64_tr_b16 v[104:105], v234 offset:28672
    ds_read_b64_tr_b16 v[106:107], v234 offset:29184
    s_waitcnt lgkmcnt(12)
    v_mfma_f32_16x16x32_bf16 v[200:203], v[84:87], v[64:67], v[200:203]
    ds_read_b64_tr_b16 v[108:109], v235 offset:28672
    ds_read_b64_tr_b16 v[110:111], v235 offset:29184
    v_mfma_f32_16x16x32_bf16 v[204:207], v[84:87], v[68:71], v[204:207]
    v_add_u32 v176, s58, v224
    v_add_u32 v177, s58, v225
    s_waitcnt lgkmcnt(12)
    v_mfma_f32_16x16x32_bf16 v[208:211], v[88:91], v[64:67], v[208:211]
    v_add_u32 v178, s59, v226
    v_add_u32 v179, s59, v227
    v_mfma_f32_16x16x32_bf16 v[212:215], v[88:91], v[68:71], v[212:215]
    s_waitcnt lgkmcnt(10)
    v_mfma_f32_16x16x32_bf16 v[216:219], v[92:95], v[64:67], v[216:219]
    v_mfma_f32_16x16x32_bf16 v[220:223], v[92:95], v[68:71], v[220:223]
    s_waitcnt lgkmcnt(6)
    v_mfma_f32_16x16x32_bf16 v[192:195], v[96:99], v[72:75], v[192:195]
    v_mfma_f32_16x16x32_bf16 v[196:199], v[96:99], v[76:79], v[196:199]
    s_waitcnt lgkmcnt(0)
    s_barrier
    ds_read_b128 v[16:19], v176
    ds_read_b128 v[20:23], v178
    v_mfma_f32_16x16x32_bf16 v[200:203], v[100:103], v[72:75], v[200:203]
    s_add_u32 s97, s97, 2048
    ds_read_b64_tr_b16 v[32:33], v228 offset:0
    ds_read_b64_tr_b16 v[34:35], v228 offset:512
    v_mfma_f32_16x16x32_bf16 v[204:207], v[100:103], v[76:79], v[204:207]
    s_and_b32 s97, s97, 32767
    ds_read_b64_tr_b16 v[36:37], v229 offset:0
    ds_read_b64_tr_b16 v[38:39], v229 offset:512
    v_mfma_f32_16x16x32_bf16 v[208:211], v[104:107], v[72:75], v[208:211]
    s_cmp_eq_u32 s96, 0
    ds_read_b64_tr_b16 v[40:41], v230 offset:0
    ds_read_b64_tr_b16 v[42:43], v230 offset:512
    v_mfma_f32_16x16x32_bf16 v[212:215], v[104:107], v[76:79], v[212:215]
    s_cselect_b32 s58, s97, 65536
    ds_read_b64_tr_b16 v[44:45], v231 offset:0
    ds_read_b64_tr_b16 v[46:47], v231 offset:512
    v_mfma_f32_16x16x32_bf16 v[216:219], v[108:111], v[72:75], v[216:219]
    s_cmp_eq_u32 s96, 1
    ds_read_b128 v[24:27], v177
    ds_read_b128 v[28:31], v179
    v_mfma_f32_16x16x32_bf16 v[220:223], v[108:111], v[76:79], v[220:223]
    s_cselect_b32 s59, s97, 65536
    ds_read_b64_tr_b16 v[48:49], v228 offset:4096
    ds_read_b64_tr_b16 v[50:51], v228 offset:4608
    s_waitcnt lgkmcnt(10)
    v_mfma_f32_16x16x32_bf16 v[192:195], v[32:35], v[16:19], v[192:195]
    ds_read_b64_tr_b16 v[52:53], v229 offset:4096
    ds_read_b64_tr_b16 v[54:55], v229 offset:4608
    v_mfma_f32_16x16x32_bf16 v[196:199], v[32:35], v[20:23], v[196:199]
    ds_read_b64_tr_b16 v[56:57], v230 offset:4096
    ds_read_b64_tr_b16 v[58:59], v230 offset:4608
    s_waitcnt lgkmcnt(12)
    v_mfma_f32_16x16x32_bf16 v[200:203], v[36:39], v[16:19], v[200:203]
    ds_read_b64_tr_b16 v[60:61], v231 offset:4096
    ds_read_b64_tr_b16 v[62:63], v231 offset:4608
    v_mfma_f32_16x16x32_bf16 v[204:207], v[36:39], v[20:23], v[204:207]
    v_add_u32 v176, s58, v224
    v_add_u32 v177, s58, v225
    s_waitcnt lgkmcnt(12)
    v_mfma_f32_16x16x32_bf16 v[208:211], v[40:43], v[16:19], v[208:211]
    v_add_u32 v178, s59, v226
    v_add_u32 v179, s59, v227
    v_mfma_f32_16x16x32_bf16 v[212:215], v[40:43], v[20:23], v[212:215]
    s_waitcnt lgkmcnt(10)
    v_mfma_f32_16x16x32_bf16 v[216:219], v[44:47], v[16:19], v[216:219]
    v_mfma_f32_16x16x32_bf16 v[220:223], v[44:47], v[20:23], v[220:223]
    s_waitcnt lgkmcnt(6)
    v_mfma_f32_16x16x32_bf16 v[192:195], v[48:51], v[24:27], v[192:195]
    v_mfma_f32_16x16x32_bf16 v[196:199], v[48:51], v[28:31], v[196:199]
    s_waitcnt lgkmcnt(0)
    s_barrier
    ds_read_b128 v[64:67], v176
    ds_read_b128 v[68:71], v178
    v_mfma_f32_16x16x32_bf16 v[200:203], v[52:55], v[24:27], v[200:203]
    ds_read_b64_tr_b16 v[80:81], v228 offset:24576
    ds_read_b64_tr_b16 v[82:83], v228 offset:25088
    v_mfma_f32_16x16x32_bf16 v[204:207], v[52:55], v[28:31], v[204:207]
    ds_read_b64_tr_b16 v[84:85], v229 offset:24576
    ds_read_b64_tr_b16 v[86:87], v229 offset:25088
    v_mfma_f32_16x16x32_bf16 v[208:211], v[56:59], v[24:27], v[208:211]
L_pg1:
    s_cbranch_execz L_pgret
    ds_read_b64_tr_b16 v[88:89], v230 offset:24576
    ds_read_b64_tr_b16 v[90:91], v230 offset:25088
    v_mfma_f32_16x16x32_bf16 v[212:215], v[56:59], v[28:31], v[212:215]
    ds_read_b64_tr_b16 v[92:93], v231 offset:24576
    ds_read_b64_tr_b16 v[94:95], v231 offset:25088
    v_mfma_f32_16x16x32_bf16 v[216:219], v[60:63], v[24:27], v[216:219]
    ds_read_b128 v[72:75], v177
    ds_read_b128 v[76:79], v179
    v_mfma_f32_16x16x32_bf16 v[220:223], v[60:63], v[28:31], v[220:223]
    ds_read_b64_tr_b16 v[96:97], v228 offset:28672
    ds_read_b64_tr_b16 v[98:99], v228 offset:29184
    s_waitcnt lgkmcnt(10)
    v_mfma_f32_16x16x32_bf16 v[192:195], v[80:83], v[64:67], v[192:195]
    ds_read_b64_tr_b16 v[100:101], v229 offset:28672
    ds_read_b64_tr_b16 v[102:103], v229 offset:29184
    v_mfma_f32_16x16x32_bf16 v[196:199], v[80:83], v[68:71], v[196:199]
    ds_read_b64_tr_b16 v[104:105], v230 offset:28672
    ds_read_b64_tr_b16 v[106:107], v230 offset:29184
    s_waitcnt lgkmcnt(12)
    v_mfma_f32_16x16x32_bf16 v[200:203], v[84:87], v[64:67], v[200:203]
    ds_read_b64_tr_b16 v[108:109], v231 offset:28672
    ds_read_b64_tr_b16 v[110:111], v231 offset:29184
    v_mfma_f32_16x16x32_bf16 v[204:207], v[84:87], v[68:71], v[204:207]
    s_waitcnt lgkmcnt(12)
    v_mfma_f32_16x16x32_bf16 v[208:211], v[88:91], v[64:67], v[208:211]
    v_mfma_f32_16x16x32_bf16 v[212:215], v[88:91], v[68:71], v[212:215]
    s_waitcnt lgkmcnt(10)
    v_mfma_f32_16x16x32_bf16 v[216:219], v[92:95], v[64:67], v[216:219]
    v_mfma_f32_16x16x32_bf16 v[220:223], v[92:95], v[68:71], v[220:223]
    s_waitcnt lgkmcnt(6)
    v_mfma_f32_16x16x32_bf16 v[192:195], v[96:99], v[72:75], v[192:195]
    v_mfma_f32_16x16x32_bf16 v[196:199], v[96:99], v[76:79], v[196:199]
    s_waitcnt lgkmcnt(0)
    v_mfma_f32_16x16x32_bf16 v[200:203], v[100:103], v[72:75], v[200:203]
    v_mfma_f32_16x16x32_bf16 v[204:207], v[100:103], v[76:79], v[204:207]
    v_mfma_f32_16x16x32_bf16 v[208:211], v[104:107], v[72:75], v[208:211]
    v_mfma_f32_16x16x32_bf16 v[212:215], v[104:107], v[76:79], v[212:215]
    v_mfma_f32_16x16x32_bf16 v[216:219], v[108:111], v[72:75], v[216:219]
    v_mfma_f32_16x16x32_bf16 v[220:223], v[108:111], v[76:79], v[220:223]
    ds_read_b128 v[96:99], v134 offset:32768
    ds_read_b128 v[100:103], v134 offset:33792
    ds_read_b128 v[104:107], v134 offset:34816
    ds_read_b128 v[108:111], v134 offset:35840
    ds_read_b128 v[112:115], v134 offset:36864
    v_cvt_pk_bf16_f32 v80, v192, v193
    v_cvt_pk_bf16_f32 v81, v194, v195
    v_cvt_pk_bf16_f32 v82, v196, v197
    v_cvt_pk_bf16_f32 v83, v198, v199
    v_cvt_pk_bf16_f32 v84, v200, v201
    v_cvt_pk_bf16_f32 v85, v202, v203
    v_cvt_pk_bf16_f32 v86, v204, v205
    v_cvt_pk_bf16_f32 v87, v206, v207
    s_nop 0
    v_permlane16_swap_b32 v80, v82
    v_permlane16_swap_b32 v81, v83
    v_permlane16_swap_b32 v84, v86
    v_permlane16_swap_b32 v85, v87
    v_permlane32_swap_b32 v80, v82
    v_permlane32_swap_b32 v81, v83
    v_permlane32_swap_b32 v84, v86
    v_permlane32_swap_b32 v85, v87
    s_waitcnt lgkmcnt(3)
    s_nop 0
    v_mfma_f32_32x32x16_bf16 v[16:31], v[96:99], v[80:83], 0
    v_mfma_f32_32x32x16_bf16 v[16:31], v[100:103], v[84:87], v[16:31]
    v_cvt_pk_bf16_f32 v88, v208, v209
    v_cvt_pk_bf16_f32 v89, v210, v211
    v_cvt_pk_bf16_f32 v90, v212, v213
    v_cvt_pk_bf16_f32 v91, v214, v215
    v_cvt_pk_bf16_f32 v92, v216, v217
    v_cvt_pk_bf16_f32 v93, v218, v219
    v_cvt_pk_bf16_f32 v94, v220, v221
    v_cvt_pk_bf16_f32 v95, v222, v223
    s_nop 0
    v_permlane16_swap_b32 v88, v90
    v_permlane16_swap_b32 v89, v91
    v_permlane16_swap_b32 v92, v94
    v_permlane16_swap_b32 v93, v95
    v_permlane32_swap_b32 v88, v90
    v_permlane32_swap_b32 v89, v91
    v_permlane32_swap_b32 v92, v94
    v_permlane32_swap_b32 v93, v95
    s_nop 1
    v_mfma_f32_32x32x16_bf16 v[32:47], v[96:99], v[88:91], 0
    v_mfma_f32_32x32x16_bf16 v[32:47], v[100:103], v[92:95], v[32:47]
    v_max3_f32 v2, v16, v17, v18
    v_max3_f32 v2, v2, v19, v20
    v_max3_f32 v2, v2, v21, v22
    v_max3_f32 v2, v2, v23, v24
    v_max3_f32 v2, v2, v25, v26
    v_max3_f32 v2, v2, v27, v28
    v_max3_f32 v2, v2, v29, v30
    v_max_f32 v2, v2, v31
    v_mov_b32 v3, v2
    s_nop 1
    v_permlane32_swap_b32 v2, v3
    v_min_f32_e64 v48, -v2, -v3
    v_min_f32_e64 v49, -v2, -v3
    v_mov_b64 v[50:51], v[48:49]
    v_mov_b64 v[52:53], v[48:49]
    v_mov_b64 v[54:55], v[48:49]
    v_mov_b64 v[56:57], v[48:49]
    v_mov_b64 v[58:59], v[48:49]
    v_mov_b64 v[60:61], v[48:49]
    v_mov_b64 v[62:63], v[48:49]
    s_nop 1
    v_mfma_f32_32x32x16_bf16 v[16:31], v[96:99], v[80:83], v[48:63]
    v_mfma_f32_32x32x16_bf16 v[16:31], v[100:103], v[84:87], v[16:31]
    v_max3_f32 v4, v32, v33, v34
    v_max3_f32 v4, v4, v35, v36
    v_max3_f32 v4, v4, v37, v38
    v_max3_f32 v4, v4, v39, v40
    v_max3_f32 v4, v4, v41, v42
    v_max3_f32 v4, v4, v43, v44
    v_max3_f32 v4, v4, v45, v46
    v_max_f32 v4, v4, v47
    v_mov_b32 v5, v4
    s_nop 1
    v_permlane32_swap_b32 v4, v5
    v_min_f32_e64 v64, -v4, -v5
    v_min_f32_e64 v65, -v4, -v5
    v_mov_b64 v[66:67], v[64:65]
    v_mov_b64 v[68:69], v[64:65]
    v_mov_b64 v[70:71], v[64:65]
    v_mov_b64 v[72:73], v[64:65]
    v_mov_b64 v[74:75], v[64:65]
    v_mov_b64 v[76:77], v[64:65]
    v_mov_b64 v[78:79], v[64:65]
    s_mov_b32 s56, 0x76800000
    s_movk_i32 s57, 0x207
    s_mov_b32 s70, 0x35800000
    v_exp_f32 v16, v16
    v_exp_f32 v17, v17
    s_waitcnt lgkmcnt(1)
    v_exp_f32 v18, v18
    v_exp_f32 v19, v19
    v_exp_f32 v20, v20
    ds_read_b128 v[116:119], v134 offset:37888
    v_exp_f32 v21, v21
    v_exp_f32 v22, v22
    v_mfma_f32_32x32x16_bf16 v[32:47], v[96:99], v[88:91], v[64:79]
    v_exp_f32 v23, v23
    v_exp_f32 v24, v24
    v_exp_f32 v25, v25
    v_mfma_f32_32x32x16_bf16 v[32:47], v[100:103], v[92:95], v[32:47]
    s_nop 0
    v_exp_f32 v26, v26
    v_exp_f32 v27, v27
    v_exp_f32 v28, v28
    v_smfmac_f32_32x32x32_bf16 v[136:151], v[104:107], v[16:23], v132
    s_nop 1
    v_exp_f32 v29, v29
    v_exp_f32 v30, v30
    v_exp_f32 v31, v31
    v_smfmac_f32_16x16x64_bf16 v[168:171], v[128:131], v[16:23], v132
    ds_read_b128 v[120:123], v134 offset:38912
    v_exp_f32 v32, v32
    v_exp_f32 v33, v33
    v_smfmac_f32_32x32x32_bf16 v[136:151], v[108:111], v[24:31], v132
    s_waitcnt lgkmcnt(1)
    v_exp_f32 v34, v34
    v_exp_f32 v35, v35
    v_exp_f32 v36, v36
    v_smfmac_f32_16x16x64_bf16 v[168:171], v[128:131], v[24:31], v132
    ds_read_b128 v[124:127], v134 offset:39936
    v_exp_f32 v37, v37
    v_exp_f32 v38, v38
    v_mfma_f32_32x32x16_bf16 v[16:31], v[112:115], v[80:83], v[48:63]
    v_exp_f32 v39, v39
    v_exp_f32 v40, v40
    v_exp_f32 v41, v41
    v_mfma_f32_32x32x16_bf16 v[16:31], v[116:119], v[84:87], v[16:31]
    s_nop 0
    v_exp_f32 v42, v42
    v_exp_f32 v43, v43
    v_exp_f32 v44, v44
    v_smfmac_f32_32x32x32_bf16 v[152:167], v[104:107], v[32:39], v132
    s_waitcnt lgkmcnt(0)
    s_barrier
    v_exp_f32 v45, v45
    v_exp_f32 v46, v46
    v_exp_f32 v47, v47
    v_smfmac_f32_16x16x64_bf16 v[172:175], v[128:131], v[32:39], v132
    ds_read_b128 v[96:99], v134 offset:40960
    v_exp_f32 v16, v16
    v_exp_f32 v17, v17
    v_smfmac_f32_32x32x32_bf16 v[152:167], v[108:111], v[40:47], v132
    s_nop 0
    v_exp_f32 v18, v18
    v_exp_f32 v19, v19
    v_exp_f32 v20, v20
    v_smfmac_f32_16x16x64_bf16 v[172:175], v[128:131], v[40:47], v132
    ds_read_b128 v[100:103], v134 offset:41984
    v_exp_f32 v21, v21
    v_exp_f32 v22, v22
    v_mfma_f32_32x32x16_bf16 v[32:47], v[112:115], v[88:91], v[64:79]
    v_exp_f32 v23, v23
    v_exp_f32 v24, v24
    v_exp_f32 v25, v25
    v_mfma_f32_32x32x16_bf16 v[32:47], v[116:119], v[92:95], v[32:47]
    s_nop 0
    v_exp_f32 v26, v26
    v_exp_f32 v27, v27
    v_exp_f32 v28, v28
    v_smfmac_f32_32x32x32_bf16 v[136:151], v[120:123], v[16:23], v132
    s_nop 1
    v_exp_f32 v29, v29
    v_exp_f32 v30, v30
    v_exp_f32 v31, v31
    v_smfmac_f32_16x16x64_bf16 v[168:171], v[128:131], v[16:23], v132
    ds_read_b128 v[104:107], v134 offset:43008
    v_exp_f32 v32, v32
    v_exp_f32 v33, v33
    v_smfmac_f32_32x32x32_bf16 v[136:151], v[124:127], v[24:31], v132
    s_waitcnt lgkmcnt(1)
    v_exp_f32 v34, v34
    v_exp_f32 v35, v35
    v_exp_f32 v36, v36
    v_smfmac_f32_16x16x64_bf16 v[168:171], v[128:131], v[24:31], v132
    ds_read_b128 v[108:111], v134 offset:44032
    v_exp_f32 v37, v37
    v_exp_f32 v38, v38
    v_mfma_f32_32x32x16_bf16 v[16:31], v[96:99], v[80:83], v[48:63]
    v_exp_f32 v39, v39
    v_exp_f32 v40, v40
    v_exp_f32 v41, v41
    v_mfma_f32_32x32x16_bf16 v[16:31], v[100:103], v[84:87], v[16:31]
    s_nop 0
    v_exp_f32 v42, v42
    v_exp_f32 v43, v43
    v_exp_f32 v44, v44
    v_smfmac_f32_32x32x32_bf16 v[152:167], v[120:123], v[32:39], v132
    s_nop 1
    v_exp_f32 v45, v45
    v_exp_f32 v46, v46
    v_exp_f32 v47, v47
    v_smfmac_f32_16x16x64_bf16 v[172:175], v[128:131], v[32:39], v132
    ds_read_b128 v[112:115], v134 offset:45056
    v_exp_f32 v16, v16
    v_exp_f32 v17, v17
    v_smfmac_f32_32x32x32_bf16 v[152:167], v[124:127], v[40:47], v132
    s_waitcnt lgkmcnt(1)
    v_exp_f32 v18, v18
    v_exp_f32 v19, v19
    v_exp_f32 v20, v20
    v_smfmac_f32_16x16x64_bf16 v[172:175], v[128:131], v[40:47], v132
    ds_read_b128 v[116:119], v134 offset:46080
    v_exp_f32 v21, v21
    v_exp_f32 v22, v22
    v_mfma_f32_32x32x16_bf16 v[32:47], v[96:99], v[88:91], v[64:79]
    v_exp_f32 v23, v23
    v_exp_f32 v24, v24
    v_exp_f32 v25, v25
    v_mfma_f32_32x32x16_bf16 v[32:47], v[100:103], v[92:95], v[32:47]
    s_nop 0
    v_exp_f32 v26, v26
    v_exp_f32 v27, v27
    v_exp_f32 v28, v28
    v_smfmac_f32_32x32x32_bf16 v[136:151], v[104:107], v[16:23], v132
    s_nop 1
    v_exp_f32 v29, v29
    v_exp_f32 v30, v30
    v_exp_f32 v31, v31
    v_smfmac_f32_16x16x64_bf16 v[168:171], v[128:131], v[16:23], v132
    ds_read_b128 v[120:123], v134 offset:47104
    v_exp_f32 v32, v32
    v_exp_f32 v33, v33
    v_smfmac_f32_32x32x32_bf16 v[136:151], v[108:111], v[24:31], v132
    s_waitcnt lgkmcnt(1)
    v_exp_f32 v34, v34
    v_exp_f32 v35, v35
    v_exp_f32 v36, v36
    v_smfmac_f32_16x16x64_bf16 v[168:171], v[128:131], v[24:31], v132
    ds_read_b128 v[124:127], v134 offset:48128
    v_exp_f32 v37, v37
    v_exp_f32 v38, v38
    v_mfma_f32_32x32x16_bf16 v[16:31], v[112:115], v[80:83], v[48:63]
    v_exp_f32 v39, v39
    v_exp_f32 v40, v40
    v_exp_f32 v41, v41
    v_mfma_f32_32x32x16_bf16 v[16:31], v[116:119], v[84:87], v[16:31]
    s_nop 0
    v_exp_f32 v42, v42
    v_exp_f32 v43, v43
    v_exp_f32 v44, v44
    v_smfmac_f32_32x32x32_bf16 v[152:167], v[104:107], v[32:39], v132
    s_nop 1
    v_exp_f32 v45, v45
    v_exp_f32 v46, v46
    v_exp_f32 v47, v47
    v_smfmac_f32_16x16x64_bf16 v[172:175], v[128:131], v[32:39], v132
    ds_read_b128 v[96:99], v134 offset:49152
    v_exp_f32 v16, v16
    v_exp_f32 v17, v17
    v_smfmac_f32_32x32x32_bf16 v[152:167], v[108:111], v[40:47], v132
    s_waitcnt lgkmcnt(1)
    v_exp_f32 v18, v18
    v_exp_f32 v19, v19
    v_exp_f32 v20, v20
    v_smfmac_f32_16x16x64_bf16 v[172:175], v[128:131], v[40:47], v132
    ds_read_b128 v[100:103], v134 offset:50176
    v_exp_f32 v21, v21
    v_exp_f32 v22, v22
    v_mfma_f32_32x32x16_bf16 v[32:47], v[112:115], v[88:91], v[64:79]
    v_exp_f32 v23, v23
    v_exp_f32 v24, v24
    v_exp_f32 v25, v25
    v_mfma_f32_32x32x16_bf16 v[32:47], v[116:119], v[92:95], v[32:47]
    s_nop 0
    v_exp_f32 v26, v26
    v_exp_f32 v27, v27
    v_exp_f32 v28, v28
    v_smfmac_f32_32x32x32_bf16 v[136:151], v[120:123], v[16:23], v132
    s_nop 1
    v_exp_f32 v29, v29
    v_exp_f32 v30, v30
    v_exp_f32 v31, v31
    v_smfmac_f32_16x16x64_bf16 v[168:171], v[128:131], v[16:23], v132
    ds_read_b128 v[104:107], v134 offset:51200
    v_exp_f32 v32, v32
    v_exp_f32 v33, v33
    v_smfmac_f32_32x32x32_bf16 v[136:151], v[124:127], v[24:31], v132
    s_waitcnt lgkmcnt(1)
    v_exp_f32 v34, v34
    v_exp_f32 v35, v35
    v_exp_f32 v36, v36
    v_smfmac_f32_16x16x64_bf16 v[168:171], v[128:131], v[24:31], v132
    ds_read_b128 v[108:111], v134 offset:52224
    v_exp_f32 v37, v37
    v_exp_f32 v38, v38
    v_mfma_f32_32x32x16_bf16 v[16:31], v[96:99], v[80:83], v[48:63]
    v_exp_f32 v39, v39
    v_exp_f32 v40, v40
    v_exp_f32 v41, v41
    v_mfma_f32_32x32x16_bf16 v[16:31], v[100:103], v[84:87], v[16:31]
    s_nop 0
    v_exp_f32 v42, v42
    v_exp_f32 v43, v43
    v_exp_f32 v44, v44
    v_smfmac_f32_32x32x32_bf16 v[152:167], v[120:123], v[32:39], v132
    s_nop 1
    v_exp_f32 v45, v45
    v_exp_f32 v46, v46
    v_exp_f32 v47, v47
    v_smfmac_f32_16x16x64_bf16 v[172:175], v[128:131], v[32:39], v132
    ds_read_b128 v[112:115], v134 offset:53248
    v_exp_f32 v16, v16
    v_exp_f32 v17, v17
    v_smfmac_f32_32x32x32_bf16 v[152:167], v[124:127], v[40:47], v132
    s_waitcnt lgkmcnt(1)
    v_exp_f32 v18, v18
    v_exp_f32 v19, v19
    v_exp_f32 v20, v20
    v_smfmac_f32_16x16x64_bf16 v[172:175], v[128:131], v[40:47], v132
    ds_read_b128 v[116:119], v134 offset:54272
    v_exp_f32 v21, v21
    v_exp_f32 v22, v22
    v_mfma_f32_32x32x16_bf16 v[32:47], v[96:99], v[88:91], v[64:79]
    v_exp_f32 v23, v23
    v_exp_f32 v24, v24
    v_exp_f32 v25, v25
    v_mfma_f32_32x32x16_bf16 v[32:47], v[100:103], v[92:95], v[32:47]
    s_nop 0
    v_exp_f32 v26, v26
    v_exp_f32 v27, v27
    v_exp_f32 v28, v28
    v_smfmac_f32_32x32x32_bf16 v[136:151], v[104:107], v[16:23], v132
    s_nop 1
    v_exp_f32 v29, v29
    v_exp_f32 v30, v30
    v_exp_f32 v31, v31
    v_smfmac_f32_16x16x64_bf16 v[168:171], v[128:131], v[16:23], v132
    ds_read_b128 v[120:123], v134 offset:55296
    v_exp_f32 v32, v32
    v_exp_f32 v33, v33
    v_smfmac_f32_32x32x32_bf16 v[136:151], v[108:111], v[24:31], v132
    s_waitcnt lgkmcnt(1)
    v_exp_f32 v34, v34
    v_exp_f32 v35, v35
    v_exp_f32 v36, v36
    v_smfmac_f32_16x16x64_bf16 v[168:171], v[128:131], v[24:31], v132
    ds_read_b128 v[124:127], v134 offset:56320
    v_exp_f32 v37, v37
    v_exp_f32 v38, v38
    v_mfma_f32_32x32x16_bf16 v[16:31], v[112:115], v[80:83], v[48:63]
    v_exp_f32 v39, v39
    v_exp_f32 v40, v40
    v_exp_f32 v41, v41
    v_mfma_f32_32x32x16_bf16 v[16:31], v[116:119], v[84:87], v[16:31]
    s_nop 0
    v_exp_f32 v42, v42
    v_exp_f32 v43, v43
    v_exp_f32 v44, v44
    v_smfmac_f32_32x32x32_bf16 v[152:167], v[104:107], v[32:39], v132
    s_nop 1
    v_exp_f32 v45, v45
    v_exp_f32 v46, v46
    v_exp_f32 v47, v47
    v_smfmac_f32_16x16x64_bf16 v[172:175], v[128:131], v[32:39], v132
    ds_read_b128 v[96:99], v134 offset:57344
    v_exp_f32 v16, v16
    v_exp_f32 v17, v17
    v_smfmac_f32_32x32x32_bf16 v[152:167], v[108:111], v[40:47], v132
    s_waitcnt lgkmcnt(1)
    v_exp_f32 v18, v18
    v_exp_f32 v19, v19
    v_exp_f32 v20, v20
    v_smfmac_f32_16x16x64_bf16 v[172:175], v[128:131], v[40:47], v132
    ds_read_b128 v[100:103], v134 offset:58368
    v_exp_f32 v21, v21
    v_exp_f32 v22, v22
    v_mfma_f32_32x32x16_bf16 v[32:47], v[112:115], v[88:91], v[64:79]
    v_exp_f32 v23, v23
    v_exp_f32 v24, v24
    v_exp_f32 v25, v25
    v_mfma_f32_32x32x16_bf16 v[32:47], v[116:119], v[92:95], v[32:47]
    s_nop 0
    v_exp_f32 v26, v26
    v_exp_f32 v27, v27
    v_exp_f32 v28, v28
    v_smfmac_f32_32x32x32_bf16 v[136:151], v[120:123], v[16:23], v132
    s_nop 1
    v_exp_f32 v29, v29
    v_exp_f32 v30, v30
    v_exp_f32 v31, v31
    v_smfmac_f32_16x16x64_bf16 v[168:171], v[128:131], v[16:23], v132
    ds_read_b128 v[104:107], v134 offset:59392
    v_exp_f32 v32, v32
    v_exp_f32 v33, v33
    v_smfmac_f32_32x32x32_bf16 v[136:151], v[124:127], v[24:31], v132
    s_waitcnt lgkmcnt(1)
    v_exp_f32 v34, v34
    v_exp_f32 v35, v35
    v_exp_f32 v36, v36
    v_smfmac_f32_16x16x64_bf16 v[168:171], v[128:131], v[24:31], v132
    ds_read_b128 v[108:111], v134 offset:60416
    v_exp_f32 v37, v37
    v_exp_f32 v38, v38
    v_mfma_f32_32x32x16_bf16 v[16:31], v[96:99], v[80:83], v[48:63]
    v_exp_f32 v39, v39
    v_exp_f32 v40, v40
    v_exp_f32 v41, v41
    v_mfma_f32_32x32x16_bf16 v[16:31], v[100:103], v[84:87], v[16:31]
    s_nop 0
    v_exp_f32 v42, v42
    v_exp_f32 v43, v43
    v_exp_f32 v44, v44
    v_smfmac_f32_32x32x32_bf16 v[152:167], v[120:123], v[32:39], v132
    s_nop 1
    v_exp_f32 v45, v45
    v_exp_f32 v46, v46
    v_exp_f32 v47, v47
    v_smfmac_f32_16x16x64_bf16 v[172:175], v[128:131], v[32:39], v132
    ds_read_b128 v[112:115], v134 offset:61440
    v_exp_f32 v16, v16
    v_exp_f32 v17, v17
    v_smfmac_f32_32x32x32_bf16 v[152:167], v[124:127], v[40:47], v132
    s_waitcnt lgkmcnt(1)
    v_exp_f32 v18, v18
    v_exp_f32 v19, v19
    v_exp_f32 v20, v20
    v_smfmac_f32_16x16x64_bf16 v[172:175], v[128:131], v[40:47], v132
    ds_read_b128 v[116:119], v134 offset:62464
    v_exp_f32 v21, v21
    v_exp_f32 v22, v22
    v_mfma_f32_32x32x16_bf16 v[32:47], v[96:99], v[88:91], v[64:79]
    v_exp_f32 v23, v23
    v_exp_f32 v24, v24
    v_exp_f32 v25, v25
    v_mfma_f32_32x32x16_bf16 v[32:47], v[100:103], v[92:95], v[32:47]
    s_nop 0
    v_exp_f32 v26, v26
    v_exp_f32 v27, v27
    v_exp_f32 v28, v28
    v_smfmac_f32_32x32x32_bf16 v[136:151], v[104:107], v[16:23], v132
    s_nop 1
    v_exp_f32 v29, v29
    v_exp_f32 v30, v30
    v_exp_f32 v31, v31
    v_smfmac_f32_16x16x64_bf16 v[168:171], v[128:131], v[16:23], v132
    ds_read_b128 v[120:123], v134 offset:63488
    v_exp_f32 v32, v32
    v_exp_f32 v33, v33
    v_smfmac_f32_32x32x32_bf16 v[136:151], v[108:111], v[24:31], v132
    s_waitcnt lgkmcnt(1)
    v_exp_f32 v34, v34
    v_exp_f32 v35, v35
    v_exp_f32 v36, v36
    v_smfmac_f32_16x16x64_bf16 v[168:171], v[128:131], v[24:31], v132
    ds_read_b128 v[124:127], v134 offset:64512
    v_exp_f32 v37, v37
    v_exp_f32 v38, v38
    v_mfma_f32_32x32x16_bf16 v[16:31], v[112:115], v[80:83], v[48:63]
    v_exp_f32 v39, v39
    v_exp_f32 v40, v40
    v_exp_f32 v41, v41
    v_mfma_f32_32x32x16_bf16 v[16:31], v[116:119], v[84:87], v[16:31]
    s_nop 0
    v_exp_f32 v42, v42
    v_exp_f32 v43, v43
    v_exp_f32 v44, v44
    v_smfmac_f32_32x32x32_bf16 v[152:167], v[104:107], v[32:39], v132
    s_waitcnt lgkmcnt(0)
    s_barrier
    v_exp_f32 v45, v45
    v_exp_f32 v46, v46
    v_exp_f32 v47, v47
    v_smfmac_f32_16x16x64_bf16 v[172:175], v[128:131], v[32:39], v132
    ds_read_b128 v[96:99], v135 offset:0
    v_exp_f32 v16, v16
    v_exp_f32 v17, v17
    v_smfmac_f32_32x32x32_bf16 v[152:167], v[108:111], v[40:47], v132
    s_nop 0
    v_exp_f32 v18, v18
    v_exp_f32 v19, v19
    v_exp_f32 v20, v20
    v_smfmac_f32_16x16x64_bf16 v[172:175], v[128:131], v[40:47], v132
    ds_read_b128 v[100:103], v135 offset:1024
    v_exp_f32 v21, v21
    v_exp_f32 v22, v22
    v_mfma_f32_32x32x16_bf16 v[32:47], v[112:115], v[88:91], v[64:79]
    v_exp_f32 v23, v23
    v_exp_f32 v24, v24
    v_exp_f32 v25, v25
    v_mfma_f32_32x32x16_bf16 v[32:47], v[116:119], v[92:95], v[32:47]
    s_nop 0
    v_exp_f32 v26, v26
    v_exp_f32 v27, v27
    v_exp_f32 v28, v28
    v_smfmac_f32_32x32x32_bf16 v[136:151], v[120:123], v[16:23], v132
    s_nop 1
    v_exp_f32 v29, v29
    v_exp_f32 v30, v30
    v_exp_f32 v31, v31
    v_smfmac_f32_16x16x64_bf16 v[168:171], v[128:131], v[16:23], v132
    ds_read_b128 v[104:107], v135 offset:2048
    v_exp_f32 v32, v32
    v_exp_f32 v33, v33
    v_smfmac_f32_32x32x32_bf16 v[136:151], v[124:127], v[24:31], v132
    s_waitcnt lgkmcnt(1)
    v_exp_f32 v34, v34
    v_exp_f32 v35, v35
    v_exp_f32 v36, v36
    v_smfmac_f32_16x16x64_bf16 v[168:171], v[128:131], v[24:31], v132
    ds_read_b128 v[108:111], v135 offset:3072
    v_exp_f32 v37, v37
    v_exp_f32 v38, v38
    v_mfma_f32_32x32x16_bf16 v[16:31], v[96:99], v[80:83], v[48:63]
    v_exp_f32 v39, v39
    v_exp_f32 v40, v40
    v_exp_f32 v41, v41
    v_mfma_f32_32x32x16_bf16 v[16:31], v[100:103], v[84:87], v[16:31]
    s_nop 0
    v_exp_f32 v42, v42
    v_exp_f32 v43, v43
    v_exp_f32 v44, v44
    v_smfmac_f32_32x32x32_bf16 v[152:167], v[120:123], v[32:39], v132
    s_nop 1
    v_exp_f32 v45, v45
    v_exp_f32 v46, v46
    v_exp_f32 v47, v47
    v_smfmac_f32_16x16x64_bf16 v[172:175], v[128:131], v[32:39], v132
    ds_read_b128 v[112:115], v135 offset:4096
    v_exp_f32 v16, v16
    v_exp_f32 v17, v17
    v_smfmac_f32_32x32x32_bf16 v[152:167], v[124:127], v[40:47], v132
    s_waitcnt lgkmcnt(1)
    v_exp_f32 v18, v18
    v_exp_f32 v19, v19
    v_exp_f32 v20, v20
    v_smfmac_f32_16x16x64_bf16 v[172:175], v[128:131], v[40:47], v132
    ds_read_b128 v[116:119], v135 offset:5120
    v_exp_f32 v21, v21
    v_exp_f32 v22, v22
    v_mfma_f32_32x32x16_bf16 v[32:47], v[96:99], v[88:91], v[64:79]
    v_exp_f32 v23, v23
    v_exp_f32 v24, v24
    v_exp_f32 v25, v25
    v_mfma_f32_32x32x16_bf16 v[32:47], v[100:103], v[92:95], v[32:47]
    s_nop 0
    v_exp_f32 v26, v26
    v_exp_f32 v27, v27
    v_exp_f32 v28, v28
    v_smfmac_f32_32x32x32_bf16 v[136:151], v[104:107], v[16:23], v132
    s_nop 1
    v_exp_f32 v29, v29
    v_exp_f32 v30, v30
    v_exp_f32 v31, v31
    v_smfmac_f32_16x16x64_bf16 v[168:171], v[128:131], v[16:23], v132
    ds_read_b128 v[120:123], v135 offset:6144
    v_exp_f32 v32, v32
    v_exp_f32 v33, v33
    v_smfmac_f32_32x32x32_bf16 v[136:151], v[108:111], v[24:31], v132
    s_waitcnt lgkmcnt(1)
    v_exp_f32 v34, v34
    v_exp_f32 v35, v35
    v_exp_f32 v36, v36
    v_smfmac_f32_16x16x64_bf16 v[168:171], v[128:131], v[24:31], v132
    ds_read_b128 v[124:127], v135 offset:7168
    v_exp_f32 v37, v37
    v_exp_f32 v38, v38
    v_mfma_f32_32x32x16_bf16 v[16:31], v[112:115], v[80:83], v[48:63]
    v_exp_f32 v39, v39
    v_exp_f32 v40, v40
    v_exp_f32 v41, v41
    v_mfma_f32_32x32x16_bf16 v[16:31], v[116:119], v[84:87], v[16:31]
    s_nop 0
    v_exp_f32 v42, v42
    v_exp_f32 v43, v43
    v_exp_f32 v44, v44
    v_smfmac_f32_32x32x32_bf16 v[152:167], v[104:107], v[32:39], v132
    s_nop 1
    v_exp_f32 v45, v45
    v_exp_f32 v46, v46
    v_exp_f32 v47, v47
    v_smfmac_f32_16x16x64_bf16 v[172:175], v[128:131], v[32:39], v132
    ds_read_b128 v[96:99], v135 offset:8192
    v_exp_f32 v16, v16
    v_exp_f32 v17, v17
    v_smfmac_f32_32x32x32_bf16 v[152:167], v[108:111], v[40:47], v132
    s_waitcnt lgkmcnt(1)
    v_exp_f32 v18, v18
    v_exp_f32 v19, v19
    v_exp_f32 v20, v20
    v_smfmac_f32_16x16x64_bf16 v[172:175], v[128:131], v[40:47], v132
    ds_read_b128 v[100:103], v135 offset:9216
    v_exp_f32 v21, v21
    v_exp_f32 v22, v22
    v_mfma_f32_32x32x16_bf16 v[32:47], v[112:115], v[88:91], v[64:79]
    v_exp_f32 v23, v23
    v_exp_f32 v24, v24
    v_exp_f32 v25, v25
    v_mfma_f32_32x32x16_bf16 v[32:47], v[116:119], v[92:95], v[32:47]
    s_nop 0
    v_exp_f32 v26, v26
    v_exp_f32 v27, v27
    v_exp_f32 v28, v28
    v_smfmac_f32_32x32x32_bf16 v[136:151], v[120:123], v[16:23], v132
    s_nop 1
    v_exp_f32 v29, v29
    v_exp_f32 v30, v30
    v_exp_f32 v31, v31
    v_smfmac_f32_16x16x64_bf16 v[168:171], v[128:131], v[16:23], v132
    ds_read_b128 v[104:107], v135 offset:10240
    v_exp_f32 v32, v32
    v_exp_f32 v33, v33
    v_smfmac_f32_32x32x32_bf16 v[136:151], v[124:127], v[24:31], v132
    s_waitcnt lgkmcnt(1)
    v_exp_f32 v34, v34
    v_exp_f32 v35, v35
    v_exp_f32 v36, v36
    v_smfmac_f32_16x16x64_bf16 v[168:171], v[128:131], v[24:31], v132
    ds_read_b128 v[108:111], v135 offset:11264
    v_exp_f32 v37, v37
    v_exp_f32 v38, v38
    v_mfma_f32_32x32x16_bf16 v[16:31], v[96:99], v[80:83], v[48:63]
    v_exp_f32 v39, v39
    v_exp_f32 v40, v40
    v_exp_f32 v41, v41
    v_mfma_f32_32x32x16_bf16 v[16:31], v[100:103], v[84:87], v[16:31]
    s_nop 0
    v_exp_f32 v42, v42
    v_exp_f32 v43, v43
    v_exp_f32 v44, v44
    v_smfmac_f32_32x32x32_bf16 v[152:167], v[120:123], v[32:39], v132
    s_nop 1
    v_exp_f32 v45, v45
    v_exp_f32 v46, v46
    v_exp_f32 v47, v47
    v_smfmac_f32_16x16x64_bf16 v[172:175], v[128:131], v[32:39], v132
    ds_read_b128 v[112:115], v135 offset:12288
    v_exp_f32 v16, v16
    v_exp_f32 v17, v17
    v_smfmac_f32_32x32x32_bf16 v[152:167], v[124:127], v[40:47], v132
    s_waitcnt lgkmcnt(1)
    v_exp_f32 v18, v18
    v_exp_f32 v19, v19
    v_exp_f32 v20, v20
    v_smfmac_f32_16x16x64_bf16 v[172:175], v[128:131], v[40:47], v132
    ds_read_b128 v[116:119], v135 offset:13312
    v_exp_f32 v21, v21
    v_exp_f32 v22, v22
    v_mfma_f32_32x32x16_bf16 v[32:47], v[96:99], v[88:91], v[64:79]
    v_exp_f32 v23, v23
    v_exp_f32 v24, v24
    v_exp_f32 v25, v25
    v_mfma_f32_32x32x16_bf16 v[32:47], v[100:103], v[92:95], v[32:47]
    s_nop 0
    v_exp_f32 v26, v26
    v_exp_f32 v27, v27
    v_exp_f32 v28, v28
    v_smfmac_f32_32x32x32_bf16 v[136:151], v[104:107], v[16:23], v132
    s_nop 1
    v_exp_f32 v29, v29
    v_exp_f32 v30, v30
    v_exp_f32 v31, v31
    v_smfmac_f32_16x16x64_bf16 v[168:171], v[128:131], v[16:23], v132
    ds_read_b128 v[120:123], v135 offset:14336
    v_exp_f32 v32, v32
    v_exp_f32 v33, v33
    v_smfmac_f32_32x32x32_bf16 v[136:151], v[108:111], v[24:31], v132
    s_waitcnt lgkmcnt(1)
    v_exp_f32 v34, v34
    v_exp_f32 v35, v35
    v_exp_f32 v36, v36
    v_smfmac_f32_16x16x64_bf16 v[168:171], v[128:131], v[24:31], v132
    ds_read_b128 v[124:127], v135 offset:15360
    v_exp_f32 v37, v37
    v_exp_f32 v38, v38
    v_mfma_f32_32x32x16_bf16 v[16:31], v[112:115], v[80:83], v[48:63]
    v_exp_f32 v39, v39
    v_exp_f32 v40, v40
    v_exp_f32 v41, v41
    v_mfma_f32_32x32x16_bf16 v[16:31], v[116:119], v[84:87], v[16:31]
    s_nop 0
    v_exp_f32 v42, v42
    v_exp_f32 v43, v43
    v_exp_f32 v44, v44
    v_smfmac_f32_32x32x32_bf16 v[152:167], v[104:107], v[32:39], v132
    s_nop 1
    v_exp_f32 v45, v45
    v_exp_f32 v46, v46
    v_exp_f32 v47, v47
    v_smfmac_f32_16x16x64_bf16 v[172:175], v[128:131], v[32:39], v132
    ds_read_b128 v[96:99], v135 offset:16384
    v_exp_f32 v16, v16
    v_exp_f32 v17, v17
    v_smfmac_f32_32x32x32_bf16 v[152:167], v[108:111], v[40:47], v132
    s_waitcnt lgkmcnt(1)
    v_exp_f32 v18, v18
    v_exp_f32 v19, v19
    v_exp_f32 v20, v20
    v_smfmac_f32_16x16x64_bf16 v[172:175], v[128:131], v[40:47], v132
    ds_read_b128 v[100:103], v135 offset:17408
    v_exp_f32 v21, v21
    v_exp_f32 v22, v22
    v_mfma_f32_32x32x16_bf16 v[32:47], v[112:115], v[88:91], v[64:79]
    v_exp_f32 v23, v23
    v_exp_f32 v24, v24
    v_exp_f32 v25, v25
    v_mfma_f32_32x32x16_bf16 v[32:47], v[116:119], v[92:95], v[32:47]
    s_nop 0
    v_exp_f32 v26, v26
    v_exp_f32 v27, v27
    v_exp_f32 v28, v28
    v_smfmac_f32_32x32x32_bf16 v[136:151], v[120:123], v[16:23], v132
    s_nop 1
    v_exp_f32 v29, v29
    v_exp_f32 v30, v30
    v_exp_f32 v31, v31
    v_smfmac_f32_16x16x64_bf16 v[168:171], v[128:131], v[16:23], v132
    ds_read_b128 v[104:107], v135 offset:18432
    v_exp_f32 v32, v32
    v_exp_f32 v33, v33
    v_smfmac_f32_32x32x32_bf16 v[136:151], v[124:127], v[24:31], v132
    s_waitcnt lgkmcnt(1)
    v_exp_f32 v34, v34
    v_exp_f32 v35, v35
    v_exp_f32 v36, v36
L_pg2:
    s_cbranch_execz L_pgret
    v_smfmac_f32_16x16x64_bf16 v[168:171], v[128:131], v[24:31], v132
    ds_read_b128 v[108:111], v135 offset:19456
    v_exp_f32 v37, v37
    v_exp_f32 v38, v38
    v_mfma_f32_32x32x16_bf16 v[16:31], v[96:99], v[80:83], v[48:63]
    v_exp_f32 v39, v39
    v_exp_f32 v40, v40
    v_exp_f32 v41, v41
    v_mfma_f32_32x32x16_bf16 v[16:31], v[100:103], v[84:87], v[16:31]
    s_nop 0
    v_exp_f32 v42, v42
    v_exp_f32 v43, v43
    v_exp_f32 v44, v44
    v_smfmac_f32_32x32x32_bf16 v[152:167], v[120:123], v[32:39], v132
    s_nop 1
    v_exp_f32 v45, v45
    v_exp_f32 v46, v46
    v_exp_f32 v47, v47
    v_smfmac_f32_16x16x64_bf16 v[172:175], v[128:131], v[32:39], v132
    ds_read_b128 v[112:115], v135 offset:20480
    v_exp_f32 v16, v16
    v_exp_f32 v17, v17
    v_smfmac_f32_32x32x32_bf16 v[152:167], v[124:127], v[40:47], v132
    s_waitcnt lgkmcnt(1)
    v_exp_f32 v18, v18
    v_exp_f32 v19, v19
    v_exp_f32 v20, v20
    v_smfmac_f32_16x16x64_bf16 v[172:175], v[128:131], v[40:47], v132
    ds_read_b128 v[116:119], v135 offset:21504
    v_exp_f32 v21, v21
    v_exp_f32 v22, v22
    v_mfma_f32_32x32x16_bf16 v[32:47], v[96:99], v[88:91], v[64:79]
    v_exp_f32 v23, v23
    v_exp_f32 v24, v24
    v_exp_f32 v25, v25
    v_mfma_f32_32x32x16_bf16 v[32:47], v[100:103], v[92:95], v[32:47]
    s_nop 0
    v_exp_f32 v26, v26
    v_exp_f32 v27, v27
    v_exp_f32 v28, v28
    v_smfmac_f32_32x32x32_bf16 v[136:151], v[104:107], v[16:23], v132
    s_nop 1
    v_exp_f32 v29, v29
    v_exp_f32 v30, v30
    v_exp_f32 v31, v31
    v_smfmac_f32_16x16x64_bf16 v[168:171], v[128:131], v[16:23], v132
    ds_read_b128 v[120:123], v135 offset:22528
    v_exp_f32 v32, v32
    v_exp_f32 v33, v33
    v_smfmac_f32_32x32x32_bf16 v[136:151], v[108:111], v[24:31], v132
    s_waitcnt lgkmcnt(1)
    v_exp_f32 v34, v34
    v_exp_f32 v35, v35
    v_exp_f32 v36, v36
    v_smfmac_f32_16x16x64_bf16 v[168:171], v[128:131], v[24:31], v132
    ds_read_b128 v[124:127], v135 offset:23552
    v_exp_f32 v37, v37
    v_exp_f32 v38, v38
    v_mfma_f32_32x32x16_bf16 v[16:31], v[112:115], v[80:83], v[48:63]
    v_exp_f32 v39, v39
    v_exp_f32 v40, v40
    v_exp_f32 v41, v41
    v_mfma_f32_32x32x16_bf16 v[16:31], v[116:119], v[84:87], v[16:31]
    s_nop 0
    v_exp_f32 v42, v42
    v_exp_f32 v43, v43
    v_exp_f32 v44, v44
    v_smfmac_f32_32x32x32_bf16 v[152:167], v[104:107], v[32:39], v132
    s_nop 1
    v_exp_f32 v45, v45
    v_exp_f32 v46, v46
    v_exp_f32 v47, v47
    v_smfmac_f32_16x16x64_bf16 v[172:175], v[128:131], v[32:39], v132
    ds_read_b128 v[96:99], v135 offset:24576
    v_exp_f32 v16, v16
    v_exp_f32 v17, v17
    v_smfmac_f32_32x32x32_bf16 v[152:167], v[108:111], v[40:47], v132
    s_waitcnt lgkmcnt(1)
    v_exp_f32 v18, v18
    v_exp_f32 v19, v19
    v_exp_f32 v20, v20
    v_smfmac_f32_16x16x64_bf16 v[172:175], v[128:131], v[40:47], v132
    ds_read_b128 v[100:103], v135 offset:25600
    v_exp_f32 v21, v21
    v_exp_f32 v22, v22
    v_mfma_f32_32x32x16_bf16 v[32:47], v[112:115], v[88:91], v[64:79]
    v_exp_f32 v23, v23
    v_exp_f32 v24, v24
    v_exp_f32 v25, v25
    v_mfma_f32_32x32x16_bf16 v[32:47], v[116:119], v[92:95], v[32:47]
    s_nop 0
    v_exp_f32 v26, v26
    v_exp_f32 v27, v27
    v_exp_f32 v28, v28
    v_smfmac_f32_32x32x32_bf16 v[136:151], v[120:123], v[16:23], v132
    s_nop 1
    v_exp_f32 v29, v29
    v_exp_f32 v30, v30
    v_exp_f32 v31, v31
    v_smfmac_f32_16x16x64_bf16 v[168:171], v[128:131], v[16:23], v132
    ds_read_b128 v[104:107], v135 offset:26624
    v_exp_f32 v32, v32
    v_exp_f32 v33, v33
    v_smfmac_f32_32x32x32_bf16 v[136:151], v[124:127], v[24:31], v132
    s_waitcnt lgkmcnt(1)
    v_exp_f32 v34, v34
    v_exp_f32 v35, v35
    v_exp_f32 v36, v36
    v_smfmac_f32_16x16x64_bf16 v[168:171], v[128:131], v[24:31], v132
    ds_read_b128 v[108:111], v135 offset:27648
    v_exp_f32 v37, v37
    v_exp_f32 v38, v38
    v_mfma_f32_32x32x16_bf16 v[16:31], v[96:99], v[80:83], v[48:63]
    v_exp_f32 v39, v39
    v_exp_f32 v40, v40
    v_exp_f32 v41, v41
    v_mfma_f32_32x32x16_bf16 v[16:31], v[100:103], v[84:87], v[16:31]
    s_nop 0
    v_exp_f32 v42, v42
    v_exp_f32 v43, v43
    v_exp_f32 v44, v44
    v_smfmac_f32_32x32x32_bf16 v[152:167], v[120:123], v[32:39], v132
    s_nop 1
    v_exp_f32 v45, v45
    v_exp_f32 v46, v46
    v_exp_f32 v47, v47
    v_smfmac_f32_16x16x64_bf16 v[172:175], v[128:131], v[32:39], v132
    ds_read_b128 v[112:115], v135 offset:28672
    v_exp_f32 v16, v16
    v_exp_f32 v17, v17
    v_smfmac_f32_32x32x32_bf16 v[152:167], v[124:127], v[40:47], v132
    s_waitcnt lgkmcnt(1)
    v_exp_f32 v18, v18
    v_exp_f32 v19, v19
    v_exp_f32 v20, v20
    v_smfmac_f32_16x16x64_bf16 v[172:175], v[128:131], v[40:47], v132
    ds_read_b128 v[116:119], v135 offset:29696
    v_exp_f32 v21, v21
    v_exp_f32 v22, v22
    v_mfma_f32_32x32x16_bf16 v[32:47], v[96:99], v[88:91], v[64:79]
    v_exp_f32 v23, v23
    v_exp_f32 v24, v24
    v_exp_f32 v25, v25
    v_mfma_f32_32x32x16_bf16 v[32:47], v[100:103], v[92:95], v[32:47]
    s_nop 0
    v_exp_f32 v26, v26
    v_exp_f32 v27, v27
    v_exp_f32 v28, v28
    v_smfmac_f32_32x32x32_bf16 v[136:151], v[104:107], v[16:23], v132
    s_nop 1
    v_exp_f32 v29, v29
    v_exp_f32 v30, v30
    v_exp_f32 v31, v31
    v_smfmac_f32_16x16x64_bf16 v[168:171], v[128:131], v[16:23], v132
    ds_read_b128 v[120:123], v135 offset:30720
    v_exp_f32 v32, v32
    v_exp_f32 v33, v33
    v_smfmac_f32_32x32x32_bf16 v[136:151], v[108:111], v[24:31], v132
    s_waitcnt lgkmcnt(1)
    v_exp_f32 v34, v34
    v_exp_f32 v35, v35
    v_exp_f32 v36, v36
    v_smfmac_f32_16x16x64_bf16 v[168:171], v[128:131], v[24:31], v132
    ds_read_b128 v[124:127], v135 offset:31744
    v_exp_f32 v37, v37
    v_exp_f32 v38, v38
    v_mfma_f32_32x32x16_bf16 v[16:31], v[112:115], v[80:83], v[48:63]
    v_exp_f32 v39, v39
    v_exp_f32 v40, v40
    v_exp_f32 v41, v41
    v_mfma_f32_32x32x16_bf16 v[16:31], v[116:119], v[84:87], v[16:31]
    s_nop 0
    v_exp_f32 v42, v42
    v_exp_f32 v43, v43
    v_exp_f32 v44, v44
    v_smfmac_f32_32x32x32_bf16 v[152:167], v[104:107], v[32:39], v132
    s_waitcnt lgkmcnt(0)
    s_barrier
    v_exp_f32 v45, v45
    v_exp_f32 v46, v46
    v_exp_f32 v47, v47
    v_smfmac_f32_16x16x64_bf16 v[172:175], v[128:131], v[32:39], v132
    ds_read_b128 v[96:99], v133 offset:0
    v_exp_f32 v16, v16
    v_exp_f32 v17, v17
    v_smfmac_f32_32x32x32_bf16 v[152:167], v[108:111], v[40:47], v132
    s_nop 0
    v_exp_f32 v18, v18
    v_exp_f32 v19, v19
    v_exp_f32 v20, v20
    v_smfmac_f32_16x16x64_bf16 v[172:175], v[128:131], v[40:47], v132
    ds_read_b128 v[100:103], v133 offset:1024
    v_exp_f32 v21, v21
    v_exp_f32 v22, v22
    v_mfma_f32_32x32x16_bf16 v[32:47], v[112:115], v[88:91], v[64:79]
    v_exp_f32 v23, v23
    v_exp_f32 v24, v24
    v_exp_f32 v25, v25
    v_mfma_f32_32x32x16_bf16 v[32:47], v[116:119], v[92:95], v[32:47]
    s_nop 0
    v_exp_f32 v26, v26
    v_exp_f32 v27, v27
    v_exp_f32 v28, v28
    v_smfmac_f32_32x32x32_bf16 v[136:151], v[120:123], v[16:23], v132
    s_nop 1
    v_exp_f32 v29, v29
    v_exp_f32 v30, v30
    v_exp_f32 v31, v31
    v_smfmac_f32_16x16x64_bf16 v[168:171], v[128:131], v[16:23], v132
    ds_read_b128 v[104:107], v133 offset:2048
    v_exp_f32 v32, v32
    v_exp_f32 v33, v33
    v_smfmac_f32_32x32x32_bf16 v[136:151], v[124:127], v[24:31], v132
    s_waitcnt lgkmcnt(1)
    v_exp_f32 v34, v34
    v_exp_f32 v35, v35
    v_exp_f32 v36, v36
    v_smfmac_f32_16x16x64_bf16 v[168:171], v[128:131], v[24:31], v132
    ds_read_b128 v[108:111], v133 offset:3072
    v_exp_f32 v37, v37
    v_exp_f32 v38, v38
    v_mfma_f32_32x32x16_bf16 v[16:31], v[96:99], v[80:83], v[48:63]
    v_exp_f32 v39, v39
    v_exp_f32 v40, v40
    v_exp_f32 v41, v41
    v_mfma_f32_32x32x16_bf16 v[16:31], v[100:103], v[84:87], v[16:31]
    s_nop 0
    v_exp_f32 v42, v42
    v_exp_f32 v43, v43
    v_exp_f32 v44, v44
    v_smfmac_f32_32x32x32_bf16 v[152:167], v[120:123], v[32:39], v132
    s_nop 1
    v_exp_f32 v45, v45
    v_exp_f32 v46, v46
    v_exp_f32 v47, v47
    v_smfmac_f32_16x16x64_bf16 v[172:175], v[128:131], v[32:39], v132
    ds_read_b128 v[112:115], v133 offset:4096
    v_exp_f32 v16, v16
    v_exp_f32 v17, v17
    v_smfmac_f32_32x32x32_bf16 v[152:167], v[124:127], v[40:47], v132
    s_waitcnt lgkmcnt(1)
    v_exp_f32 v18, v18
    v_exp_f32 v19, v19
    v_exp_f32 v20, v20
    v_smfmac_f32_16x16x64_bf16 v[172:175], v[128:131], v[40:47], v132
    ds_read_b128 v[116:119], v133 offset:5120
    v_exp_f32 v21, v21
    v_exp_f32 v22, v22
    v_mfma_f32_32x32x16_bf16 v[32:47], v[96:99], v[88:91], v[64:79]
    v_exp_f32 v23, v23
    v_exp_f32 v24, v24
    v_exp_f32 v25, v25
    v_mfma_f32_32x32x16_bf16 v[32:47], v[100:103], v[92:95], v[32:47]
    s_nop 0
    v_exp_f32 v26, v26
    v_exp_f32 v27, v27
    v_exp_f32 v28, v28
    v_smfmac_f32_32x32x32_bf16 v[136:151], v[104:107], v[16:23], v132
    s_nop 1
    v_exp_f32 v29, v29
    v_exp_f32 v30, v30
    v_exp_f32 v31, v31
    v_smfmac_f32_16x16x64_bf16 v[168:171], v[128:131], v[16:23], v132
    ds_read_b128 v[120:123], v133 offset:6144
    v_exp_f32 v32, v32
    v_exp_f32 v33, v33
    v_smfmac_f32_32x32x32_bf16 v[136:151], v[108:111], v[24:31], v132
    s_waitcnt lgkmcnt(1)
    v_exp_f32 v34, v34
    v_exp_f32 v35, v35
    v_exp_f32 v36, v36
    v_smfmac_f32_16x16x64_bf16 v[168:171], v[128:131], v[24:31], v132
    ds_read_b128 v[124:127], v133 offset:7168
    v_exp_f32 v37, v37
    v_exp_f32 v38, v38
    v_mfma_f32_32x32x16_bf16 v[16:31], v[112:115], v[80:83], v[48:63]
    v_exp_f32 v39, v39
    v_exp_f32 v40, v40
    v_exp_f32 v41, v41
    v_mfma_f32_32x32x16_bf16 v[16:31], v[116:119], v[84:87], v[16:31]
    s_nop 0
    v_exp_f32 v42, v42
    v_exp_f32 v43, v43
    v_exp_f32 v44, v44
    v_smfmac_f32_32x32x32_bf16 v[152:167], v[104:107], v[32:39], v132
    s_nop 1
    v_exp_f32 v45, v45
    v_exp_f32 v46, v46
    v_exp_f32 v47, v47
    v_smfmac_f32_16x16x64_bf16 v[172:175], v[128:131], v[32:39], v132
    ds_read_b128 v[96:99], v133 offset:8192
    v_exp_f32 v16, v16
    v_exp_f32 v17, v17
    v_smfmac_f32_32x32x32_bf16 v[152:167], v[108:111], v[40:47], v132
    s_waitcnt lgkmcnt(1)
    v_exp_f32 v18, v18
    v_exp_f32 v19, v19
    v_exp_f32 v20, v20
    v_smfmac_f32_16x16x64_bf16 v[172:175], v[128:131], v[40:47], v132
    ds_read_b128 v[100:103], v133 offset:9216
    v_exp_f32 v21, v21
    v_exp_f32 v22, v22
    v_mfma_f32_32x32x16_bf16 v[32:47], v[112:115], v[88:91], v[64:79]
    v_exp_f32 v23, v23
    v_exp_f32 v24, v24
    v_exp_f32 v25, v25
    v_mfma_f32_32x32x16_bf16 v[32:47], v[116:119], v[92:95], v[32:47]
    s_nop 0
    v_exp_f32 v26, v26
    v_exp_f32 v27, v27
    v_exp_f32 v28, v28
    v_smfmac_f32_32x32x32_bf16 v[136:151], v[120:123], v[16:23], v132
    s_nop 1
    v_exp_f32 v29, v29
    v_exp_f32 v30, v30
    v_exp_f32 v31, v31
    v_smfmac_f32_16x16x64_bf16 v[168:171], v[128:131], v[16:23], v132
    ds_read_b128 v[104:107], v133 offset:10240
    v_exp_f32 v32, v32
    v_exp_f32 v33, v33
    v_smfmac_f32_32x32x32_bf16 v[136:151], v[124:127], v[24:31], v132
    s_waitcnt lgkmcnt(1)
    v_exp_f32 v34, v34
    v_exp_f32 v35, v35
    v_exp_f32 v36, v36
    v_smfmac_f32_16x16x64_bf16 v[168:171], v[128:131], v[24:31], v132
    ds_read_b128 v[108:111], v133 offset:11264
    v_exp_f32 v37, v37
    v_exp_f32 v38, v38
    v_mfma_f32_32x32x16_bf16 v[16:31], v[96:99], v[80:83], v[48:63]
    v_exp_f32 v39, v39
    v_exp_f32 v40, v40
    v_exp_f32 v41, v41
    v_mfma_f32_32x32x16_bf16 v[16:31], v[100:103], v[84:87], v[16:31]
    s_nop 0
    v_exp_f32 v42, v42
    v_exp_f32 v43, v43
    v_exp_f32 v44, v44
    v_smfmac_f32_32x32x32_bf16 v[152:167], v[120:123], v[32:39], v132
    s_nop 1
    v_exp_f32 v45, v45
    v_exp_f32 v46, v46
    v_exp_f32 v47, v47
    v_smfmac_f32_16x16x64_bf16 v[172:175], v[128:131], v[32:39], v132
    ds_read_b128 v[112:115], v133 offset:12288
    v_exp_f32 v16, v16
    v_exp_f32 v17, v17
    v_smfmac_f32_32x32x32_bf16 v[152:167], v[124:127], v[40:47], v132
    s_waitcnt lgkmcnt(1)
    v_exp_f32 v18, v18
    v_exp_f32 v19, v19
    v_exp_f32 v20, v20
    v_smfmac_f32_16x16x64_bf16 v[172:175], v[128:131], v[40:47], v132
    ds_read_b128 v[116:119], v133 offset:13312
    v_exp_f32 v21, v21
    v_exp_f32 v22, v22
    v_mfma_f32_32x32x16_bf16 v[32:47], v[96:99], v[88:91], v[64:79]
    v_exp_f32 v23, v23
    v_exp_f32 v24, v24
    v_exp_f32 v25, v25
    v_mfma_f32_32x32x16_bf16 v[32:47], v[100:103], v[92:95], v[32:47]
    s_nop 0
    v_exp_f32 v26, v26
    v_exp_f32 v27, v27
    v_exp_f32 v28, v28
    v_smfmac_f32_32x32x32_bf16 v[136:151], v[104:107], v[16:23], v132
    s_nop 1
    v_exp_f32 v29, v29
    v_exp_f32 v30, v30
    v_exp_f32 v31, v31
    v_smfmac_f32_16x16x64_bf16 v[168:171], v[128:131], v[16:23], v132
    ds_read_b128 v[120:123], v133 offset:14336
    v_exp_f32 v32, v32
    v_exp_f32 v33, v33
    v_smfmac_f32_32x32x32_bf16 v[136:151], v[108:111], v[24:31], v132
    s_waitcnt lgkmcnt(1)
    v_exp_f32 v34, v34
    v_exp_f32 v35, v35
    v_exp_f32 v36, v36
    v_smfmac_f32_16x16x64_bf16 v[168:171], v[128:131], v[24:31], v132
    ds_read_b128 v[124:127], v133 offset:15360
    v_exp_f32 v37, v37
    v_exp_f32 v38, v38
    v_mfma_f32_32x32x16_bf16 v[16:31], v[112:115], v[80:83], v[48:63]
    v_exp_f32 v39, v39
    v_exp_f32 v40, v40
    v_exp_f32 v41, v41
    v_mfma_f32_32x32x16_bf16 v[16:31], v[116:119], v[84:87], v[16:31]
    s_nop 0
    v_exp_f32 v42, v42
    v_exp_f32 v43, v43
    v_exp_f32 v44, v44
    v_smfmac_f32_32x32x32_bf16 v[152:167], v[104:107], v[32:39], v132
    s_nop 1
    v_exp_f32 v45, v45
    v_exp_f32 v46, v46
    v_exp_f32 v47, v47
    v_smfmac_f32_16x16x64_bf16 v[172:175], v[128:131], v[32:39], v132
    ds_read_b128 v[96:99], v133 offset:16384
    v_exp_f32 v16, v16
    v_exp_f32 v17, v17
    v_smfmac_f32_32x32x32_bf16 v[152:167], v[108:111], v[40:47], v132
    s_waitcnt lgkmcnt(1)
    v_exp_f32 v18, v18
    v_exp_f32 v19, v19
    v_exp_f32 v20, v20
    v_smfmac_f32_16x16x64_bf16 v[172:175], v[128:131], v[40:47], v132
    ds_read_b128 v[100:103], v133 offset:17408
    v_exp_f32 v21, v21
    v_exp_f32 v22, v22
    v_mfma_f32_32x32x16_bf16 v[32:47], v[112:115], v[88:91], v[64:79]
    v_exp_f32 v23, v23
    v_exp_f32 v24, v24
    v_exp_f32 v25, v25
    v_mfma_f32_32x32x16_bf16 v[32:47], v[116:119], v[92:95], v[32:47]
    s_nop 0
    v_exp_f32 v26, v26
    v_exp_f32 v27, v27
    v_exp_f32 v28, v28
    v_smfmac_f32_32x32x32_bf16 v[136:151], v[120:123], v[16:23], v132
    s_nop 1
    v_exp_f32 v29, v29
    v_exp_f32 v30, v30
    v_exp_f32 v31, v31
    v_smfmac_f32_16x16x64_bf16 v[168:171], v[128:131], v[16:23], v132
    ds_read_b128 v[104:107], v133 offset:18432
    v_exp_f32 v32, v32
    v_exp_f32 v33, v33
    v_smfmac_f32_32x32x32_bf16 v[136:151], v[124:127], v[24:31], v132
    s_waitcnt lgkmcnt(1)
    v_exp_f32 v34, v34
    v_exp_f32 v35, v35
    v_exp_f32 v36, v36
    v_smfmac_f32_16x16x64_bf16 v[168:171], v[128:131], v[24:31], v132
    ds_read_b128 v[108:111], v133 offset:19456
    v_exp_f32 v37, v37
    v_exp_f32 v38, v38
    v_mfma_f32_32x32x16_bf16 v[16:31], v[96:99], v[80:83], v[48:63]
    v_exp_f32 v39, v39
    v_exp_f32 v40, v40
    v_exp_f32 v41, v41
    v_mfma_f32_32x32x16_bf16 v[16:31], v[100:103], v[84:87], v[16:31]
    s_nop 0
    v_exp_f32 v42, v42
    v_exp_f32 v43, v43
    v_exp_f32 v44, v44
    v_smfmac_f32_32x32x32_bf16 v[152:167], v[120:123], v[32:39], v132
    s_nop 1
    v_exp_f32 v45, v45
    v_exp_f32 v46, v46
    v_exp_f32 v47, v47
    v_smfmac_f32_16x16x64_bf16 v[172:175], v[128:131], v[32:39], v132
    ds_read_b128 v[112:115], v133 offset:20480
    v_exp_f32 v16, v16
    v_exp_f32 v17, v17
    v_smfmac_f32_32x32x32_bf16 v[152:167], v[124:127], v[40:47], v132
    s_waitcnt lgkmcnt(1)
    v_exp_f32 v18, v18
    v_exp_f32 v19, v19
    v_exp_f32 v20, v20
    v_smfmac_f32_16x16x64_bf16 v[172:175], v[128:131], v[40:47], v132
    ds_read_b128 v[116:119], v133 offset:21504
    v_exp_f32 v21, v21
    v_exp_f32 v22, v22
    v_mfma_f32_32x32x16_bf16 v[32:47], v[96:99], v[88:91], v[64:79]
    v_exp_f32 v23, v23
    v_exp_f32 v24, v24
    v_exp_f32 v25, v25
    v_mfma_f32_32x32x16_bf16 v[32:47], v[100:103], v[92:95], v[32:47]
    s_nop 0
    v_exp_f32 v26, v26
    v_exp_f32 v27, v27
    v_exp_f32 v28, v28
    v_smfmac_f32_32x32x32_bf16 v[136:151], v[104:107], v[16:23], v132
    s_nop 1
    v_exp_f32 v29, v29
    v_exp_f32 v30, v30
    v_exp_f32 v31, v31
    v_smfmac_f32_16x16x64_bf16 v[168:171], v[128:131], v[16:23], v132
    ds_read_b128 v[120:123], v133 offset:22528
    v_exp_f32 v32, v32
    v_exp_f32 v33, v33
    v_smfmac_f32_32x32x32_bf16 v[136:151], v[108:111], v[24:31], v132
    s_waitcnt lgkmcnt(1)
    v_exp_f32 v34, v34
    v_exp_f32 v35, v35
    v_exp_f32 v36, v36
    v_smfmac_f32_16x16x64_bf16 v[168:171], v[128:131], v[24:31], v132
    ds_read_b128 v[124:127], v133 offset:23552
    v_exp_f32 v37, v37
    v_exp_f32 v38, v38
    v_mfma_f32_32x32x16_bf16 v[16:31], v[112:115], v[80:83], v[48:63]
    v_exp_f32 v39, v39
    v_exp_f32 v40, v40
    v_exp_f32 v41, v41
    v_mfma_f32_32x32x16_bf16 v[16:31], v[116:119], v[84:87], v[16:31]
    s_nop 0
    v_exp_f32 v42, v42
    v_exp_f32 v43, v43
    v_exp_f32 v44, v44
    v_smfmac_f32_32x32x32_bf16 v[152:167], v[104:107], v[32:39], v132
    s_nop 1
    v_exp_f32 v45, v45
    v_exp_f32 v46, v46
    v_exp_f32 v47, v47
    v_smfmac_f32_16x16x64_bf16 v[172:175], v[128:131], v[32:39], v132
    ds_read_b128 v[96:99], v133 offset:24576
    v_exp_f32 v16, v16
    v_exp_f32 v17, v17
    v_smfmac_f32_32x32x32_bf16 v[152:167], v[108:111], v[40:47], v132
    s_waitcnt lgkmcnt(1)
    v_exp_f32 v18, v18
    v_exp_f32 v19, v19
    v_exp_f32 v20, v20
    v_smfmac_f32_16x16x64_bf16 v[172:175], v[128:131], v[40:47], v132
    ds_read_b128 v[100:103], v133 offset:25600
    v_exp_f32 v21, v21
    v_exp_f32 v22, v22
    v_mfma_f32_32x32x16_bf16 v[32:47], v[112:115], v[88:91], v[64:79]
    v_exp_f32 v23, v23
    v_exp_f32 v24, v24
    v_exp_f32 v25, v25
    v_mfma_f32_32x32x16_bf16 v[32:47], v[116:119], v[92:95], v[32:47]
    s_nop 0
    v_exp_f32 v26, v26
    v_exp_f32 v27, v27
    v_exp_f32 v28, v28
    v_smfmac_f32_32x32x32_bf16 v[136:151], v[120:123], v[16:23], v132
    s_nop 1
    v_exp_f32 v29, v29
    v_exp_f32 v30, v30
    v_exp_f32 v31, v31
    v_smfmac_f32_16x16x64_bf16 v[168:171], v[128:131], v[16:23], v132
    ds_read_b128 v[104:107], v133 offset:26624
    v_exp_f32 v32, v32
    v_exp_f32 v33, v33
    v_smfmac_f32_32x32x32_bf16 v[136:151], v[124:127], v[24:31], v132
    s_waitcnt lgkmcnt(1)
    v_exp_f32 v34, v34
    v_exp_f32 v35, v35
    v_exp_f32 v36, v36
    v_smfmac_f32_16x16x64_bf16 v[168:171], v[128:131], v[24:31], v132
    ds_read_b128 v[108:111], v133 offset:27648
    v_exp_f32 v37, v37
    v_exp_f32 v38, v38
    v_mfma_f32_32x32x16_bf16 v[16:31], v[96:99], v[80:83], v[48:63]
    v_exp_f32 v39, v39
    v_exp_f32 v40, v40
    v_exp_f32 v41, v41
    v_mfma_f32_32x32x16_bf16 v[16:31], v[100:103], v[84:87], v[16:31]
    s_nop 0
    v_exp_f32 v42, v42
    v_exp_f32 v43, v43
    v_exp_f32 v44, v44
    v_smfmac_f32_32x32x32_bf16 v[152:167], v[120:123], v[32:39], v132
    s_nop 1
    v_exp_f32 v45, v45
    v_exp_f32 v46, v46
    v_exp_f32 v47, v47
    v_smfmac_f32_16x16x64_bf16 v[172:175], v[128:131], v[32:39], v132
    ds_read_b128 v[112:115], v133 offset:28672
    v_exp_f32 v16, v16
    v_exp_f32 v17, v17
    v_smfmac_f32_32x32x32_bf16 v[152:167], v[124:127], v[40:47], v132
    s_waitcnt lgkmcnt(1)
    v_exp_f32 v18, v18
    v_exp_f32 v19, v19
    v_exp_f32 v20, v20
    v_smfmac_f32_16x16x64_bf16 v[172:175], v[128:131], v[40:47], v132
    ds_read_b128 v[116:119], v133 offset:29696
    v_exp_f32 v21, v21
    v_exp_f32 v22, v22
    v_mfma_f32_32x32x16_bf16 v[32:47], v[96:99], v[88:91], v[64:79]
    v_exp_f32 v23, v23
    v_exp_f32 v24, v24
    v_exp_f32 v25, v25
    v_mfma_f32_32x32x16_bf16 v[32:47], v[100:103], v[92:95], v[32:47]
    s_nop 0
    v_exp_f32 v26, v26
    v_exp_f32 v27, v27
    v_exp_f32 v28, v28
    v_smfmac_f32_32x32x32_bf16 v[136:151], v[104:107], v[16:23], v132
    s_nop 1
    v_exp_f32 v29, v29
    v_exp_f32 v30, v30
    v_exp_f32 v31, v31
    v_smfmac_f32_16x16x64_bf16 v[168:171], v[128:131], v[16:23], v132
    ds_read_b128 v[120:123], v133 offset:30720
    v_exp_f32 v32, v32
    v_exp_f32 v33, v33
    v_smfmac_f32_32x32x32_bf16 v[136:151], v[108:111], v[24:31], v132
    s_waitcnt lgkmcnt(1)
    v_exp_f32 v34, v34
    v_exp_f32 v35, v35
    v_exp_f32 v36, v36
    v_smfmac_f32_16x16x64_bf16 v[168:171], v[128:131], v[24:31], v132
    ds_read_b128 v[124:127], v133 offset:31744
    v_exp_f32 v37, v37
    v_exp_f32 v38, v38
    v_mfma_f32_32x32x16_bf16 v[16:31], v[112:115], v[80:83], v[48:63]
    v_exp_f32 v39, v39
    v_exp_f32 v40, v40
    v_exp_f32 v41, v41
    v_mfma_f32_32x32x16_bf16 v[16:31], v[116:119], v[84:87], v[16:31]
    s_nop 0
    v_exp_f32 v42, v42
    v_exp_f32 v43, v43
    v_exp_f32 v44, v44
    v_smfmac_f32_32x32x32_bf16 v[152:167], v[104:107], v[32:39], v132
    s_waitcnt lgkmcnt(0)
    s_barrier
    v_exp_f32 v45, v45
    v_exp_f32 v46, v46
    v_exp_f32 v47, v47
    v_smfmac_f32_16x16x64_bf16 v[172:175], v[128:131], v[32:39], v132
    ds_read_b128 v[96:99], v133 offset:32768
    v_exp_f32 v16, v16
    v_exp_f32 v17, v17
    v_smfmac_f32_32x32x32_bf16 v[152:167], v[108:111], v[40:47], v132
    s_nop 0
    v_exp_f32 v18, v18
    v_exp_f32 v19, v19
    v_exp_f32 v20, v20
    v_smfmac_f32_16x16x64_bf16 v[172:175], v[128:131], v[40:47], v132
    ds_read_b128 v[100:103], v133 offset:33792
    v_exp_f32 v21, v21
    v_exp_f32 v22, v22
    v_mfma_f32_32x32x16_bf16 v[32:47], v[112:115], v[88:91], v[64:79]
    v_exp_f32 v23, v23
    v_exp_f32 v24, v24
    v_exp_f32 v25, v25
    v_mfma_f32_32x32x16_bf16 v[32:47], v[116:119], v[92:95], v[32:47]
    s_nop 0
    v_exp_f32 v26, v26
    v_exp_f32 v27, v27
    v_exp_f32 v28, v28
    v_smfmac_f32_32x32x32_bf16 v[136:151], v[120:123], v[16:23], v132
    s_nop 1
    v_exp_f32 v29, v29
    v_exp_f32 v30, v30
    v_exp_f32 v31, v31
    v_smfmac_f32_16x16x64_bf16 v[168:171], v[128:131], v[16:23], v132
    ds_read_b128 v[104:107], v133 offset:34816
    v_exp_f32 v32, v32
    v_exp_f32 v33, v33
    v_smfmac_f32_32x32x32_bf16 v[136:151], v[124:127], v[24:31], v132
    s_waitcnt lgkmcnt(1)
    v_exp_f32 v34, v34
    v_exp_f32 v35, v35
    v_exp_f32 v36, v36
    v_smfmac_f32_16x16x64_bf16 v[168:171], v[128:131], v[24:31], v132
    ds_read_b128 v[108:111], v133 offset:35840
    v_exp_f32 v37, v37
    v_exp_f32 v38, v38
    v_mfma_f32_32x32x16_bf16 v[16:31], v[96:99], v[80:83], v[48:63]
    v_exp_f32 v39, v39
    v_exp_f32 v40, v40
    v_exp_f32 v41, v41
    v_mfma_f32_32x32x16_bf16 v[16:31], v[100:103], v[84:87], v[16:31]
    s_nop 0
    v_exp_f32 v42, v42
    v_exp_f32 v43, v43
    v_exp_f32 v44, v44
    v_smfmac_f32_32x32x32_bf16 v[152:167], v[120:123], v[32:39], v132
    s_nop 1
    v_exp_f32 v45, v45
    v_exp_f32 v46, v46
    v_exp_f32 v47, v47
    v_smfmac_f32_16x16x64_bf16 v[172:175], v[128:131], v[32:39], v132
    ds_read_b128 v[112:115], v133 offset:36864
    v_exp_f32 v16, v16
    v_exp_f32 v17, v17
    v_smfmac_f32_32x32x32_bf16 v[152:167], v[124:127], v[40:47], v132
    s_waitcnt lgkmcnt(1)
    v_exp_f32 v18, v18
    v_exp_f32 v19, v19
    v_exp_f32 v20, v20
    v_smfmac_f32_16x16x64_bf16 v[172:175], v[128:131], v[40:47], v132
    ds_read_b128 v[116:119], v133 offset:37888
    v_exp_f32 v21, v21
    v_exp_f32 v22, v22
    v_mfma_f32_32x32x16_bf16 v[32:47], v[96:99], v[88:91], v[64:79]
    v_exp_f32 v23, v23
    v_exp_f32 v24, v24
    v_exp_f32 v25, v25
    v_mfma_f32_32x32x16_bf16 v[32:47], v[100:103], v[92:95], v[32:47]
    s_nop 0
    v_exp_f32 v26, v26
    v_exp_f32 v27, v27
    v_exp_f32 v28, v28
    v_smfmac_f32_32x32x32_bf16 v[136:151], v[104:107], v[16:23], v132
    s_nop 1
    v_exp_f32 v29, v29
    v_exp_f32 v30, v30
    v_exp_f32 v31, v31
    v_smfmac_f32_16x16x64_bf16 v[168:171], v[128:131], v[16:23], v132
    ds_read_b128 v[120:123], v133 offset:38912
    v_exp_f32 v32, v32
    v_exp_f32 v33, v33
    v_smfmac_f32_32x32x32_bf16 v[136:151], v[108:111], v[24:31], v132
    s_waitcnt lgkmcnt(1)
    v_exp_f32 v34, v34
    v_exp_f32 v35, v35
    v_exp_f32 v36, v36
    v_smfmac_f32_16x16x64_bf16 v[168:171], v[128:131], v[24:31], v132
    ds_read_b128 v[124:127], v133 offset:39936
    v_exp_f32 v37, v37
    v_exp_f32 v38, v38
    v_mfma_f32_32x32x16_bf16 v[16:31], v[112:115], v[80:83], v[48:63]
    v_exp_f32 v39, v39
    v_exp_f32 v40, v40
    v_exp_f32 v41, v41
    v_mfma_f32_32x32x16_bf16 v[16:31], v[116:119], v[84:87], v[16:31]
    s_nop 0
    v_exp_f32 v42, v42
    v_exp_f32 v43, v43
    v_exp_f32 v44, v44
    v_smfmac_f32_32x32x32_bf16 v[152:167], v[104:107], v[32:39], v132
    s_nop 1
    v_exp_f32 v45, v45
    v_exp_f32 v46, v46
    v_exp_f32 v47, v47
    v_smfmac_f32_16x16x64_bf16 v[172:175], v[128:131], v[32:39], v132
    ds_read_b128 v[96:99], v133 offset:40960
    v_exp_f32 v16, v16
    v_exp_f32 v17, v17
    v_smfmac_f32_32x32x32_bf16 v[152:167], v[108:111], v[40:47], v132
    s_waitcnt lgkmcnt(1)
    v_exp_f32 v18, v18
    v_exp_f32 v19, v19
    v_exp_f32 v20, v20
    v_smfmac_f32_16x16x64_bf16 v[172:175], v[128:131], v[40:47], v132
    ds_read_b128 v[100:103], v133 offset:41984
    v_exp_f32 v21, v21
    v_exp_f32 v22, v22
    v_mfma_f32_32x32x16_bf16 v[32:47], v[112:115], v[88:91], v[64:79]
    v_exp_f32 v23, v23
    v_exp_f32 v24, v24
    v_exp_f32 v25, v25
    v_mfma_f32_32x32x16_bf16 v[32:47], v[116:119], v[92:95], v[32:47]
    s_nop 0
    v_exp_f32 v26, v26
    v_exp_f32 v27, v27
    v_exp_f32 v28, v28
    v_smfmac_f32_32x32x32_bf16 v[136:151], v[120:123], v[16:23], v132
    s_nop 1
    v_exp_f32 v29, v29
    v_exp_f32 v30, v30
    v_exp_f32 v31, v31
    v_smfmac_f32_16x16x64_bf16 v[168:171], v[128:131], v[16:23], v132
    ds_read_b128 v[104:107], v133 offset:43008
    v_exp_f32 v32, v32
    v_exp_f32 v33, v33
    v_smfmac_f32_32x32x32_bf16 v[136:151], v[124:127], v[24:31], v132
    s_waitcnt lgkmcnt(1)
    v_exp_f32 v34, v34
    v_exp_f32 v35, v35
    v_exp_f32 v36, v36
    v_smfmac_f32_16x16x64_bf16 v[168:171], v[128:131], v[24:31], v132
    ds_read_b128 v[108:111], v133 offset:44032
    v_exp_f32 v37, v37
    v_exp_f32 v38, v38
    v_mfma_f32_32x32x16_bf16 v[16:31], v[96:99], v[80:83], v[48:63]
    v_exp_f32 v39, v39
    v_exp_f32 v40, v40
    v_exp_f32 v41, v41
    v_mfma_f32_32x32x16_bf16 v[16:31], v[100:103], v[84:87], v[16:31]
    s_nop 0
    v_exp_f32 v42, v42
    v_exp_f32 v43, v43
    v_exp_f32 v44, v44
    v_smfmac_f32_32x32x32_bf16 v[152:167], v[120:123], v[32:39], v132
    s_nop 1
    v_exp_f32 v45, v45
    v_exp_f32 v46, v46
    v_exp_f32 v47, v47
    v_smfmac_f32_16x16x64_bf16 v[172:175], v[128:131], v[32:39], v132
    ds_read_b128 v[112:115], v133 offset:45056
    v_exp_f32 v16, v16
    v_exp_f32 v17, v17
    v_smfmac_f32_32x32x32_bf16 v[152:167], v[124:127], v[40:47], v132
    s_waitcnt lgkmcnt(1)
    v_exp_f32 v18, v18
    v_exp_f32 v19, v19
    v_exp_f32 v20, v20
    v_smfmac_f32_16x16x64_bf16 v[172:175], v[128:131], v[40:47], v132
    ds_read_b128 v[116:119], v133 offset:46080
    v_exp_f32 v21, v21
    v_exp_f32 v22, v22
L_pg3:
    s_cbranch_execz L_pgret
    v_mfma_f32_32x32x16_bf16 v[32:47], v[96:99], v[88:91], v[64:79]
    v_exp_f32 v23, v23
    v_exp_f32 v24, v24
    v_exp_f32 v25, v25
    v_mfma_f32_32x32x16_bf16 v[32:47], v[100:103], v[92:95], v[32:47]
    s_nop 0
    v_exp_f32 v26, v26
    v_exp_f32 v27, v27
    v_exp_f32 v28, v28
    v_smfmac_f32_32x32x32_bf16 v[136:151], v[104:107], v[16:23], v132
    s_nop 1
    v_exp_f32 v29, v29
    v_exp_f32 v30, v30
    v_exp_f32 v31, v31
    v_smfmac_f32_16x16x64_bf16 v[168:171], v[128:131], v[16:23], v132
    ds_read_b128 v[120:123], v133 offset:47104
    v_exp_f32 v32, v32
    v_exp_f32 v33, v33
    v_smfmac_f32_32x32x32_bf16 v[136:151], v[108:111], v[24:31], v132
    s_waitcnt lgkmcnt(1)
    v_exp_f32 v34, v34
    v_exp_f32 v35, v35
    v_exp_f32 v36, v36
    v_smfmac_f32_16x16x64_bf16 v[168:171], v[128:131], v[24:31], v132
    ds_read_b128 v[124:127], v133 offset:48128
    v_exp_f32 v37, v37
    v_exp_f32 v38, v38
    v_mfma_f32_32x32x16_bf16 v[16:31], v[112:115], v[80:83], v[48:63]
    v_exp_f32 v39, v39
    v_exp_f32 v40, v40
    v_exp_f32 v41, v41
    v_mfma_f32_32x32x16_bf16 v[16:31], v[116:119], v[84:87], v[16:31]
    s_nop 0
    v_exp_f32 v42, v42
    v_exp_f32 v43, v43
    v_exp_f32 v44, v44
    v_smfmac_f32_32x32x32_bf16 v[152:167], v[104:107], v[32:39], v132
    s_nop 1
    v_exp_f32 v45, v45
    v_exp_f32 v46, v46
    v_exp_f32 v47, v47
    v_smfmac_f32_16x16x64_bf16 v[172:175], v[128:131], v[32:39], v132
    ds_read_b128 v[96:99], v133 offset:49152
    v_exp_f32 v16, v16
    v_exp_f32 v17, v17
    v_smfmac_f32_32x32x32_bf16 v[152:167], v[108:111], v[40:47], v132
    s_waitcnt lgkmcnt(1)
    v_exp_f32 v18, v18
    v_exp_f32 v19, v19
    v_exp_f32 v20, v20
    v_smfmac_f32_16x16x64_bf16 v[172:175], v[128:131], v[40:47], v132
    ds_read_b128 v[100:103], v133 offset:50176
    v_exp_f32 v21, v21
    v_exp_f32 v22, v22
    v_mfma_f32_32x32x16_bf16 v[32:47], v[112:115], v[88:91], v[64:79]
    v_exp_f32 v23, v23
    v_exp_f32 v24, v24
    v_exp_f32 v25, v25
    v_mfma_f32_32x32x16_bf16 v[32:47], v[116:119], v[92:95], v[32:47]
    s_nop 0
    v_exp_f32 v26, v26
    v_exp_f32 v27, v27
    v_exp_f32 v28, v28
    v_smfmac_f32_32x32x32_bf16 v[136:151], v[120:123], v[16:23], v132
    s_nop 1
    v_exp_f32 v29, v29
    v_exp_f32 v30, v30
    v_exp_f32 v31, v31
    v_smfmac_f32_16x16x64_bf16 v[168:171], v[128:131], v[16:23], v132
    ds_read_b128 v[104:107], v133 offset:51200
    v_exp_f32 v32, v32
    v_exp_f32 v33, v33
    v_smfmac_f32_32x32x32_bf16 v[136:151], v[124:127], v[24:31], v132
    s_waitcnt lgkmcnt(1)
    v_exp_f32 v34, v34
    v_exp_f32 v35, v35
    v_exp_f32 v36, v36
    v_smfmac_f32_16x16x64_bf16 v[168:171], v[128:131], v[24:31], v132
    ds_read_b128 v[108:111], v133 offset:52224
    v_exp_f32 v37, v37
    v_exp_f32 v38, v38
    v_mfma_f32_32x32x16_bf16 v[16:31], v[96:99], v[80:83], v[48:63]
    v_exp_f32 v39, v39
    v_exp_f32 v40, v40
    v_exp_f32 v41, v41
    v_mfma_f32_32x32x16_bf16 v[16:31], v[100:103], v[84:87], v[16:31]
    s_nop 0
    v_exp_f32 v42, v42
    v_exp_f32 v43, v43
    v_exp_f32 v44, v44
    v_smfmac_f32_32x32x32_bf16 v[152:167], v[120:123], v[32:39], v132
    s_nop 1
    v_exp_f32 v45, v45
    v_exp_f32 v46, v46
    v_exp_f32 v47, v47
    v_smfmac_f32_16x16x64_bf16 v[172:175], v[128:131], v[32:39], v132
    ds_read_b128 v[112:115], v133 offset:53248
    v_exp_f32 v16, v16
    v_exp_f32 v17, v17
    v_smfmac_f32_32x32x32_bf16 v[152:167], v[124:127], v[40:47], v132
    s_waitcnt lgkmcnt(1)
    v_exp_f32 v18, v18
    v_exp_f32 v19, v19
    v_exp_f32 v20, v20
    v_smfmac_f32_16x16x64_bf16 v[172:175], v[128:131], v[40:47], v132
    ds_read_b128 v[116:119], v133 offset:54272
    v_exp_f32 v21, v21
    v_exp_f32 v22, v22
    v_mfma_f32_32x32x16_bf16 v[32:47], v[96:99], v[88:91], v[64:79]
    v_exp_f32 v23, v23
    v_exp_f32 v24, v24
    v_exp_f32 v25, v25
    v_mfma_f32_32x32x16_bf16 v[32:47], v[100:103], v[92:95], v[32:47]
    s_nop 0
    v_exp_f32 v26, v26
    v_exp_f32 v27, v27
    v_exp_f32 v28, v28
    v_smfmac_f32_32x32x32_bf16 v[136:151], v[104:107], v[16:23], v132
    s_nop 1
    v_exp_f32 v29, v29
    v_exp_f32 v30, v30
    v_exp_f32 v31, v31
    v_smfmac_f32_16x16x64_bf16 v[168:171], v[128:131], v[16:23], v132
    ds_read_b128 v[120:123], v133 offset:55296
    v_exp_f32 v32, v32
    v_exp_f32 v33, v33
    v_smfmac_f32_32x32x32_bf16 v[136:151], v[108:111], v[24:31], v132
    s_waitcnt lgkmcnt(1)
    v_exp_f32 v34, v34
    v_exp_f32 v35, v35
    v_exp_f32 v36, v36
    v_smfmac_f32_16x16x64_bf16 v[168:171], v[128:131], v[24:31], v132
    ds_read_b128 v[124:127], v133 offset:56320
    v_exp_f32 v37, v37
    v_exp_f32 v38, v38
    v_mfma_f32_32x32x16_bf16 v[16:31], v[112:115], v[80:83], v[48:63]
    v_exp_f32 v39, v39
    v_exp_f32 v40, v40
    v_exp_f32 v41, v41
    v_mfma_f32_32x32x16_bf16 v[16:31], v[116:119], v[84:87], v[16:31]
    s_nop 0
    v_exp_f32 v42, v42
    v_exp_f32 v43, v43
    v_exp_f32 v44, v44
    v_smfmac_f32_32x32x32_bf16 v[152:167], v[104:107], v[32:39], v132
    s_nop 1
    v_exp_f32 v45, v45
    v_exp_f32 v46, v46
    v_exp_f32 v47, v47
    v_smfmac_f32_16x16x64_bf16 v[172:175], v[128:131], v[32:39], v132
    ds_read_b128 v[96:99], v133 offset:57344
    v_exp_f32 v16, v16
    v_exp_f32 v17, v17
    v_smfmac_f32_32x32x32_bf16 v[152:167], v[108:111], v[40:47], v132
    s_waitcnt lgkmcnt(1)
    v_exp_f32 v18, v18
    v_exp_f32 v19, v19
    v_exp_f32 v20, v20
    v_smfmac_f32_16x16x64_bf16 v[172:175], v[128:131], v[40:47], v132
    ds_read_b128 v[100:103], v133 offset:58368
    v_exp_f32 v21, v21
    v_exp_f32 v22, v22
    v_mfma_f32_32x32x16_bf16 v[32:47], v[112:115], v[88:91], v[64:79]
    v_exp_f32 v23, v23
    v_exp_f32 v24, v24
    v_exp_f32 v25, v25
    v_mfma_f32_32x32x16_bf16 v[32:47], v[116:119], v[92:95], v[32:47]
    s_nop 0
    v_exp_f32 v26, v26
    v_exp_f32 v27, v27
    v_exp_f32 v28, v28
    v_smfmac_f32_32x32x32_bf16 v[136:151], v[120:123], v[16:23], v132
    s_nop 1
    v_exp_f32 v29, v29
    v_exp_f32 v30, v30
    v_exp_f32 v31, v31
    v_smfmac_f32_16x16x64_bf16 v[168:171], v[128:131], v[16:23], v132
    ds_read_b128 v[104:107], v133 offset:59392
    v_exp_f32 v32, v32
    v_exp_f32 v33, v33
    v_smfmac_f32_32x32x32_bf16 v[136:151], v[124:127], v[24:31], v132
    s_waitcnt lgkmcnt(1)
    v_exp_f32 v34, v34
    v_exp_f32 v35, v35
    v_exp_f32 v36, v36
    v_smfmac_f32_16x16x64_bf16 v[168:171], v[128:131], v[24:31], v132
    ds_read_b128 v[108:111], v133 offset:60416
    v_exp_f32 v37, v37
    v_exp_f32 v38, v38
    v_mfma_f32_32x32x16_bf16 v[16:31], v[96:99], v[80:83], v[48:63]
    v_exp_f32 v39, v39
    v_exp_f32 v40, v40
    v_exp_f32 v41, v41
    v_mfma_f32_32x32x16_bf16 v[16:31], v[100:103], v[84:87], v[16:31]
    s_nop 0
    v_exp_f32 v42, v42
    v_exp_f32 v43, v43
    v_exp_f32 v44, v44
    v_smfmac_f32_32x32x32_bf16 v[152:167], v[120:123], v[32:39], v132
    s_nop 1
    v_exp_f32 v45, v45
    v_exp_f32 v46, v46
    v_exp_f32 v47, v47
    v_smfmac_f32_16x16x64_bf16 v[172:175], v[128:131], v[32:39], v132
    ds_read_b128 v[112:115], v133 offset:61440
    v_exp_f32 v16, v16
    v_exp_f32 v17, v17
    v_smfmac_f32_32x32x32_bf16 v[152:167], v[124:127], v[40:47], v132
    s_waitcnt lgkmcnt(1)
    v_exp_f32 v18, v18
    v_exp_f32 v19, v19
    v_exp_f32 v20, v20
    v_smfmac_f32_16x16x64_bf16 v[172:175], v[128:131], v[40:47], v132
    ds_read_b128 v[116:119], v133 offset:62464
    v_exp_f32 v21, v21
    v_exp_f32 v22, v22
    v_mfma_f32_32x32x16_bf16 v[32:47], v[96:99], v[88:91], v[64:79]
    v_exp_f32 v23, v23
    v_exp_f32 v24, v24
    v_exp_f32 v25, v25
    v_mfma_f32_32x32x16_bf16 v[32:47], v[100:103], v[92:95], v[32:47]
    s_nop 0
    v_exp_f32 v26, v26
    v_exp_f32 v27, v27
    v_exp_f32 v28, v28
    v_smfmac_f32_32x32x32_bf16 v[136:151], v[104:107], v[16:23], v132
    s_nop 1
    v_exp_f32 v29, v29
    v_exp_f32 v30, v30
    v_exp_f32 v31, v31
    v_smfmac_f32_16x16x64_bf16 v[168:171], v[128:131], v[16:23], v132
    ds_read_b128 v[120:123], v133 offset:63488
    v_exp_f32 v32, v32
    v_exp_f32 v33, v33
    v_smfmac_f32_32x32x32_bf16 v[136:151], v[108:111], v[24:31], v132
    s_waitcnt lgkmcnt(1)
    v_exp_f32 v34, v34
    v_exp_f32 v35, v35
    v_exp_f32 v36, v36
    v_smfmac_f32_16x16x64_bf16 v[168:171], v[128:131], v[24:31], v132
    ds_read_b128 v[124:127], v133 offset:64512
    v_exp_f32 v37, v37
    v_exp_f32 v38, v38
    v_mfma_f32_32x32x16_bf16 v[16:31], v[112:115], v[80:83], v[48:63]
    v_exp_f32 v39, v39
    v_exp_f32 v40, v40
    v_exp_f32 v41, v41
    v_mfma_f32_32x32x16_bf16 v[16:31], v[116:119], v[84:87], v[16:31]
    s_nop 0
    v_exp_f32 v42, v42
    v_exp_f32 v43, v43
    v_exp_f32 v44, v44
    v_smfmac_f32_32x32x32_bf16 v[152:167], v[104:107], v[32:39], v132
    s_waitcnt lgkmcnt(0)
    s_barrier
    v_exp_f32 v45, v45
    v_exp_f32 v46, v46
    v_exp_f32 v47, v47
    v_smfmac_f32_16x16x64_bf16 v[172:175], v[128:131], v[32:39], v132
    ds_read_b128 v[96:99], v134 offset:0
    v_exp_f32 v16, v16
    v_exp_f32 v17, v17
    v_smfmac_f32_32x32x32_bf16 v[152:167], v[108:111], v[40:47], v132
    s_nop 0
    v_exp_f32 v18, v18
    v_exp_f32 v19, v19
    v_exp_f32 v20, v20
    v_smfmac_f32_16x16x64_bf16 v[172:175], v[128:131], v[40:47], v132
    ds_read_b128 v[100:103], v134 offset:1024
    v_exp_f32 v21, v21
    v_exp_f32 v22, v22
    v_mfma_f32_32x32x16_bf16 v[32:47], v[112:115], v[88:91], v[64:79]
    v_exp_f32 v23, v23
    v_exp_f32 v24, v24
    v_exp_f32 v25, v25
    v_mfma_f32_32x32x16_bf16 v[32:47], v[116:119], v[92:95], v[32:47]
    s_nop 0
    v_exp_f32 v26, v26
    v_exp_f32 v27, v27
    v_exp_f32 v28, v28
    v_smfmac_f32_32x32x32_bf16 v[136:151], v[120:123], v[16:23], v132
    s_nop 1
    v_exp_f32 v29, v29
    v_exp_f32 v30, v30
    v_exp_f32 v31, v31
    v_smfmac_f32_16x16x64_bf16 v[168:171], v[128:131], v[16:23], v132
    ds_read_b128 v[104:107], v134 offset:2048
    v_exp_f32 v32, v32
    v_exp_f32 v33, v33
    v_smfmac_f32_32x32x32_bf16 v[136:151], v[124:127], v[24:31], v132
    s_waitcnt lgkmcnt(1)
    v_exp_f32 v34, v34
    v_exp_f32 v35, v35
    v_exp_f32 v36, v36
    v_smfmac_f32_16x16x64_bf16 v[168:171], v[128:131], v[24:31], v132
    ds_read_b128 v[108:111], v134 offset:3072
    v_exp_f32 v37, v37
    v_exp_f32 v38, v38
    v_mfma_f32_32x32x16_bf16 v[16:31], v[96:99], v[80:83], v[48:63]
    v_exp_f32 v39, v39
    v_exp_f32 v40, v40
    v_exp_f32 v41, v41
    v_mfma_f32_32x32x16_bf16 v[16:31], v[100:103], v[84:87], v[16:31]
    s_nop 0
    v_exp_f32 v42, v42
    v_exp_f32 v43, v43
    v_exp_f32 v44, v44
    v_smfmac_f32_32x32x32_bf16 v[152:167], v[120:123], v[32:39], v132
    s_nop 1
    v_exp_f32 v45, v45
    v_exp_f32 v46, v46
    v_exp_f32 v47, v47
    v_smfmac_f32_16x16x64_bf16 v[172:175], v[128:131], v[32:39], v132
    ds_read_b128 v[112:115], v134 offset:4096
    v_exp_f32 v16, v16
    v_exp_f32 v17, v17
    v_smfmac_f32_32x32x32_bf16 v[152:167], v[124:127], v[40:47], v132
    s_waitcnt lgkmcnt(1)
    v_exp_f32 v18, v18
    v_exp_f32 v19, v19
    v_exp_f32 v20, v20
    v_smfmac_f32_16x16x64_bf16 v[172:175], v[128:131], v[40:47], v132
    ds_read_b128 v[116:119], v134 offset:5120
    v_exp_f32 v21, v21
    v_exp_f32 v22, v22
    v_mfma_f32_32x32x16_bf16 v[32:47], v[96:99], v[88:91], v[64:79]
    v_exp_f32 v23, v23
    v_exp_f32 v24, v24
    v_exp_f32 v25, v25
    v_mfma_f32_32x32x16_bf16 v[32:47], v[100:103], v[92:95], v[32:47]
    s_nop 0
    v_exp_f32 v26, v26
    v_exp_f32 v27, v27
    v_exp_f32 v28, v28
    v_smfmac_f32_32x32x32_bf16 v[136:151], v[104:107], v[16:23], v132
    s_nop 1
    v_exp_f32 v29, v29
    v_exp_f32 v30, v30
    v_exp_f32 v31, v31
    v_smfmac_f32_16x16x64_bf16 v[168:171], v[128:131], v[16:23], v132
    ds_read_b128 v[120:123], v134 offset:6144
    v_exp_f32 v32, v32
    v_exp_f32 v33, v33
    v_smfmac_f32_32x32x32_bf16 v[136:151], v[108:111], v[24:31], v132
    s_waitcnt lgkmcnt(1)
    v_exp_f32 v34, v34
    v_exp_f32 v35, v35
    v_exp_f32 v36, v36
    v_smfmac_f32_16x16x64_bf16 v[168:171], v[128:131], v[24:31], v132
    ds_read_b128 v[124:127], v134 offset:7168
    v_exp_f32 v37, v37
    v_exp_f32 v38, v38
    v_mfma_f32_32x32x16_bf16 v[16:31], v[112:115], v[80:83], v[48:63]
    v_exp_f32 v39, v39
    v_exp_f32 v40, v40
    v_exp_f32 v41, v41
    v_mfma_f32_32x32x16_bf16 v[16:31], v[116:119], v[84:87], v[16:31]
    s_nop 0
    v_exp_f32 v42, v42
    v_exp_f32 v43, v43
    v_exp_f32 v44, v44
    v_smfmac_f32_32x32x32_bf16 v[152:167], v[104:107], v[32:39], v132
    s_nop 1
    v_exp_f32 v45, v45
    v_exp_f32 v46, v46
    v_exp_f32 v47, v47
    v_smfmac_f32_16x16x64_bf16 v[172:175], v[128:131], v[32:39], v132
    ds_read_b128 v[96:99], v134 offset:8192
    v_exp_f32 v16, v16
    v_exp_f32 v17, v17
    v_smfmac_f32_32x32x32_bf16 v[152:167], v[108:111], v[40:47], v132
    s_waitcnt lgkmcnt(1)
    v_exp_f32 v18, v18
    v_exp_f32 v19, v19
    v_exp_f32 v20, v20
    v_smfmac_f32_16x16x64_bf16 v[172:175], v[128:131], v[40:47], v132
    ds_read_b128 v[100:103], v134 offset:9216
    v_exp_f32 v21, v21
    v_exp_f32 v22, v22
    v_mfma_f32_32x32x16_bf16 v[32:47], v[112:115], v[88:91], v[64:79]
    v_exp_f32 v23, v23
    v_exp_f32 v24, v24
    v_exp_f32 v25, v25
    v_mfma_f32_32x32x16_bf16 v[32:47], v[116:119], v[92:95], v[32:47]
    s_nop 0
    v_exp_f32 v26, v26
    v_exp_f32 v27, v27
    v_exp_f32 v28, v28
    v_smfmac_f32_32x32x32_bf16 v[136:151], v[120:123], v[16:23], v132
    s_nop 1
    v_exp_f32 v29, v29
    v_exp_f32 v30, v30
    v_exp_f32 v31, v31
    v_smfmac_f32_16x16x64_bf16 v[168:171], v[128:131], v[16:23], v132
    ds_read_b128 v[104:107], v134 offset:10240
    v_exp_f32 v32, v32
    v_exp_f32 v33, v33
    v_smfmac_f32_32x32x32_bf16 v[136:151], v[124:127], v[24:31], v132
    s_waitcnt lgkmcnt(1)
    v_exp_f32 v34, v34
    v_exp_f32 v35, v35
    v_exp_f32 v36, v36
    v_smfmac_f32_16x16x64_bf16 v[168:171], v[128:131], v[24:31], v132
    ds_read_b128 v[108:111], v134 offset:11264
    v_exp_f32 v37, v37
    v_exp_f32 v38, v38
    v_mfma_f32_32x32x16_bf16 v[16:31], v[96:99], v[80:83], v[48:63]
    v_exp_f32 v39, v39
    v_exp_f32 v40, v40
    v_exp_f32 v41, v41
    v_mfma_f32_32x32x16_bf16 v[16:31], v[100:103], v[84:87], v[16:31]
    s_nop 0
    v_exp_f32 v42, v42
    v_exp_f32 v43, v43
    v_exp_f32 v44, v44
    v_smfmac_f32_32x32x32_bf16 v[152:167], v[120:123], v[32:39], v132
    s_nop 1
    v_exp_f32 v45, v45
    v_exp_f32 v46, v46
    v_exp_f32 v47, v47
    v_smfmac_f32_16x16x64_bf16 v[172:175], v[128:131], v[32:39], v132
    ds_read_b128 v[112:115], v134 offset:12288
    v_exp_f32 v16, v16
    v_exp_f32 v17, v17
    v_smfmac_f32_32x32x32_bf16 v[152:167], v[124:127], v[40:47], v132
    s_waitcnt lgkmcnt(1)
    v_exp_f32 v18, v18
    v_exp_f32 v19, v19
    v_exp_f32 v20, v20
    v_smfmac_f32_16x16x64_bf16 v[172:175], v[128:131], v[40:47], v132
    ds_read_b128 v[116:119], v134 offset:13312
    v_exp_f32 v21, v21
    v_exp_f32 v22, v22
    v_mfma_f32_32x32x16_bf16 v[32:47], v[96:99], v[88:91], v[64:79]
    v_exp_f32 v23, v23
    v_exp_f32 v24, v24
    v_exp_f32 v25, v25
    v_mfma_f32_32x32x16_bf16 v[32:47], v[100:103], v[92:95], v[32:47]
    s_nop 0
    v_exp_f32 v26, v26
    v_exp_f32 v27, v27
    v_exp_f32 v28, v28
    v_smfmac_f32_32x32x32_bf16 v[136:151], v[104:107], v[16:23], v132
    s_nop 1
    v_exp_f32 v29, v29
    v_exp_f32 v30, v30
    v_exp_f32 v31, v31
    v_smfmac_f32_16x16x64_bf16 v[168:171], v[128:131], v[16:23], v132
    ds_read_b128 v[120:123], v134 offset:14336
    v_exp_f32 v32, v32
    v_exp_f32 v33, v33
    v_smfmac_f32_32x32x32_bf16 v[136:151], v[108:111], v[24:31], v132
    s_waitcnt lgkmcnt(1)
    v_exp_f32 v34, v34
    v_exp_f32 v35, v35
    v_exp_f32 v36, v36
    v_smfmac_f32_16x16x64_bf16 v[168:171], v[128:131], v[24:31], v132
    ds_read_b128 v[124:127], v134 offset:15360
    v_exp_f32 v37, v37
    v_exp_f32 v38, v38
    v_mfma_f32_32x32x16_bf16 v[16:31], v[112:115], v[80:83], v[48:63]
    v_exp_f32 v39, v39
    v_exp_f32 v40, v40
    v_exp_f32 v41, v41
    v_mfma_f32_32x32x16_bf16 v[16:31], v[116:119], v[84:87], v[16:31]
    s_nop 0
    v_exp_f32 v42, v42
    v_exp_f32 v43, v43
    v_exp_f32 v44, v44
    v_smfmac_f32_32x32x32_bf16 v[152:167], v[104:107], v[32:39], v132
    s_nop 1
    v_exp_f32 v45, v45
    v_exp_f32 v46, v46
    v_exp_f32 v47, v47
    v_smfmac_f32_16x16x64_bf16 v[172:175], v[128:131], v[32:39], v132
    ds_read_b128 v[96:99], v134 offset:16384
    v_exp_f32 v16, v16
    v_exp_f32 v17, v17
    v_smfmac_f32_32x32x32_bf16 v[152:167], v[108:111], v[40:47], v132
    s_waitcnt lgkmcnt(1)
    v_exp_f32 v18, v18
    v_exp_f32 v19, v19
    v_exp_f32 v20, v20
    v_smfmac_f32_16x16x64_bf16 v[172:175], v[128:131], v[40:47], v132
    ds_read_b128 v[100:103], v134 offset:17408
    v_exp_f32 v21, v21
    v_exp_f32 v22, v22
    v_mfma_f32_32x32x16_bf16 v[32:47], v[112:115], v[88:91], v[64:79]
    v_exp_f32 v23, v23
    v_exp_f32 v24, v24
    v_exp_f32 v25, v25
    v_mfma_f32_32x32x16_bf16 v[32:47], v[116:119], v[92:95], v[32:47]
    s_nop 0
    v_exp_f32 v26, v26
    v_exp_f32 v27, v27
    v_exp_f32 v28, v28
    v_smfmac_f32_32x32x32_bf16 v[136:151], v[120:123], v[16:23], v132
    s_nop 1
    v_exp_f32 v29, v29
    v_exp_f32 v30, v30
    v_exp_f32 v31, v31
    v_smfmac_f32_16x16x64_bf16 v[168:171], v[128:131], v[16:23], v132
    ds_read_b128 v[104:107], v134 offset:18432
    v_exp_f32 v32, v32
    v_exp_f32 v33, v33
    v_smfmac_f32_32x32x32_bf16 v[136:151], v[124:127], v[24:31], v132
    s_waitcnt lgkmcnt(1)
    v_exp_f32 v34, v34
    v_exp_f32 v35, v35
    v_exp_f32 v36, v36
    v_smfmac_f32_16x16x64_bf16 v[168:171], v[128:131], v[24:31], v132
    ds_read_b128 v[108:111], v134 offset:19456
    v_exp_f32 v37, v37
    v_exp_f32 v38, v38
    v_mfma_f32_32x32x16_bf16 v[16:31], v[96:99], v[80:83], v[48:63]
    v_exp_f32 v39, v39
    v_exp_f32 v40, v40
    v_exp_f32 v41, v41
    v_mfma_f32_32x32x16_bf16 v[16:31], v[100:103], v[84:87], v[16:31]
    s_nop 0
    v_exp_f32 v42, v42
    v_exp_f32 v43, v43
    v_exp_f32 v44, v44
    v_smfmac_f32_32x32x32_bf16 v[152:167], v[120:123], v[32:39], v132
    s_nop 1
    v_exp_f32 v45, v45
    v_exp_f32 v46, v46
    v_exp_f32 v47, v47
    v_smfmac_f32_16x16x64_bf16 v[172:175], v[128:131], v[32:39], v132
    ds_read_b128 v[112:115], v134 offset:20480
    v_exp_f32 v16, v16
    v_exp_f32 v17, v17
    v_smfmac_f32_32x32x32_bf16 v[152:167], v[124:127], v[40:47], v132
    s_waitcnt lgkmcnt(1)
    v_exp_f32 v18, v18
    v_exp_f32 v19, v19
    v_exp_f32 v20, v20
    v_smfmac_f32_16x16x64_bf16 v[172:175], v[128:131], v[40:47], v132
    ds_read_b128 v[116:119], v134 offset:21504
    v_exp_f32 v21, v21
    v_exp_f32 v22, v22
    v_mfma_f32_32x32x16_bf16 v[32:47], v[96:99], v[88:91], v[64:79]
    v_exp_f32 v23, v23
    v_exp_f32 v24, v24
    v_exp_f32 v25, v25
    v_mfma_f32_32x32x16_bf16 v[32:47], v[100:103], v[92:95], v[32:47]
    s_nop 0
    v_exp_f32 v26, v26
    v_exp_f32 v27, v27
    v_exp_f32 v28, v28
    v_smfmac_f32_32x32x32_bf16 v[136:151], v[104:107], v[16:23], v132
    s_nop 1
    v_exp_f32 v29, v29
    v_exp_f32 v30, v30
    v_exp_f32 v31, v31
    v_smfmac_f32_16x16x64_bf16 v[168:171], v[128:131], v[16:23], v132
    ds_read_b128 v[120:123], v134 offset:22528
    v_exp_f32 v32, v32
    v_exp_f32 v33, v33
    v_smfmac_f32_32x32x32_bf16 v[136:151], v[108:111], v[24:31], v132
    s_waitcnt lgkmcnt(1)
    v_exp_f32 v34, v34
    v_exp_f32 v35, v35
    v_exp_f32 v36, v36
    v_smfmac_f32_16x16x64_bf16 v[168:171], v[128:131], v[24:31], v132
    ds_read_b128 v[124:127], v134 offset:23552
    v_exp_f32 v37, v37
    v_exp_f32 v38, v38
    v_mfma_f32_32x32x16_bf16 v[16:31], v[112:115], v[80:83], v[48:63]
    v_exp_f32 v39, v39
    v_exp_f32 v40, v40
    v_exp_f32 v41, v41
    v_mfma_f32_32x32x16_bf16 v[16:31], v[116:119], v[84:87], v[16:31]
    s_nop 0
    v_exp_f32 v42, v42
    v_exp_f32 v43, v43
    v_exp_f32 v44, v44
    v_smfmac_f32_32x32x32_bf16 v[152:167], v[104:107], v[32:39], v132
    s_nop 1
    v_exp_f32 v45, v45
    v_exp_f32 v46, v46
    v_exp_f32 v47, v47
    v_smfmac_f32_16x16x64_bf16 v[172:175], v[128:131], v[32:39], v132
    ds_read_b128 v[96:99], v134 offset:24576
    v_exp_f32 v16, v16
    v_exp_f32 v17, v17
    v_smfmac_f32_32x32x32_bf16 v[152:167], v[108:111], v[40:47], v132
    s_waitcnt lgkmcnt(1)
    v_exp_f32 v18, v18
    v_exp_f32 v19, v19
    v_exp_f32 v20, v20
    v_smfmac_f32_16x16x64_bf16 v[172:175], v[128:131], v[40:47], v132
    ds_read_b128 v[100:103], v134 offset:25600
    v_exp_f32 v21, v21
    v_exp_f32 v22, v22
    v_mfma_f32_32x32x16_bf16 v[32:47], v[112:115], v[88:91], v[64:79]
    v_exp_f32 v23, v23
    v_exp_f32 v24, v24
    v_exp_f32 v25, v25
    v_mfma_f32_32x32x16_bf16 v[32:47], v[116:119], v[92:95], v[32:47]
    s_nop 0
    v_exp_f32 v26, v26
    v_exp_f32 v27, v27
    v_exp_f32 v28, v28
    v_smfmac_f32_32x32x32_bf16 v[136:151], v[120:123], v[16:23], v132
    s_nop 1
    v_exp_f32 v29, v29
    v_exp_f32 v30, v30
    v_exp_f32 v31, v31
    v_smfmac_f32_16x16x64_bf16 v[168:171], v[128:131], v[16:23], v132
    ds_read_b128 v[104:107], v134 offset:26624
    v_exp_f32 v32, v32
    v_exp_f32 v33, v33
    v_smfmac_f32_32x32x32_bf16 v[136:151], v[124:127], v[24:31], v132
    s_waitcnt lgkmcnt(1)
    v_exp_f32 v34, v34
    v_exp_f32 v35, v35
    v_exp_f32 v36, v36
    v_smfmac_f32_16x16x64_bf16 v[168:171], v[128:131], v[24:31], v132
    ds_read_b128 v[108:111], v134 offset:27648
    v_exp_f32 v37, v37
    v_exp_f32 v38, v38
    v_mfma_f32_32x32x16_bf16 v[16:31], v[96:99], v[80:83], v[48:63]
    v_exp_f32 v39, v39
    v_exp_f32 v40, v40
    v_exp_f32 v41, v41
    v_mfma_f32_32x32x16_bf16 v[16:31], v[100:103], v[84:87], v[16:31]
    s_nop 0
    v_exp_f32 v42, v42
    v_exp_f32 v43, v43
    v_exp_f32 v44, v44
    v_smfmac_f32_32x32x32_bf16 v[152:167], v[120:123], v[32:39], v132
    s_nop 1
    v_exp_f32 v45, v45
    v_exp_f32 v46, v46
    v_exp_f32 v47, v47
    v_smfmac_f32_16x16x64_bf16 v[172:175], v[128:131], v[32:39], v132
    ds_read_b128 v[112:115], v134 offset:28672
    v_exp_f32 v16, v16
    v_exp_f32 v17, v17
    v_smfmac_f32_32x32x32_bf16 v[152:167], v[124:127], v[40:47], v132
    s_waitcnt lgkmcnt(1)
    v_exp_f32 v18, v18
    v_exp_f32 v19, v19
    v_exp_f32 v20, v20
    v_smfmac_f32_16x16x64_bf16 v[172:175], v[128:131], v[40:47], v132
    ds_read_b128 v[116:119], v134 offset:29696
    v_exp_f32 v21, v21
    v_exp_f32 v22, v22
    v_mfma_f32_32x32x16_bf16 v[32:47], v[96:99], v[88:91], v[64:79]
    v_exp_f32 v23, v23
    v_exp_f32 v24, v24
    v_exp_f32 v25, v25
    v_mfma_f32_32x32x16_bf16 v[32:47], v[100:103], v[92:95], v[32:47]
    s_nop 0
    v_exp_f32 v26, v26
    v_exp_f32 v27, v27
    v_exp_f32 v28, v28
    v_smfmac_f32_32x32x32_bf16 v[136:151], v[104:107], v[16:23], v132
    s_nop 1
    v_exp_f32 v29, v29
    v_exp_f32 v30, v30
    v_exp_f32 v31, v31
    v_smfmac_f32_16x16x64_bf16 v[168:171], v[128:131], v[16:23], v132
    ds_read_b128 v[120:123], v134 offset:30720
    v_exp_f32 v32, v32
    v_exp_f32 v33, v33
    v_smfmac_f32_32x32x32_bf16 v[136:151], v[108:111], v[24:31], v132
    s_waitcnt lgkmcnt(1)
    v_exp_f32 v34, v34
    v_exp_f32 v35, v35
    v_exp_f32 v36, v36
    v_smfmac_f32_16x16x64_bf16 v[168:171], v[128:131], v[24:31], v132
    ds_read_b128 v[124:127], v134 offset:31744
    v_exp_f32 v37, v37
    v_exp_f32 v38, v38
    v_mfma_f32_32x32x16_bf16 v[16:31], v[112:115], v[80:83], v[48:63]
    v_exp_f32 v39, v39
    v_exp_f32 v40, v40
    v_exp_f32 v41, v41
    v_mfma_f32_32x32x16_bf16 v[16:31], v[116:119], v[84:87], v[16:31]
    s_nop 0
    v_exp_f32 v42, v42
    v_exp_f32 v43, v43
    v_exp_f32 v44, v44
    v_smfmac_f32_32x32x32_bf16 v[152:167], v[104:107], v[32:39], v132
    s_waitcnt lgkmcnt(0)
    s_barrier
    v_exp_f32 v45, v45
    v_exp_f32 v46, v46
    v_exp_f32 v47, v47
    v_smfmac_f32_16x16x64_bf16 v[172:175], v[128:131], v[32:39], v132
    ds_read_b128 v[96:99], v134 offset:32768
    v_exp_f32 v16, v16
    v_exp_f32 v17, v17
    v_smfmac_f32_32x32x32_bf16 v[152:167], v[108:111], v[40:47], v132
    s_nop 0
    v_exp_f32 v18, v18
    v_exp_f32 v19, v19
    v_exp_f32 v20, v20
    v_smfmac_f32_16x16x64_bf16 v[172:175], v[128:131], v[40:47], v132
    ds_read_b128 v[100:103], v134 offset:33792
    v_exp_f32 v21, v21
    v_exp_f32 v22, v22
    v_mfma_f32_32x32x16_bf16 v[32:47], v[112:115], v[88:91], v[64:79]
    v_exp_f32 v23, v23
    v_exp_f32 v24, v24
    v_exp_f32 v25, v25
    v_mfma_f32_32x32x16_bf16 v[32:47], v[116:119], v[92:95], v[32:47]
    s_nop 0
    v_exp_f32 v26, v26
    v_exp_f32 v27, v27
    v_exp_f32 v28, v28
    v_smfmac_f32_32x32x32_bf16 v[136:151], v[120:123], v[16:23], v132
    s_nop 1
    v_exp_f32 v29, v29
    v_exp_f32 v30, v30
    v_exp_f32 v31, v31
    v_smfmac_f32_16x16x64_bf16 v[168:171], v[128:131], v[16:23], v132
    ds_read_b128 v[104:107], v134 offset:34816
    v_exp_f32 v32, v32
    v_exp_f32 v33, v33
    v_smfmac_f32_32x32x32_bf16 v[136:151], v[124:127], v[24:31], v132
    s_waitcnt lgkmcnt(1)
    v_exp_f32 v34, v34
    v_exp_f32 v35, v35
    v_exp_f32 v36, v36
    v_smfmac_f32_16x16x64_bf16 v[168:171], v[128:131], v[24:31], v132
    ds_read_b128 v[108:111], v134 offset:35840
    v_exp_f32 v37, v37
    v_exp_f32 v38, v38
    v_mfma_f32_32x32x16_bf16 v[16:31], v[96:99], v[80:83], v[48:63]
    v_exp_f32 v39, v39
    v_exp_f32 v40, v40
    v_exp_f32 v41, v41
    v_mfma_f32_32x32x16_bf16 v[16:31], v[100:103], v[84:87], v[16:31]
    s_nop 0
    v_exp_f32 v42, v42
    v_exp_f32 v43, v43
    v_exp_f32 v44, v44
    v_smfmac_f32_32x32x32_bf16 v[152:167], v[120:123], v[32:39], v132
    s_nop 1
    v_exp_f32 v45, v45
    v_exp_f32 v46, v46
    v_exp_f32 v47, v47
    v_smfmac_f32_16x16x64_bf16 v[172:175], v[128:131], v[32:39], v132
    ds_read_b128 v[112:115], v134 offset:36864
    v_exp_f32 v16, v16
    v_exp_f32 v17, v17
    v_smfmac_f32_32x32x32_bf16 v[152:167], v[124:127], v[40:47], v132
    s_waitcnt lgkmcnt(1)
    v_exp_f32 v18, v18
    v_exp_f32 v19, v19
    v_exp_f32 v20, v20
    v_smfmac_f32_16x16x64_bf16 v[172:175], v[128:131], v[40:47], v132
    ds_read_b128 v[116:119], v134 offset:37888
    v_exp_f32 v21, v21
    v_exp_f32 v22, v22
    v_mfma_f32_32x32x16_bf16 v[32:47], v[96:99], v[88:91], v[64:79]
    v_exp_f32 v23, v23
    v_exp_f32 v24, v24
    v_exp_f32 v25, v25
    v_mfma_f32_32x32x16_bf16 v[32:47], v[100:103], v[92:95], v[32:47]
    s_nop 0
    v_exp_f32 v26, v26
    v_exp_f32 v27, v27
    v_exp_f32 v28, v28
    v_smfmac_f32_32x32x32_bf16 v[136:151], v[104:107], v[16:23], v132
    s_nop 1
    v_exp_f32 v29, v29
    v_exp_f32 v30, v30
    v_exp_f32 v31, v31
    v_smfmac_f32_16x16x64_bf16 v[168:171], v[128:131], v[16:23], v132
    ds_read_b128 v[120:123], v134 offset:38912
    v_exp_f32 v32, v32
    v_exp_f32 v33, v33
    v_smfmac_f32_32x32x32_bf16 v[136:151], v[108:111], v[24:31], v132
    s_waitcnt lgkmcnt(1)
    v_exp_f32 v34, v34
    v_exp_f32 v35, v35
    v_exp_f32 v36, v36
    v_smfmac_f32_16x16x64_bf16 v[168:171], v[128:131], v[24:31], v132
    ds_read_b128 v[124:127], v134 offset:39936
    v_exp_f32 v37, v37
    v_exp_f32 v38, v38
    v_mfma_f32_32x32x16_bf16 v[16:31], v[112:115], v[80:83], v[48:63]
    v_exp_f32 v39, v39
    v_exp_f32 v40, v40
    v_exp_f32 v41, v41
    v_mfma_f32_32x32x16_bf16 v[16:31], v[116:119], v[84:87], v[16:31]
L_pg4:
    s_cbranch_execz L_pgret
    s_nop 0
    v_exp_f32 v42, v42
    v_exp_f32 v43, v43
    v_exp_f32 v44, v44
    v_smfmac_f32_32x32x32_bf16 v[152:167], v[104:107], v[32:39], v132
    s_nop 1
    v_exp_f32 v45, v45
    v_exp_f32 v46, v46
    v_exp_f32 v47, v47
    v_smfmac_f32_16x16x64_bf16 v[172:175], v[128:131], v[32:39], v132
    ds_read_b128 v[96:99], v134 offset:40960
    v_exp_f32 v16, v16
    v_exp_f32 v17, v17
    v_smfmac_f32_32x32x32_bf16 v[152:167], v[108:111], v[40:47], v132
    s_waitcnt lgkmcnt(1)
    v_exp_f32 v18, v18
    v_exp_f32 v19, v19
    v_exp_f32 v20, v20
    v_smfmac_f32_16x16x64_bf16 v[172:175], v[128:131], v[40:47], v132
    ds_read_b128 v[100:103], v134 offset:41984
    v_exp_f32 v21, v21
    v_exp_f32 v22, v22
    v_mfma_f32_32x32x16_bf16 v[32:47], v[112:115], v[88:91], v[64:79]
    v_exp_f32 v23, v23
    v_exp_f32 v24, v24
    v_exp_f32 v25, v25
    v_mfma_f32_32x32x16_bf16 v[32:47], v[116:119], v[92:95], v[32:47]
    s_nop 0
    v_exp_f32 v26, v26
    v_exp_f32 v27, v27
    v_exp_f32 v28, v28
    v_smfmac_f32_32x32x32_bf16 v[136:151], v[120:123], v[16:23], v132
    s_nop 1
    v_exp_f32 v29, v29
    v_exp_f32 v30, v30
    v_exp_f32 v31, v31
    v_smfmac_f32_16x16x64_bf16 v[168:171], v[128:131], v[16:23], v132
    ds_read_b128 v[104:107], v134 offset:43008
    v_exp_f32 v32, v32
    v_exp_f32 v33, v33
    v_smfmac_f32_32x32x32_bf16 v[136:151], v[124:127], v[24:31], v132
    s_waitcnt lgkmcnt(1)
    v_exp_f32 v34, v34
    v_exp_f32 v35, v35
    v_exp_f32 v36, v36
    v_smfmac_f32_16x16x64_bf16 v[168:171], v[128:131], v[24:31], v132
    ds_read_b128 v[108:111], v134 offset:44032
    v_exp_f32 v37, v37
    v_exp_f32 v38, v38
    v_mfma_f32_32x32x16_bf16 v[16:31], v[96:99], v[80:83], v[48:63]
    v_exp_f32 v39, v39
    v_exp_f32 v40, v40
    v_exp_f32 v41, v41
    v_mfma_f32_32x32x16_bf16 v[16:31], v[100:103], v[84:87], v[16:31]
    s_nop 0
    v_exp_f32 v42, v42
    v_exp_f32 v43, v43
    v_exp_f32 v44, v44
    v_smfmac_f32_32x32x32_bf16 v[152:167], v[120:123], v[32:39], v132
    s_nop 1
    v_exp_f32 v45, v45
    v_exp_f32 v46, v46
    v_exp_f32 v47, v47
    v_smfmac_f32_16x16x64_bf16 v[172:175], v[128:131], v[32:39], v132
    ds_read_b128 v[112:115], v134 offset:45056
    v_exp_f32 v16, v16
    v_exp_f32 v17, v17
    v_smfmac_f32_32x32x32_bf16 v[152:167], v[124:127], v[40:47], v132
    s_waitcnt lgkmcnt(1)
    v_exp_f32 v18, v18
    v_exp_f32 v19, v19
    v_exp_f32 v20, v20
    v_smfmac_f32_16x16x64_bf16 v[172:175], v[128:131], v[40:47], v132
    ds_read_b128 v[116:119], v134 offset:46080
    v_exp_f32 v21, v21
    v_exp_f32 v22, v22
    v_mfma_f32_32x32x16_bf16 v[32:47], v[96:99], v[88:91], v[64:79]
    v_exp_f32 v23, v23
    v_exp_f32 v24, v24
    v_exp_f32 v25, v25
    v_mfma_f32_32x32x16_bf16 v[32:47], v[100:103], v[92:95], v[32:47]
    s_nop 0
    v_exp_f32 v26, v26
    v_exp_f32 v27, v27
    v_exp_f32 v28, v28
    v_smfmac_f32_32x32x32_bf16 v[136:151], v[104:107], v[16:23], v132
    s_nop 1
    v_exp_f32 v29, v29
    v_exp_f32 v30, v30
    v_exp_f32 v31, v31
    v_smfmac_f32_16x16x64_bf16 v[168:171], v[128:131], v[16:23], v132
    ds_read_b128 v[120:123], v134 offset:47104
    v_exp_f32 v32, v32
    v_exp_f32 v33, v33
    v_smfmac_f32_32x32x32_bf16 v[136:151], v[108:111], v[24:31], v132
    s_waitcnt lgkmcnt(1)
    v_exp_f32 v34, v34
    v_exp_f32 v35, v35
    v_exp_f32 v36, v36
    v_smfmac_f32_16x16x64_bf16 v[168:171], v[128:131], v[24:31], v132
    ds_read_b128 v[124:127], v134 offset:48128
    v_exp_f32 v37, v37
    v_exp_f32 v38, v38
    v_mfma_f32_32x32x16_bf16 v[16:31], v[112:115], v[80:83], v[48:63]
    v_exp_f32 v39, v39
    v_exp_f32 v40, v40
    v_exp_f32 v41, v41
    v_mfma_f32_32x32x16_bf16 v[16:31], v[116:119], v[84:87], v[16:31]
    s_nop 0
    v_exp_f32 v42, v42
    v_exp_f32 v43, v43
    v_exp_f32 v44, v44
    v_smfmac_f32_32x32x32_bf16 v[152:167], v[104:107], v[32:39], v132
    s_nop 1
    v_exp_f32 v45, v45
    v_exp_f32 v46, v46
    v_exp_f32 v47, v47
    v_smfmac_f32_16x16x64_bf16 v[172:175], v[128:131], v[32:39], v132
    ds_read_b128 v[96:99], v134 offset:49152
    v_exp_f32 v16, v16
    v_exp_f32 v17, v17
    v_smfmac_f32_32x32x32_bf16 v[152:167], v[108:111], v[40:47], v132
    s_waitcnt lgkmcnt(1)
    v_exp_f32 v18, v18
    v_exp_f32 v19, v19
    v_exp_f32 v20, v20
    v_smfmac_f32_16x16x64_bf16 v[172:175], v[128:131], v[40:47], v132
    ds_read_b128 v[100:103], v134 offset:50176
    v_exp_f32 v21, v21
    v_exp_f32 v22, v22
    v_mfma_f32_32x32x16_bf16 v[32:47], v[112:115], v[88:91], v[64:79]
    v_exp_f32 v23, v23
    v_exp_f32 v24, v24
    v_exp_f32 v25, v25
    v_mfma_f32_32x32x16_bf16 v[32:47], v[116:119], v[92:95], v[32:47]
    s_nop 0
    v_exp_f32 v26, v26
    v_exp_f32 v27, v27
    v_exp_f32 v28, v28
    v_smfmac_f32_32x32x32_bf16 v[136:151], v[120:123], v[16:23], v132
    s_nop 1
    v_exp_f32 v29, v29
    v_exp_f32 v30, v30
    v_exp_f32 v31, v31
    v_smfmac_f32_16x16x64_bf16 v[168:171], v[128:131], v[16:23], v132
    ds_read_b128 v[104:107], v134 offset:51200
    v_exp_f32 v32, v32
    v_exp_f32 v33, v33
    v_smfmac_f32_32x32x32_bf16 v[136:151], v[124:127], v[24:31], v132
    s_waitcnt lgkmcnt(1)
    v_exp_f32 v34, v34
    v_exp_f32 v35, v35
    v_exp_f32 v36, v36
    v_smfmac_f32_16x16x64_bf16 v[168:171], v[128:131], v[24:31], v132
    ds_read_b128 v[108:111], v134 offset:52224
    v_exp_f32 v37, v37
    v_exp_f32 v38, v38
    v_mfma_f32_32x32x16_bf16 v[16:31], v[96:99], v[80:83], v[48:63]
    v_exp_f32 v39, v39
    v_exp_f32 v40, v40
    v_exp_f32 v41, v41
    v_mfma_f32_32x32x16_bf16 v[16:31], v[100:103], v[84:87], v[16:31]
    s_nop 0
    v_exp_f32 v42, v42
    v_exp_f32 v43, v43
    v_exp_f32 v44, v44
    v_smfmac_f32_32x32x32_bf16 v[152:167], v[120:123], v[32:39], v132
    s_nop 1
    v_exp_f32 v45, v45
    v_exp_f32 v46, v46
    v_exp_f32 v47, v47
    v_smfmac_f32_16x16x64_bf16 v[172:175], v[128:131], v[32:39], v132
    ds_read_b128 v[112:115], v134 offset:53248
    v_exp_f32 v16, v16
    v_exp_f32 v17, v17
    v_smfmac_f32_32x32x32_bf16 v[152:167], v[124:127], v[40:47], v132
    s_waitcnt lgkmcnt(1)
    v_exp_f32 v18, v18
    v_exp_f32 v19, v19
    v_exp_f32 v20, v20
    v_smfmac_f32_16x16x64_bf16 v[172:175], v[128:131], v[40:47], v132
    ds_read_b128 v[116:119], v134 offset:54272
    v_exp_f32 v21, v21
    v_exp_f32 v22, v22
    v_mfma_f32_32x32x16_bf16 v[32:47], v[96:99], v[88:91], v[64:79]
    v_exp_f32 v23, v23
    v_exp_f32 v24, v24
    v_exp_f32 v25, v25
    v_mfma_f32_32x32x16_bf16 v[32:47], v[100:103], v[92:95], v[32:47]
    s_nop 0
    v_exp_f32 v26, v26
    v_exp_f32 v27, v27
    v_exp_f32 v28, v28
    v_smfmac_f32_32x32x32_bf16 v[136:151], v[104:107], v[16:23], v132
    s_nop 1
    v_exp_f32 v29, v29
    v_exp_f32 v30, v30
    v_exp_f32 v31, v31
    v_smfmac_f32_16x16x64_bf16 v[168:171], v[128:131], v[16:23], v132
    ds_read_b128 v[120:123], v134 offset:55296
    v_exp_f32 v32, v32
    v_exp_f32 v33, v33
    v_smfmac_f32_32x32x32_bf16 v[136:151], v[108:111], v[24:31], v132
    s_waitcnt lgkmcnt(1)
    v_exp_f32 v34, v34
    v_exp_f32 v35, v35
    v_exp_f32 v36, v36
    v_smfmac_f32_16x16x64_bf16 v[168:171], v[128:131], v[24:31], v132
    ds_read_b128 v[124:127], v134 offset:56320
    v_exp_f32 v37, v37
    v_exp_f32 v38, v38
    v_mfma_f32_32x32x16_bf16 v[16:31], v[112:115], v[80:83], v[48:63]
    v_exp_f32 v39, v39
    v_exp_f32 v40, v40
    v_exp_f32 v41, v41
    v_mfma_f32_32x32x16_bf16 v[16:31], v[116:119], v[84:87], v[16:31]
    s_nop 0
    v_exp_f32 v42, v42
    v_exp_f32 v43, v43
    v_exp_f32 v44, v44
    v_smfmac_f32_32x32x32_bf16 v[152:167], v[104:107], v[32:39], v132
    s_nop 1
    v_exp_f32 v45, v45
    v_exp_f32 v46, v46
    v_exp_f32 v47, v47
    v_smfmac_f32_16x16x64_bf16 v[172:175], v[128:131], v[32:39], v132
    ds_read_b128 v[96:99], v134 offset:57344
    v_exp_f32 v16, v16
    v_exp_f32 v17, v17
    v_smfmac_f32_32x32x32_bf16 v[152:167], v[108:111], v[40:47], v132
    s_waitcnt lgkmcnt(1)
    v_exp_f32 v18, v18
    v_exp_f32 v19, v19
    v_exp_f32 v20, v20
    v_smfmac_f32_16x16x64_bf16 v[172:175], v[128:131], v[40:47], v132
    ds_read_b128 v[100:103], v134 offset:58368
    v_exp_f32 v21, v21
    v_exp_f32 v22, v22
    v_mfma_f32_32x32x16_bf16 v[32:47], v[112:115], v[88:91], v[64:79]
    v_exp_f32 v23, v23
    v_exp_f32 v24, v24
    v_exp_f32 v25, v25
    v_mfma_f32_32x32x16_bf16 v[32:47], v[116:119], v[92:95], v[32:47]
    s_nop 0
    v_exp_f32 v26, v26
    v_exp_f32 v27, v27
    v_exp_f32 v28, v28
    v_smfmac_f32_32x32x32_bf16 v[136:151], v[120:123], v[16:23], v132
    s_nop 1
    v_exp_f32 v29, v29
    v_exp_f32 v30, v30
    v_exp_f32 v31, v31
    v_smfmac_f32_16x16x64_bf16 v[168:171], v[128:131], v[16:23], v132
    ds_read_b128 v[104:107], v134 offset:59392
    v_exp_f32 v32, v32
    v_exp_f32 v33, v33
    v_smfmac_f32_32x32x32_bf16 v[136:151], v[124:127], v[24:31], v132
    s_waitcnt lgkmcnt(1)
    v_exp_f32 v34, v34
    v_exp_f32 v35, v35
    v_exp_f32 v36, v36
    v_smfmac_f32_16x16x64_bf16 v[168:171], v[128:131], v[24:31], v132
    ds_read_b128 v[108:111], v134 offset:60416
    v_exp_f32 v37, v37
    v_exp_f32 v38, v38
    v_mfma_f32_32x32x16_bf16 v[16:31], v[96:99], v[80:83], v[48:63]
    v_exp_f32 v39, v39
    v_exp_f32 v40, v40
    v_exp_f32 v41, v41
    v_mfma_f32_32x32x16_bf16 v[16:31], v[100:103], v[84:87], v[16:31]
    s_nop 0
    v_exp_f32 v42, v42
    v_exp_f32 v43, v43
    v_exp_f32 v44, v44
    v_smfmac_f32_32x32x32_bf16 v[152:167], v[120:123], v[32:39], v132
    s_nop 1
    v_exp_f32 v45, v45
    v_exp_f32 v46, v46
    v_exp_f32 v47, v47
    v_smfmac_f32_16x16x64_bf16 v[172:175], v[128:131], v[32:39], v132
    ds_read_b128 v[112:115], v134 offset:61440
    v_exp_f32 v16, v16
    v_exp_f32 v17, v17
    v_smfmac_f32_32x32x32_bf16 v[152:167], v[124:127], v[40:47], v132
    s_waitcnt lgkmcnt(1)
    v_exp_f32 v18, v18
    v_exp_f32 v19, v19
    v_exp_f32 v20, v20
    v_smfmac_f32_16x16x64_bf16 v[172:175], v[128:131], v[40:47], v132
    ds_read_b128 v[116:119], v134 offset:62464
    v_exp_f32 v21, v21
    v_exp_f32 v22, v22
    v_mfma_f32_32x32x16_bf16 v[32:47], v[96:99], v[88:91], v[64:79]
    v_exp_f32 v23, v23
    v_exp_f32 v24, v24
    v_exp_f32 v25, v25
    v_mfma_f32_32x32x16_bf16 v[32:47], v[100:103], v[92:95], v[32:47]
    s_nop 0
    v_exp_f32 v26, v26
    v_exp_f32 v27, v27
    v_exp_f32 v28, v28
    v_smfmac_f32_32x32x32_bf16 v[136:151], v[104:107], v[16:23], v132
    s_nop 1
    v_exp_f32 v29, v29
    v_exp_f32 v30, v30
    v_exp_f32 v31, v31
    v_smfmac_f32_16x16x64_bf16 v[168:171], v[128:131], v[16:23], v132
    ds_read_b128 v[120:123], v134 offset:63488
    v_exp_f32 v32, v32
    v_exp_f32 v33, v33
    v_smfmac_f32_32x32x32_bf16 v[136:151], v[108:111], v[24:31], v132
    s_waitcnt lgkmcnt(1)
    v_exp_f32 v34, v34
    v_exp_f32 v35, v35
    v_exp_f32 v36, v36
    v_smfmac_f32_16x16x64_bf16 v[168:171], v[128:131], v[24:31], v132
    ds_read_b128 v[124:127], v134 offset:64512
    v_exp_f32 v37, v37
    v_exp_f32 v38, v38
    v_mfma_f32_32x32x16_bf16 v[16:31], v[112:115], v[80:83], v[48:63]
    v_exp_f32 v39, v39
    v_exp_f32 v40, v40
    v_exp_f32 v41, v41
    v_mfma_f32_32x32x16_bf16 v[16:31], v[116:119], v[84:87], v[16:31]
    s_nop 0
    v_exp_f32 v42, v42
    v_exp_f32 v43, v43
    v_exp_f32 v44, v44
    v_smfmac_f32_32x32x32_bf16 v[152:167], v[104:107], v[32:39], v132
    s_waitcnt lgkmcnt(0)
    s_barrier
    v_exp_f32 v45, v45
    v_exp_f32 v46, v46
    v_exp_f32 v47, v47
    v_smfmac_f32_16x16x64_bf16 v[172:175], v[128:131], v[32:39], v132
    ds_read_b128 v[96:99], v135 offset:0
    v_exp_f32 v16, v16
    v_exp_f32 v17, v17
    v_smfmac_f32_32x32x32_bf16 v[152:167], v[108:111], v[40:47], v132
    s_nop 0
    v_exp_f32 v18, v18
    v_exp_f32 v19, v19
    v_exp_f32 v20, v20
    v_smfmac_f32_16x16x64_bf16 v[172:175], v[128:131], v[40:47], v132
    ds_read_b128 v[100:103], v135 offset:1024
    v_exp_f32 v21, v21
    v_exp_f32 v22, v22
    v_mfma_f32_32x32x16_bf16 v[32:47], v[112:115], v[88:91], v[64:79]
    v_exp_f32 v23, v23
    v_exp_f32 v24, v24
    v_exp_f32 v25, v25
    v_mfma_f32_32x32x16_bf16 v[32:47], v[116:119], v[92:95], v[32:47]
    s_nop 0
    v_exp_f32 v26, v26
    v_exp_f32 v27, v27
    v_exp_f32 v28, v28
    v_smfmac_f32_32x32x32_bf16 v[136:151], v[120:123], v[16:23], v132
    s_nop 1
    v_exp_f32 v29, v29
    v_exp_f32 v30, v30
    v_exp_f32 v31, v31
    v_smfmac_f32_16x16x64_bf16 v[168:171], v[128:131], v[16:23], v132
    ds_read_b128 v[104:107], v135 offset:2048
    v_exp_f32 v32, v32
    v_exp_f32 v33, v33
    v_smfmac_f32_32x32x32_bf16 v[136:151], v[124:127], v[24:31], v132
    s_waitcnt lgkmcnt(1)
    v_exp_f32 v34, v34
    v_exp_f32 v35, v35
    v_exp_f32 v36, v36
    v_smfmac_f32_16x16x64_bf16 v[168:171], v[128:131], v[24:31], v132
    ds_read_b128 v[108:111], v135 offset:3072
    v_exp_f32 v37, v37
    v_exp_f32 v38, v38
    v_mfma_f32_32x32x16_bf16 v[16:31], v[96:99], v[80:83], v[48:63]
    v_exp_f32 v39, v39
    v_exp_f32 v40, v40
    v_exp_f32 v41, v41
    v_mfma_f32_32x32x16_bf16 v[16:31], v[100:103], v[84:87], v[16:31]
    s_nop 0
    v_exp_f32 v42, v42
    v_exp_f32 v43, v43
    v_exp_f32 v44, v44
    v_smfmac_f32_32x32x32_bf16 v[152:167], v[120:123], v[32:39], v132
    s_nop 1
    v_exp_f32 v45, v45
    v_exp_f32 v46, v46
    v_exp_f32 v47, v47
    v_smfmac_f32_16x16x64_bf16 v[172:175], v[128:131], v[32:39], v132
    ds_read_b128 v[112:115], v135 offset:4096
    v_exp_f32 v16, v16
    v_exp_f32 v17, v17
    v_smfmac_f32_32x32x32_bf16 v[152:167], v[124:127], v[40:47], v132
    s_waitcnt lgkmcnt(1)
    v_exp_f32 v18, v18
    v_exp_f32 v19, v19
    v_exp_f32 v20, v20
    v_smfmac_f32_16x16x64_bf16 v[172:175], v[128:131], v[40:47], v132
    ds_read_b128 v[116:119], v135 offset:5120
    v_exp_f32 v21, v21
    v_exp_f32 v22, v22
    v_mfma_f32_32x32x16_bf16 v[32:47], v[96:99], v[88:91], v[64:79]
    v_exp_f32 v23, v23
    v_exp_f32 v24, v24
    v_exp_f32 v25, v25
    v_mfma_f32_32x32x16_bf16 v[32:47], v[100:103], v[92:95], v[32:47]
    s_nop 0
    v_exp_f32 v26, v26
    v_exp_f32 v27, v27
    v_exp_f32 v28, v28
    v_smfmac_f32_32x32x32_bf16 v[136:151], v[104:107], v[16:23], v132
    s_nop 1
    v_exp_f32 v29, v29
    v_exp_f32 v30, v30
    v_exp_f32 v31, v31
    v_smfmac_f32_16x16x64_bf16 v[168:171], v[128:131], v[16:23], v132
    ds_read_b128 v[120:123], v135 offset:6144
    v_exp_f32 v32, v32
    v_exp_f32 v33, v33
    v_smfmac_f32_32x32x32_bf16 v[136:151], v[108:111], v[24:31], v132
    s_waitcnt lgkmcnt(1)
    v_exp_f32 v34, v34
    v_exp_f32 v35, v35
    v_exp_f32 v36, v36
    v_smfmac_f32_16x16x64_bf16 v[168:171], v[128:131], v[24:31], v132
    ds_read_b128 v[124:127], v135 offset:7168
    v_exp_f32 v37, v37
    v_exp_f32 v38, v38
    v_mfma_f32_32x32x16_bf16 v[16:31], v[112:115], v[80:83], v[48:63]
    v_exp_f32 v39, v39
    v_exp_f32 v40, v40
    v_exp_f32 v41, v41
    v_mfma_f32_32x32x16_bf16 v[16:31], v[116:119], v[84:87], v[16:31]
    s_nop 0
    v_exp_f32 v42, v42
    v_exp_f32 v43, v43
    v_exp_f32 v44, v44
    v_smfmac_f32_32x32x32_bf16 v[152:167], v[104:107], v[32:39], v132
    s_nop 1
    v_exp_f32 v45, v45
    v_exp_f32 v46, v46
    v_exp_f32 v47, v47
    v_smfmac_f32_16x16x64_bf16 v[172:175], v[128:131], v[32:39], v132
    ds_read_b128 v[96:99], v135 offset:8192
    v_exp_f32 v16, v16
    v_exp_f32 v17, v17
    v_smfmac_f32_32x32x32_bf16 v[152:167], v[108:111], v[40:47], v132
    s_waitcnt lgkmcnt(1)
    v_exp_f32 v18, v18
    v_exp_f32 v19, v19
    v_exp_f32 v20, v20
    v_smfmac_f32_16x16x64_bf16 v[172:175], v[128:131], v[40:47], v132
    ds_read_b128 v[100:103], v135 offset:9216
    v_exp_f32 v21, v21
    v_exp_f32 v22, v22
    v_mfma_f32_32x32x16_bf16 v[32:47], v[112:115], v[88:91], v[64:79]
    v_exp_f32 v23, v23
    v_exp_f32 v24, v24
    v_exp_f32 v25, v25
    v_mfma_f32_32x32x16_bf16 v[32:47], v[116:119], v[92:95], v[32:47]
    s_nop 0
    v_exp_f32 v26, v26
    v_exp_f32 v27, v27
    v_exp_f32 v28, v28
    v_smfmac_f32_32x32x32_bf16 v[136:151], v[120:123], v[16:23], v132
    s_nop 1
    v_exp_f32 v29, v29
    v_exp_f32 v30, v30
    v_exp_f32 v31, v31
    v_smfmac_f32_16x16x64_bf16 v[168:171], v[128:131], v[16:23], v132
    ds_read_b128 v[104:107], v135 offset:10240
    v_exp_f32 v32, v32
    v_exp_f32 v33, v33
    v_smfmac_f32_32x32x32_bf16 v[136:151], v[124:127], v[24:31], v132
    s_waitcnt lgkmcnt(1)
    v_exp_f32 v34, v34
    v_exp_f32 v35, v35
    v_exp_f32 v36, v36
    v_smfmac_f32_16x16x64_bf16 v[168:171], v[128:131], v[24:31], v132
    ds_read_b128 v[108:111], v135 offset:11264
    v_exp_f32 v37, v37
    v_exp_f32 v38, v38
    v_mfma_f32_32x32x16_bf16 v[16:31], v[96:99], v[80:83], v[48:63]
    v_exp_f32 v39, v39
    v_exp_f32 v40, v40
    v_exp_f32 v41, v41
    v_mfma_f32_32x32x16_bf16 v[16:31], v[100:103], v[84:87], v[16:31]
    s_nop 0
    v_exp_f32 v42, v42
    v_exp_f32 v43, v43
    v_exp_f32 v44, v44
    v_smfmac_f32_32x32x32_bf16 v[152:167], v[120:123], v[32:39], v132
    s_nop 1
    v_exp_f32 v45, v45
    v_exp_f32 v46, v46
    v_exp_f32 v47, v47
    v_smfmac_f32_16x16x64_bf16 v[172:175], v[128:131], v[32:39], v132
    ds_read_b128 v[112:115], v135 offset:12288
    v_exp_f32 v16, v16
    v_exp_f32 v17, v17
    v_smfmac_f32_32x32x32_bf16 v[152:167], v[124:127], v[40:47], v132
    s_waitcnt lgkmcnt(1)
    v_exp_f32 v18, v18
    v_exp_f32 v19, v19
    v_exp_f32 v20, v20
    v_smfmac_f32_16x16x64_bf16 v[172:175], v[128:131], v[40:47], v132
    ds_read_b128 v[116:119], v135 offset:13312
    v_exp_f32 v21, v21
    v_exp_f32 v22, v22
    v_mfma_f32_32x32x16_bf16 v[32:47], v[96:99], v[88:91], v[64:79]
    v_exp_f32 v23, v23
    v_exp_f32 v24, v24
    v_exp_f32 v25, v25
    v_mfma_f32_32x32x16_bf16 v[32:47], v[100:103], v[92:95], v[32:47]
    s_nop 0
    v_exp_f32 v26, v26
    v_exp_f32 v27, v27
    v_exp_f32 v28, v28
    v_smfmac_f32_32x32x32_bf16 v[136:151], v[104:107], v[16:23], v132
    s_nop 1
    v_exp_f32 v29, v29
    v_exp_f32 v30, v30
    v_exp_f32 v31, v31
    v_smfmac_f32_16x16x64_bf16 v[168:171], v[128:131], v[16:23], v132
    ds_read_b128 v[120:123], v135 offset:14336
    v_exp_f32 v32, v32
    v_exp_f32 v33, v33
    v_smfmac_f32_32x32x32_bf16 v[136:151], v[108:111], v[24:31], v132
    s_waitcnt lgkmcnt(1)
    v_exp_f32 v34, v34
    v_exp_f32 v35, v35
    v_exp_f32 v36, v36
    v_smfmac_f32_16x16x64_bf16 v[168:171], v[128:131], v[24:31], v132
    ds_read_b128 v[124:127], v135 offset:15360
    v_exp_f32 v37, v37
    v_exp_f32 v38, v38
    v_mfma_f32_32x32x16_bf16 v[16:31], v[112:115], v[80:83], v[48:63]
    v_exp_f32 v39, v39
    v_exp_f32 v40, v40
    v_exp_f32 v41, v41
    v_mfma_f32_32x32x16_bf16 v[16:31], v[116:119], v[84:87], v[16:31]
    s_nop 0
    v_exp_f32 v42, v42
    v_exp_f32 v43, v43
    v_exp_f32 v44, v44
    v_smfmac_f32_32x32x32_bf16 v[152:167], v[104:107], v[32:39], v132
    s_nop 1
    v_exp_f32 v45, v45
    v_exp_f32 v46, v46
    v_exp_f32 v47, v47
    v_smfmac_f32_16x16x64_bf16 v[172:175], v[128:131], v[32:39], v132
    ds_read_b128 v[96:99], v135 offset:16384
    v_exp_f32 v16, v16
    v_exp_f32 v17, v17
    v_smfmac_f32_32x32x32_bf16 v[152:167], v[108:111], v[40:47], v132
    s_waitcnt lgkmcnt(1)
    v_exp_f32 v18, v18
    v_exp_f32 v19, v19
    v_exp_f32 v20, v20
    v_smfmac_f32_16x16x64_bf16 v[172:175], v[128:131], v[40:47], v132
    ds_read_b128 v[100:103], v135 offset:17408
    v_exp_f32 v21, v21
    v_exp_f32 v22, v22
    v_mfma_f32_32x32x16_bf16 v[32:47], v[112:115], v[88:91], v[64:79]
    v_exp_f32 v23, v23
    v_exp_f32 v24, v24
    v_exp_f32 v25, v25
    v_mfma_f32_32x32x16_bf16 v[32:47], v[116:119], v[92:95], v[32:47]
    s_nop 0
    v_exp_f32 v26, v26
    v_exp_f32 v27, v27
    v_exp_f32 v28, v28
    v_smfmac_f32_32x32x32_bf16 v[136:151], v[120:123], v[16:23], v132
    s_nop 1
    v_exp_f32 v29, v29
    v_exp_f32 v30, v30
    v_exp_f32 v31, v31
    v_smfmac_f32_16x16x64_bf16 v[168:171], v[128:131], v[16:23], v132
    ds_read_b128 v[104:107], v135 offset:18432
    ds_read_b128 v[108:111], v135 offset:19456
    v_exp_f32 v32, v32
    v_exp_f32 v33, v33
    v_smfmac_f32_32x32x32_bf16 v[136:151], v[124:127], v[24:31], v132
    s_waitcnt lgkmcnt(2)
    v_exp_f32 v34, v34
    v_exp_f32 v35, v35
    v_exp_f32 v36, v36
    v_smfmac_f32_16x16x64_bf16 v[168:171], v[128:131], v[24:31], v132
    ds_read_b128 v[112:115], v135 offset:20480
    ds_read_b128 v[116:119], v135 offset:21504
    v_exp_f32 v37, v37
    v_exp_f32 v38, v38
    v_mfma_f32_32x32x16_bf16 v[16:31], v[96:99], v[80:83], v[48:63]
    v_exp_f32 v39, v39
    v_exp_f32 v40, v40
    v_exp_f32 v41, v41
    v_mfma_f32_32x32x16_bf16 v[16:31], v[100:103], v[84:87], v[16:31]
    s_nop 0
    v_exp_f32 v42, v42
    v_exp_f32 v43, v43
    v_exp_f32 v44, v44
    v_smfmac_f32_32x32x32_bf16 v[152:167], v[120:123], v[32:39], v132
    s_nop 1
    v_exp_f32 v45, v45
    v_exp_f32 v46, v46
    v_exp_f32 v47, v47
    v_smfmac_f32_16x16x64_bf16 v[172:175], v[128:131], v[32:39], v132
    s_nop 0
    v_exp_f32 v16, v16
    v_exp_f32 v17, v17
    v_smfmac_f32_32x32x32_bf16 v[152:167], v[124:127], v[40:47], v132
    s_waitcnt lgkmcnt(0)
    v_exp_f32 v18, v18
    v_exp_f32 v19, v19
    v_exp_f32 v20, v20
    v_smfmac_f32_16x16x64_bf16 v[172:175], v[128:131], v[40:47], v132
    ds_read_b128 v[96:99], v135 offset:24576
    ds_read_b128 v[100:103], v135 offset:25600
    v_exp_f32 v21, v21
    v_exp_f32 v22, v22
    v_mfma_f32_32x32x16_bf16 v[32:47], v[112:115], v[80:83], v[48:63]
    v_exp_f32 v23, v23
    v_exp_f32 v24, v24
    v_exp_f32 v25, v25
    v_mfma_f32_32x32x16_bf16 v[32:47], v[116:119], v[84:87], v[32:47]
    s_nop 0
    v_exp_f32 v26, v26
    v_exp_f32 v27, v27
    v_exp_f32 v28, v28
    v_smfmac_f32_32x32x32_bf16 v[136:151], v[104:107], v[16:23], v132
    s_nop 1
    v_exp_f32 v29, v29
    v_exp_f32 v30, v30
    v_exp_f32 v31, v31
    v_smfmac_f32_16x16x64_bf16 v[168:171], v[128:131], v[16:23], v132
    ds_read_b128 v[120:123], v135 offset:22528
    ds_read_b128 v[124:127], v135 offset:23552
    v_exp_f32 v32, v32
    v_exp_f32 v33, v33
    v_smfmac_f32_32x32x32_bf16 v[136:151], v[108:111], v[24:31], v132
    s_waitcnt lgkmcnt(2)
    v_exp_f32 v34, v34
    v_exp_f32 v35, v35
    v_exp_f32 v36, v36
    v_smfmac_f32_16x16x64_bf16 v[168:171], v[128:131], v[24:31], v132
    ds_read_b128 v[112:115], v135 offset:28672
    ds_read_b128 v[116:119], v135 offset:29696
    v_exp_f32 v37, v37
    v_exp_f32 v38, v38
    v_mfma_f32_32x32x16_bf16 v[16:31], v[96:99], v[80:83], v[48:63]
    v_exp_f32 v39, v39
    v_exp_f32 v40, v40
    v_exp_f32 v41, v41
    v_mfma_f32_32x32x16_bf16 v[16:31], v[100:103], v[84:87], v[16:31]
    s_waitcnt lgkmcnt(2)
    v_exp_f32 v42, v42
    v_exp_f32 v43, v43
    v_exp_f32 v44, v44
    v_smfmac_f32_32x32x32_bf16 v[136:151], v[120:123], v[32:39], v132
    s_nop 1
    v_exp_f32 v45, v45
    v_exp_f32 v46, v46
    v_exp_f32 v47, v47
    v_smfmac_f32_16x16x64_bf16 v[168:171], v[128:131], v[32:39], v132
    ds_read_b128 v[104:107], v135 offset:26624
    ds_read_b128 v[108:111], v135 offset:27648
    v_exp_f32 v16, v16
    v_exp_f32 v17, v17
    v_smfmac_f32_32x32x32_bf16 v[136:151], v[124:127], v[40:47], v132
    s_waitcnt lgkmcnt(2)
    v_exp_f32 v18, v18
    v_exp_f32 v19, v19
    v_exp_f32 v20, v20
    v_smfmac_f32_16x16x64_bf16 v[168:171], v[128:131], v[40:47], v132
    ds_read_b128 v[96:99], v133 offset:0
    ds_read_b128 v[100:103], v133 offset:1024
    v_exp_f32 v21, v21
    v_exp_f32 v22, v22
    v_mfma_f32_32x32x16_bf16 v[32:47], v[112:115], v[80:83], v[48:63]
    v_exp_f32 v23, v23
    v_exp_f32 v24, v24
    v_exp_f32 v25, v25
    v_mfma_f32_32x32x16_bf16 v[32:47], v[116:119], v[84:87], v[32:47]
    s_waitcnt lgkmcnt(2)
    v_exp_f32 v26, v26
    v_exp_f32 v27, v27
    v_exp_f32 v28, v28
    v_smfmac_f32_32x32x32_bf16 v[136:151], v[104:107], v[16:23], v132
    s_nop 1
    v_exp_f32 v29, v29
    v_exp_f32 v30, v30
    v_exp_f32 v31, v31
    v_smfmac_f32_16x16x64_bf16 v[168:171], v[128:131], v[16:23], v132
    ds_read_b128 v[120:123], v135 offset:30720
    ds_read_b128 v[124:127], v135 offset:31744
    v_exp_f32 v32, v32
    v_exp_f32 v33, v33
    v_smfmac_f32_32x32x32_bf16 v[136:151], v[108:111], v[24:31], v132
    s_waitcnt lgkmcnt(2)
    v_exp_f32 v34, v34
    v_exp_f32 v35, v35
    v_exp_f32 v36, v36
    v_smfmac_f32_16x16x64_bf16 v[168:171], v[128:131], v[24:31], v132
    ds_read_b128 v[112:115], v133 offset:4096
    ds_read_b128 v[116:119], v133 offset:5120
    v_exp_f32 v37, v37
    v_exp_f32 v38, v38
    v_mfma_f32_32x32x16_bf16 v[16:31], v[96:99], v[80:83], v[48:63]
    v_exp_f32 v39, v39
    v_exp_f32 v40, v40
    v_exp_f32 v41, v41
    v_mfma_f32_32x32x16_bf16 v[16:31], v[100:103], v[84:87], v[16:31]
    s_waitcnt lgkmcnt(2)
    v_exp_f32 v42, v42
    v_exp_f32 v43, v43
    v_exp_f32 v44, v44
    v_smfmac_f32_32x32x32_bf16 v[136:151], v[120:123], v[32:39], v132
    s_nop 1
    v_exp_f32 v45, v45
    v_exp_f32 v46, v46
    v_exp_f32 v47, v47
    v_smfmac_f32_16x16x64_bf16 v[168:171], v[128:131], v[32:39], v132
    ds_read_b128 v[104:107], v133 offset:2048
    ds_read_b128 v[108:111], v133 offset:3072
    v_exp_f32 v16, v16
    v_exp_f32 v17, v17
    v_smfmac_f32_32x32x32_bf16 v[136:151], v[124:127], v[40:47], v132
    s_waitcnt lgkmcnt(2)
    v_exp_f32 v18, v18
    v_exp_f32 v19, v19
    v_exp_f32 v20, v20
    v_smfmac_f32_16x16x64_bf16 v[168:171], v[128:131], v[40:47], v132
    ds_read_b128 v[96:99], v133 offset:8192
    ds_read_b128 v[100:103], v133 offset:9216
    v_exp_f32 v21, v21
    v_exp_f32 v22, v22
    v_mfma_f32_32x32x16_bf16 v[32:47], v[112:115], v[80:83], v[48:63]
    v_exp_f32 v23, v23
    v_exp_f32 v24, v24
    v_exp_f32 v25, v25
    v_mfma_f32_32x32x16_bf16 v[32:47], v[116:119], v[84:87], v[32:47]
    s_waitcnt lgkmcnt(2)
    v_exp_f32 v26, v26
    v_exp_f32 v27, v27
    v_exp_f32 v28, v28
    v_smfmac_f32_32x32x32_bf16 v[136:151], v[104:107], v[16:23], v132
    s_nop 1
    v_exp_f32 v29, v29
    v_exp_f32 v30, v30
    v_exp_f32 v31, v31
    v_smfmac_f32_16x16x64_bf16 v[168:171], v[128:131], v[16:23], v132
    ds_read_b128 v[120:123], v133 offset:6144
    ds_read_b128 v[124:127], v133 offset:7168
    v_exp_f32 v32, v32
    v_exp_f32 v33, v33
    v_smfmac_f32_32x32x32_bf16 v[136:151], v[108:111], v[24:31], v132
    s_waitcnt lgkmcnt(2)
    v_exp_f32 v34, v34
    v_exp_f32 v35, v35
    v_exp_f32 v36, v36
    v_smfmac_f32_16x16x64_bf16 v[168:171], v[128:131], v[24:31], v132
    ds_read_b128 v[112:115], v133 offset:12288
    ds_read_b128 v[116:119], v133 offset:13312
    v_exp_f32 v37, v37
    v_exp_f32 v38, v38
    v_mfma_f32_32x32x16_bf16 v[16:31], v[96:99], v[80:83], v[48:63]
    v_exp_f32 v39, v39
    v_exp_f32 v40, v40
    v_exp_f32 v41, v41
    v_mfma_f32_32x32x16_bf16 v[16:31], v[100:103], v[84:87], v[16:31]
    s_waitcnt lgkmcnt(2)
    v_exp_f32 v42, v42
    v_exp_f32 v43, v43
    v_exp_f32 v44, v44
    v_smfmac_f32_32x32x32_bf16 v[136:151], v[120:123], v[32:39], v132
    s_nop 1
    v_exp_f32 v45, v45
    v_exp_f32 v46, v46
    v_exp_f32 v47, v47
    v_smfmac_f32_16x16x64_bf16 v[168:171], v[128:131], v[32:39], v132
    ds_read_b128 v[104:107], v133 offset:10240
    ds_read_b128 v[108:111], v133 offset:11264
L_pg5:
    s_cbranch_execz L_pgret
    v_exp_f32 v16, v16
    v_exp_f32 v17, v17
    v_smfmac_f32_32x32x32_bf16 v[136:151], v[124:127], v[40:47], v132
    s_waitcnt lgkmcnt(2)
    v_exp_f32 v18, v18
    v_exp_f32 v19, v19
    v_exp_f32 v20, v20
    v_smfmac_f32_16x16x64_bf16 v[168:171], v[128:131], v[40:47], v132
    ds_read_b128 v[96:99], v133 offset:16384
    ds_read_b128 v[100:103], v133 offset:17408
    v_exp_f32 v21, v21
    v_exp_f32 v22, v22
    v_mfma_f32_32x32x16_bf16 v[32:47], v[112:115], v[80:83], v[48:63]
    v_exp_f32 v23, v23
    v_exp_f32 v24, v24
    v_exp_f32 v25, v25
    v_mfma_f32_32x32x16_bf16 v[32:47], v[116:119], v[84:87], v[32:47]
    s_waitcnt lgkmcnt(2)
    v_exp_f32 v26, v26
    v_exp_f32 v27, v27
    v_exp_f32 v28, v28
    v_smfmac_f32_32x32x32_bf16 v[136:151], v[104:107], v[16:23], v132
    s_nop 1
    v_exp_f32 v29, v29
    v_exp_f32 v30, v30
    v_exp_f32 v31, v31
    v_smfmac_f32_16x16x64_bf16 v[168:171], v[128:131], v[16:23], v132
    ds_read_b128 v[120:123], v133 offset:14336
    ds_read_b128 v[124:127], v133 offset:15360
    v_exp_f32 v32, v32
    v_exp_f32 v33, v33
    v_smfmac_f32_32x32x32_bf16 v[136:151], v[108:111], v[24:31], v132
    s_waitcnt lgkmcnt(2)
    v_exp_f32 v34, v34
    v_exp_f32 v35, v35
    v_exp_f32 v36, v36
    v_smfmac_f32_16x16x64_bf16 v[168:171], v[128:131], v[24:31], v132
    ds_read_b128 v[112:115], v133 offset:20480
    ds_read_b128 v[116:119], v133 offset:21504
    v_exp_f32 v37, v37
    v_exp_f32 v38, v38
    v_mfma_f32_32x32x16_bf16 v[16:31], v[96:99], v[80:83], v[48:63]
    v_exp_f32 v39, v39
    v_exp_f32 v40, v40
    v_exp_f32 v41, v41
    v_mfma_f32_32x32x16_bf16 v[16:31], v[100:103], v[84:87], v[16:31]
    s_waitcnt lgkmcnt(2)
    v_exp_f32 v42, v42
    v_exp_f32 v43, v43
    v_exp_f32 v44, v44
    v_smfmac_f32_32x32x32_bf16 v[136:151], v[120:123], v[32:39], v132
    s_nop 1
    v_exp_f32 v45, v45
    v_exp_f32 v46, v46
    v_exp_f32 v47, v47
    v_smfmac_f32_16x16x64_bf16 v[168:171], v[128:131], v[32:39], v132
    ds_read_b128 v[104:107], v133 offset:18432
    ds_read_b128 v[108:111], v133 offset:19456
    v_exp_f32 v16, v16
    v_exp_f32 v17, v17
    v_smfmac_f32_32x32x32_bf16 v[136:151], v[124:127], v[40:47], v132
    s_waitcnt lgkmcnt(2)
    v_exp_f32 v18, v18
    v_exp_f32 v19, v19
    v_exp_f32 v20, v20
    v_smfmac_f32_16x16x64_bf16 v[168:171], v[128:131], v[40:47], v132
    ds_read_b128 v[96:99], v133 offset:24576
    ds_read_b128 v[100:103], v133 offset:25600
    v_exp_f32 v21, v21
    v_exp_f32 v22, v22
    v_mfma_f32_32x32x16_bf16 v[32:47], v[112:115], v[80:83], v[48:63]
    v_exp_f32 v23, v23
    v_exp_f32 v24, v24
    v_exp_f32 v25, v25
    v_mfma_f32_32x32x16_bf16 v[32:47], v[116:119], v[84:87], v[32:47]
    s_waitcnt lgkmcnt(2)
    v_exp_f32 v26, v26
    v_exp_f32 v27, v27
    v_exp_f32 v28, v28
    v_smfmac_f32_32x32x32_bf16 v[136:151], v[104:107], v[16:23], v132
    s_nop 1
    v_exp_f32 v29, v29
    v_exp_f32 v30, v30
    v_exp_f32 v31, v31
    v_smfmac_f32_16x16x64_bf16 v[168:171], v[128:131], v[16:23], v132
    ds_read_b128 v[120:123], v133 offset:22528
    ds_read_b128 v[124:127], v133 offset:23552
    v_exp_f32 v32, v32
    v_exp_f32 v33, v33
    v_smfmac_f32_32x32x32_bf16 v[136:151], v[108:111], v[24:31], v132
    s_waitcnt lgkmcnt(2)
    v_exp_f32 v34, v34
    v_exp_f32 v35, v35
    v_exp_f32 v36, v36
    v_smfmac_f32_16x16x64_bf16 v[168:171], v[128:131], v[24:31], v132
    ds_read_b128 v[112:115], v133 offset:28672
    ds_read_b128 v[116:119], v133 offset:29696
    v_exp_f32 v37, v37
    v_exp_f32 v38, v38
    v_mfma_f32_32x32x16_bf16 v[16:31], v[96:99], v[80:83], v[48:63]
    v_exp_f32 v39, v39
    v_exp_f32 v40, v40
    v_exp_f32 v41, v41
    v_mfma_f32_32x32x16_bf16 v[16:31], v[100:103], v[84:87], v[16:31]
    s_waitcnt lgkmcnt(2)
    v_exp_f32 v42, v42
    v_exp_f32 v43, v43
    v_exp_f32 v44, v44
    v_smfmac_f32_32x32x32_bf16 v[136:151], v[120:123], v[32:39], v132
    s_nop 1
    v_exp_f32 v45, v45
    v_exp_f32 v46, v46
    v_exp_f32 v47, v47
    v_smfmac_f32_16x16x64_bf16 v[168:171], v[128:131], v[32:39], v132
    ds_read_b128 v[104:107], v133 offset:26624
    ds_read_b128 v[108:111], v133 offset:27648
    v_exp_f32 v16, v16
    v_exp_f32 v17, v17
    v_smfmac_f32_32x32x32_bf16 v[136:151], v[124:127], v[40:47], v132
    s_waitcnt lgkmcnt(2)
    v_exp_f32 v18, v18
    v_exp_f32 v19, v19
    v_exp_f32 v20, v20
    v_smfmac_f32_16x16x64_bf16 v[168:171], v[128:131], v[40:47], v132
    ds_read_b128 v[96:99], v135 offset:16384
    ds_read_b128 v[100:103], v135 offset:17408
    v_exp_f32 v21, v21
    v_exp_f32 v22, v22
    v_mfma_f32_32x32x16_bf16 v[32:47], v[112:115], v[80:83], v[48:63]
    v_exp_f32 v23, v23
    v_exp_f32 v24, v24
    v_exp_f32 v25, v25
    v_mfma_f32_32x32x16_bf16 v[32:47], v[116:119], v[84:87], v[32:47]
    s_waitcnt lgkmcnt(2)
    v_exp_f32 v26, v26
    v_exp_f32 v27, v27
    v_exp_f32 v28, v28
    v_smfmac_f32_32x32x32_bf16 v[136:151], v[104:107], v[16:23], v132
    s_nop 1
    v_exp_f32 v29, v29
    v_exp_f32 v30, v30
    v_exp_f32 v31, v31
    v_smfmac_f32_16x16x64_bf16 v[168:171], v[128:131], v[16:23], v132
    ds_read_b128 v[120:123], v133 offset:30720
    ds_read_b128 v[124:127], v133 offset:31744
    v_exp_f32 v32, v32
    v_exp_f32 v33, v33
    v_smfmac_f32_32x32x32_bf16 v[136:151], v[108:111], v[24:31], v132
    s_waitcnt lgkmcnt(2)
    v_exp_f32 v34, v34
    v_exp_f32 v35, v35
    v_exp_f32 v36, v36
    v_smfmac_f32_16x16x64_bf16 v[168:171], v[128:131], v[24:31], v132
    ds_read_b128 v[112:115], v135 offset:20480
    ds_read_b128 v[116:119], v135 offset:21504
    v_exp_f32 v37, v37
    v_exp_f32 v38, v38
    v_mfma_f32_32x32x16_bf16 v[16:31], v[96:99], v[88:91], v[64:79]
    v_exp_f32 v39, v39
    v_exp_f32 v40, v40
    v_exp_f32 v41, v41
    v_mfma_f32_32x32x16_bf16 v[16:31], v[100:103], v[92:95], v[16:31]
    s_waitcnt lgkmcnt(2)
    v_exp_f32 v42, v42
    v_exp_f32 v43, v43
    v_exp_f32 v44, v44
    v_smfmac_f32_32x32x32_bf16 v[136:151], v[120:123], v[32:39], v132
    s_nop 1
    v_exp_f32 v45, v45
    v_exp_f32 v46, v46
    v_exp_f32 v47, v47
    v_smfmac_f32_16x16x64_bf16 v[168:171], v[128:131], v[32:39], v132
    ds_read_b128 v[104:107], v135 offset:18432
    ds_read_b128 v[108:111], v135 offset:19456
    v_exp_f32 v16, v16
    v_exp_f32 v17, v17
    v_smfmac_f32_32x32x32_bf16 v[136:151], v[124:127], v[40:47], v132
    s_waitcnt lgkmcnt(2)
    v_exp_f32 v18, v18
    v_exp_f32 v19, v19
    v_exp_f32 v20, v20
    v_smfmac_f32_16x16x64_bf16 v[168:171], v[128:131], v[40:47], v132
    ds_read_b128 v[96:99], v135 offset:24576
    ds_read_b128 v[100:103], v135 offset:25600
    v_exp_f32 v21, v21
    v_exp_f32 v22, v22
    v_mfma_f32_32x32x16_bf16 v[32:47], v[112:115], v[88:91], v[64:79]
    v_exp_f32 v23, v23
    v_exp_f32 v24, v24
    v_exp_f32 v25, v25
    v_mfma_f32_32x32x16_bf16 v[32:47], v[116:119], v[92:95], v[32:47]
    s_waitcnt lgkmcnt(2)
    v_exp_f32 v26, v26
    v_exp_f32 v27, v27
    v_exp_f32 v28, v28
    v_smfmac_f32_32x32x32_bf16 v[152:167], v[104:107], v[16:23], v132
    s_nop 1
    v_exp_f32 v29, v29
    v_exp_f32 v30, v30
    v_exp_f32 v31, v31
    v_smfmac_f32_16x16x64_bf16 v[172:175], v[128:131], v[16:23], v132
    ds_read_b128 v[120:123], v135 offset:22528
    ds_read_b128 v[124:127], v135 offset:23552
    v_mov_b32 v3, v168
    s_nop 1
    v_permlane32_swap_b32 v168, v3
    v_pk_add_f32 v[2:3], v[136:137], v[138:139]
    v_pk_add_f32 v[4:5], v[140:141], v[142:143]
    v_pk_add_f32 v[2:3], v[2:3], v[144:145]
    v_pk_add_f32 v[4:5], v[4:5], v[146:147]
    v_pk_add_f32 v[2:3], v[2:3], v[148:149]
    v_pk_add_f32 v[4:5], v[4:5], v[150:151]
    v_pk_add_f32 v[2:3], v[2:3], v[4:5]
    v_cmp_nge_f32 vcc, s56, v168
    v_add_f32 v2, v2, v3
    v_cmp_gt_f32 s[68:69], s70, v168
    v_cmp_class_f32 s[58:59], v2, s57
    s_or_b64 vcc, vcc, s[68:69]
    s_or_b64 vcc, vcc, s[58:59]
    s_cbranch_vccnz L_truemax0
    v_rcp_f32 v2, v168
    s_nop 0
    v_pk_mul_f32 v[136:137], v[136:137], v[2:3] op_sel_hi:[1,0]
    v_pk_mul_f32 v[138:139], v[138:139], v[2:3] op_sel_hi:[1,0]
    v_pk_mul_f32 v[140:141], v[140:141], v[2:3] op_sel_hi:[1,0]
    v_pk_mul_f32 v[142:143], v[142:143], v[2:3] op_sel_hi:[1,0]
    v_pk_mul_f32 v[144:145], v[144:145], v[2:3] op_sel_hi:[1,0]
    v_pk_mul_f32 v[146:147], v[146:147], v[2:3] op_sel_hi:[1,0]
    v_pk_mul_f32 v[148:149], v[148:149], v[2:3] op_sel_hi:[1,0]
    v_pk_mul_f32 v[150:151], v[150:151], v[2:3] op_sel_hi:[1,0]
    v_cvt_pk_bf16_f32 v176, v136, v137
    v_cvt_pk_bf16_f32 v177, v138, v139
    v_cvt_pk_bf16_f32 v178, v140, v141
    v_cvt_pk_bf16_f32 v179, v142, v143
    v_cvt_pk_bf16_f32 v180, v144, v145
    v_cvt_pk_bf16_f32 v181, v146, v147
    v_cvt_pk_bf16_f32 v182, v148, v149
    v_cvt_pk_bf16_f32 v183, v150, v151
L_norm0:
    s_nop 0
    v_permlane32_swap_b32 v176, v180
    v_permlane32_swap_b32 v177, v181
    v_permlane32_swap_b32 v178, v182
    v_permlane32_swap_b32 v179, v183
    v_permlane16_swap_b32 v176, v180
    v_permlane16_swap_b32 v177, v181
    v_permlane16_swap_b32 v178, v182
    v_permlane16_swap_b32 v179, v183
    buffer_store_dwordx4 v[176:179], v1, s[44:47], s80 offen offset:0 sc1
    buffer_store_dwordx4 v[180:183], v1, s[44:47], s80 offen offset:1024 sc1
    v_add_u32 v168, 65536, v6
    v_add_u32 v169, 65536, v7
    v_add_u32 v170, 65536, v8
    v_add_u32 v171, 65536, v9
    v_exp_f32 v32, v32
    v_exp_f32 v33, v33
    v_smfmac_f32_32x32x32_bf16 v[152:167], v[108:111], v[24:31], v132
    s_waitcnt lgkmcnt(2)
    v_exp_f32 v34, v34
    v_exp_f32 v35, v35
    v_exp_f32 v36, v36
    v_smfmac_f32_16x16x64_bf16 v[172:175], v[128:131], v[24:31], v132
    ds_read_b128 v[112:115], v135 offset:28672
    ds_read_b128 v[116:119], v135 offset:29696
    v_exp_f32 v37, v37
    v_exp_f32 v38, v38
    v_mfma_f32_32x32x16_bf16 v[16:31], v[96:99], v[88:91], v[64:79]
    v_exp_f32 v39, v39
    v_exp_f32 v40, v40
    v_exp_f32 v41, v41
    v_mfma_f32_32x32x16_bf16 v[16:31], v[100:103], v[92:95], v[16:31]
    s_waitcnt lgkmcnt(2)
    v_exp_f32 v42, v42
    v_exp_f32 v43, v43
    v_exp_f32 v44, v44
    v_smfmac_f32_32x32x32_bf16 v[152:167], v[120:123], v[32:39], v132
    s_nop 1
    v_exp_f32 v45, v45
    v_exp_f32 v46, v46
    v_exp_f32 v47, v47
    v_smfmac_f32_16x16x64_bf16 v[172:175], v[128:131], v[32:39], v132
    ds_read_b128 v[104:107], v135 offset:26624
    ds_read_b128 v[108:111], v135 offset:27648
    v_exp_f32 v16, v16
    v_exp_f32 v17, v17
    v_smfmac_f32_32x32x32_bf16 v[152:167], v[124:127], v[40:47], v132
    s_waitcnt lgkmcnt(2)
    v_exp_f32 v18, v18
    v_exp_f32 v19, v19
    v_exp_f32 v20, v20
    v_smfmac_f32_16x16x64_bf16 v[172:175], v[128:131], v[40:47], v132
    ds_read_b128 v[96:99], v133 offset:0
    ds_read_b128 v[100:103], v133 offset:1024
    v_exp_f32 v21, v21
    v_exp_f32 v22, v22
    v_mfma_f32_32x32x16_bf16 v[32:47], v[112:115], v[88:91], v[64:79]
    v_exp_f32 v23, v23
    v_exp_f32 v24, v24
    v_exp_f32 v25, v25
    v_mfma_f32_32x32x16_bf16 v[32:47], v[116:119], v[92:95], v[32:47]
    s_waitcnt lgkmcnt(2)
    v_exp_f32 v26, v26
    v_exp_f32 v27, v27
    v_exp_f32 v28, v28
    v_smfmac_f32_32x32x32_bf16 v[152:167], v[104:107], v[16:23], v132
    s_nop 1
    v_exp_f32 v29, v29
    v_exp_f32 v30, v30
    v_exp_f32 v31, v31
    v_smfmac_f32_16x16x64_bf16 v[172:175], v[128:131], v[16:23], v132
    ds_read_b128 v[120:123], v135 offset:30720
    ds_read_b128 v[124:127], v135 offset:31744
    v_exp_f32 v32, v32
    v_exp_f32 v33, v33
    v_smfmac_f32_32x32x32_bf16 v[152:167], v[108:111], v[24:31], v132
    s_waitcnt lgkmcnt(2)
    v_exp_f32 v34, v34
    v_exp_f32 v35, v35
    v_exp_f32 v36, v36
    v_smfmac_f32_16x16x64_bf16 v[172:175], v[128:131], v[24:31], v132
    ds_read_b128 v[112:115], v133 offset:4096
    ds_read_b128 v[116:119], v133 offset:5120
    v_exp_f32 v37, v37
    v_exp_f32 v38, v38
    v_mfma_f32_32x32x16_bf16 v[16:31], v[96:99], v[88:91], v[64:79]
    v_exp_f32 v39, v39
    v_exp_f32 v40, v40
    v_exp_f32 v41, v41
    v_mfma_f32_32x32x16_bf16 v[16:31], v[100:103], v[92:95], v[16:31]
    s_waitcnt lgkmcnt(3)
    v_exp_f32 v42, v42
    v_exp_f32 v43, v43
    v_exp_f32 v44, v44
    v_smfmac_f32_32x32x32_bf16 v[152:167], v[120:123], v[32:39], v132
    s_waitcnt lgkmcnt(0)
    s_barrier
    v_exp_f32 v45, v45
    v_exp_f32 v46, v46
    v_exp_f32 v47, v47
    v_smfmac_f32_16x16x64_bf16 v[172:175], v[128:131], v[32:39], v132
    ds_read_b128 v[104:107], v133 offset:2048
    ds_read_b128 v[108:111], v133 offset:3072
    v_exp_f32 v16, v16
    v_exp_f32 v17, v17
    v_smfmac_f32_32x32x32_bf16 v[152:167], v[124:127], v[40:47], v132
    s_nop 0
    v_exp_f32 v18, v18
    v_exp_f32 v19, v19
    v_exp_f32 v20, v20
    v_smfmac_f32_16x16x64_bf16 v[172:175], v[128:131], v[40:47], v132
    ds_read_b128 v[96:99], v133 offset:8192
    ds_read_b128 v[100:103], v133 offset:9216
    v_exp_f32 v21, v21
    v_exp_f32 v22, v22
    v_mfma_f32_32x32x16_bf16 v[32:47], v[112:115], v[88:91], v[64:79]
    v_exp_f32 v23, v23
    v_exp_f32 v24, v24
    v_exp_f32 v25, v25
    v_mfma_f32_32x32x16_bf16 v[32:47], v[116:119], v[92:95], v[32:47]
    s_waitcnt lgkmcnt(2)
    v_exp_f32 v26, v26
    v_exp_f32 v27, v27
    v_exp_f32 v28, v28
    v_smfmac_f32_32x32x32_bf16 v[152:167], v[104:107], v[16:23], v132
    s_nop 1
    v_exp_f32 v29, v29
    v_exp_f32 v30, v30
    v_exp_f32 v31, v31
    v_smfmac_f32_16x16x64_bf16 v[172:175], v[128:131], v[16:23], v132
    ds_read_b128 v[120:123], v133 offset:6144
    ds_read_b128 v[124:127], v133 offset:7168
    v_exp_f32 v32, v32
    v_exp_f32 v33, v33
    v_smfmac_f32_32x32x32_bf16 v[152:167], v[108:111], v[24:31], v132
    s_waitcnt lgkmcnt(2)
    v_exp_f32 v34, v34
    v_exp_f32 v35, v35
    v_exp_f32 v36, v36
    v_smfmac_f32_16x16x64_bf16 v[172:175], v[128:131], v[24:31], v132
    ds_read_b128 v[112:115], v133 offset:12288
    ds_read_b128 v[116:119], v133 offset:13312
    v_exp_f32 v37, v37
    v_exp_f32 v38, v38
    v_mfma_f32_32x32x16_bf16 v[16:31], v[96:99], v[88:91], v[64:79]
    v_exp_f32 v39, v39
    v_exp_f32 v40, v40
    v_exp_f32 v41, v41
    v_mfma_f32_32x32x16_bf16 v[16:31], v[100:103], v[92:95], v[16:31]
    s_waitcnt lgkmcnt(2)
    v_exp_f32 v42, v42
    v_exp_f32 v43, v43
    v_exp_f32 v44, v44
    v_smfmac_f32_32x32x32_bf16 v[152:167], v[120:123], v[32:39], v132
    s_nop 1
    v_exp_f32 v45, v45
    v_exp_f32 v46, v46
    v_exp_f32 v47, v47
    v_smfmac_f32_16x16x64_bf16 v[172:175], v[128:131], v[32:39], v132
    ds_read_b128 v[104:107], v133 offset:10240
    ds_read_b128 v[108:111], v133 offset:11264
    v_exp_f32 v16, v16
    v_exp_f32 v17, v17
    v_smfmac_f32_32x32x32_bf16 v[152:167], v[124:127], v[40:47], v132
    s_waitcnt lgkmcnt(2)
    buffer_load_dwordx4 v[192:195], v1, s[44:47], s81 offen offset:0 sc1
    v_exp_f32 v18, v18
    v_exp_f32 v19, v19
    v_exp_f32 v20, v20
    v_smfmac_f32_16x16x64_bf16 v[172:175], v[128:131], v[40:47], v132
    ds_read_b128 v[96:99], v133 offset:16384
    ds_read_b128 v[100:103], v133 offset:17408
    v_exp_f32 v21, v21
    v_exp_f32 v22, v22
    v_mfma_f32_32x32x16_bf16 v[32:47], v[112:115], v[88:91], v[64:79]
    v_exp_f32 v23, v23
    v_exp_f32 v24, v24
    v_exp_f32 v25, v25
    v_mfma_f32_32x32x16_bf16 v[32:47], v[116:119], v[92:95], v[32:47]
    s_waitcnt lgkmcnt(2)
    v_exp_f32 v26, v26
    v_exp_f32 v27, v27
    v_exp_f32 v28, v28
    v_smfmac_f32_32x32x32_bf16 v[152:167], v[104:107], v[16:23], v132
    buffer_load_dwordx4 v[196:199], v1, s[44:47], s81 offen offset:1024 sc1
    s_nop 0
    v_exp_f32 v29, v29
    v_exp_f32 v30, v30
    v_exp_f32 v31, v31
    v_smfmac_f32_16x16x64_bf16 v[172:175], v[128:131], v[16:23], v132
    ds_read_b128 v[120:123], v133 offset:14336
    ds_read_b128 v[124:127], v133 offset:15360
    v_exp_f32 v32, v32
    v_exp_f32 v33, v33
    v_smfmac_f32_32x32x32_bf16 v[152:167], v[108:111], v[24:31], v132
    s_waitcnt lgkmcnt(2)
    buffer_load_dwordx4 v[200:203], v1, s[44:47], s82 offen offset:0 sc1
    v_exp_f32 v34, v34
    v_exp_f32 v35, v35
    v_exp_f32 v36, v36
    v_smfmac_f32_16x16x64_bf16 v[172:175], v[128:131], v[24:31], v132
    ds_read_b128 v[112:115], v133 offset:20480
    ds_read_b128 v[116:119], v133 offset:21504
    v_exp_f32 v37, v37
    v_exp_f32 v38, v38
    v_mfma_f32_32x32x16_bf16 v[16:31], v[96:99], v[88:91], v[64:79]
    v_exp_f32 v39, v39
    v_exp_f32 v40, v40
    v_exp_f32 v41, v41
    v_mfma_f32_32x32x16_bf16 v[16:31], v[100:103], v[92:95], v[16:31]
    s_waitcnt lgkmcnt(2)
    v_exp_f32 v42, v42
    v_exp_f32 v43, v43
    v_exp_f32 v44, v44
    v_smfmac_f32_32x32x32_bf16 v[152:167], v[120:123], v[32:39], v132
    buffer_load_dwordx4 v[204:207], v1, s[44:47], s82 offen offset:1024 sc1
    s_nop 0
    v_exp_f32 v45, v45
    v_exp_f32 v46, v46
    v_exp_f32 v47, v47
    v_smfmac_f32_16x16x64_bf16 v[172:175], v[128:131], v[32:39], v132
    ds_read_b128 v[104:107], v133 offset:18432
    ds_read_b128 v[108:111], v133 offset:19456
    v_exp_f32 v16, v16
    v_exp_f32 v17, v17
    v_smfmac_f32_32x32x32_bf16 v[152:167], v[124:127], v[40:47], v132
    s_waitcnt lgkmcnt(2)
    buffer_load_dwordx4 v[208:211], v1, s[44:47], s83 offen offset:0 sc1
    v_exp_f32 v18, v18
    v_exp_f32 v19, v19
    v_exp_f32 v20, v20
    v_smfmac_f32_16x16x64_bf16 v[172:175], v[128:131], v[40:47], v132
    ds_read_b128 v[96:99], v133 offset:24576
    ds_read_b128 v[100:103], v133 offset:25600
    v_exp_f32 v21, v21
    v_exp_f32 v22, v22
    v_mfma_f32_32x32x16_bf16 v[32:47], v[112:115], v[88:91], v[64:79]
    v_exp_f32 v23, v23
    v_exp_f32 v24, v24
    v_exp_f32 v25, v25
    v_mfma_f32_32x32x16_bf16 v[32:47], v[116:119], v[92:95], v[32:47]
    s_waitcnt lgkmcnt(2)
    v_exp_f32 v26, v26
    v_exp_f32 v27, v27
    v_exp_f32 v28, v28
    v_smfmac_f32_32x32x32_bf16 v[152:167], v[104:107], v[16:23], v132
    buffer_load_dwordx4 v[212:215], v1, s[44:47], s83 offen offset:1024 sc1
    s_nop 0
    v_exp_f32 v29, v29
    v_exp_f32 v30, v30
    v_exp_f32 v31, v31
    v_smfmac_f32_16x16x64_bf16 v[172:175], v[128:131], v[16:23], v132
    ds_read_b128 v[120:123], v133 offset:22528
    ds_read_b128 v[124:127], v133 offset:23552
    v_exp_f32 v32, v32
    v_exp_f32 v33, v33
    v_smfmac_f32_32x32x32_bf16 v[152:167], v[108:111], v[24:31], v132
    s_waitcnt lgkmcnt(2)
    buffer_load_dwordx4 v[216:219], v1, s[44:47], s84 offen offset:0 sc1
    v_exp_f32 v34, v34
    v_exp_f32 v35, v35
    v_exp_f32 v36, v36
    v_smfmac_f32_16x16x64_bf16 v[172:175], v[128:131], v[24:31], v132
    ds_read_b128 v[112:115], v133 offset:28672
    ds_read_b128 v[116:119], v133 offset:29696
    v_exp_f32 v37, v37
    v_exp_f32 v38, v38
    v_mfma_f32_32x32x16_bf16 v[16:31], v[96:99], v[88:91], v[64:79]
    v_exp_f32 v39, v39
    v_exp_f32 v40, v40
    v_exp_f32 v41, v41
    v_mfma_f32_32x32x16_bf16 v[16:31], v[100:103], v[92:95], v[16:31]
    s_waitcnt lgkmcnt(2)
    v_exp_f32 v42, v42
    v_exp_f32 v43, v43
    v_exp_f32 v44, v44
    v_smfmac_f32_32x32x32_bf16 v[152:167], v[120:123], v[32:39], v132
    buffer_load_dwordx4 v[220:223], v1, s[44:47], s84 offen offset:1024 sc1
    s_nop 0
    v_exp_f32 v45, v45
    v_exp_f32 v46, v46
    v_exp_f32 v47, v47
    v_smfmac_f32_16x16x64_bf16 v[172:175], v[128:131], v[32:39], v132
    ds_read_b128 v[104:107], v133 offset:26624
    ds_read_b128 v[108:111], v133 offset:27648
    v_exp_f32 v16, v16
    v_exp_f32 v17, v17
    v_smfmac_f32_32x32x32_bf16 v[152:167], v[124:127], v[40:47], v132
    s_waitcnt lgkmcnt(2)
    buffer_load_dwordx4 v[224:227], v1, s[44:47], s85 offen offset:0 sc1
    v_exp_f32 v18, v18
    v_exp_f32 v19, v19
    v_exp_f32 v20, v20
    v_smfmac_f32_16x16x64_bf16 v[172:175], v[128:131], v[40:47], v132
    v_exp_f32 v21, v21
    v_exp_f32 v22, v22
    v_mfma_f32_32x32x16_bf16 v[32:47], v[112:115], v[88:91], v[64:79]
    v_exp_f32 v23, v23
    v_exp_f32 v24, v24
    v_exp_f32 v25, v25
    v_mfma_f32_32x32x16_bf16 v[32:47], v[116:119], v[92:95], v[32:47]
    s_waitcnt lgkmcnt(0)
    v_exp_f32 v26, v26
    v_exp_f32 v27, v27
    v_exp_f32 v28, v28
    v_smfmac_f32_32x32x32_bf16 v[152:167], v[104:107], v[16:23], v132
    buffer_load_dwordx4 v[228:231], v1, s[44:47], s85 offen offset:1024 sc1
    s_nop 0
    v_exp_f32 v29, v29
    v_exp_f32 v30, v30
    v_exp_f32 v31, v31
    v_smfmac_f32_16x16x64_bf16 v[172:175], v[128:131], v[16:23], v132
    ds_read_b128 v[120:123], v133 offset:30720
    ds_read_b128 v[124:127], v133 offset:31744
    v_exp_f32 v32, v32
    v_exp_f32 v33, v33
    v_smfmac_f32_32x32x32_bf16 v[152:167], v[108:111], v[24:31], v132
    s_nop 0
    buffer_load_dwordx4 v[232:235], v1, s[44:47], s86 offen offset:0 sc1
    v_exp_f32 v34, v34
    v_exp_f32 v35, v35
    v_exp_f32 v36, v36
    v_smfmac_f32_16x16x64_bf16 v[172:175], v[128:131], v[24:31], v132
    v_exp_f32 v37, v37
    v_exp_f32 v38, v38
    v_exp_f32 v39, v39
    v_exp_f32 v40, v40
    v_exp_f32 v41, v41
    s_waitcnt lgkmcnt(0)
    v_exp_f32 v42, v42
    v_exp_f32 v43, v43
    v_exp_f32 v44, v44
    v_smfmac_f32_32x32x32_bf16 v[152:167], v[120:123], v[32:39], v132
    buffer_load_dwordx4 v[236:239], v1, s[44:47], s86 offen offset:1024 sc1
    s_nop 0
    v_exp_f32 v45, v45
    v_exp_f32 v46, v46
    v_exp_f32 v47, v47
    v_smfmac_f32_16x16x64_bf16 v[172:175], v[128:131], v[32:39], v132
    s_nop 0
    s_nop 0
    v_smfmac_f32_32x32x32_bf16 v[152:167], v[124:127], v[40:47], v132
    v_smfmac_f32_16x16x64_bf16 v[172:175], v[128:131], v[40:47], v132
    buffer_load_dwordx4 v[240:243], v1, s[44:47], s87 offen offset:0 sc1
    buffer_load_dwordx4 v[244:247], v1, s[44:47], s87 offen offset:1024 sc1
    buffer_load_dwordx4 v[248:251], v1, s[44:47], s88 offen offset:0 sc1
    buffer_load_dwordx4 v[252:255], v1, s[44:47], s88 offen offset:1024 sc1
    ds_read_b64_tr_b16 v[136:137], v6 offset:0
    ds_read_b64_tr_b16 v[138:139], v6 offset:1024
    ds_read_b64_tr_b16 v[140:141], v7 offset:0
    ds_read_b64_tr_b16 v[142:143], v7 offset:1024
    ds_read_b64_tr_b16 v[144:145], v8 offset:0
    ds_read_b64_tr_b16 v[146:147], v8 offset:1024
    ds_read_b64_tr_b16 v[148:149], v9 offset:0
    ds_read_b64_tr_b16 v[150:151], v9 offset:1024
    ds_read_b64_tr_b16 v[48:49], v6 offset:4096
    ds_read_b64_tr_b16 v[50:51], v6 offset:5120
    ds_read_b64_tr_b16 v[52:53], v7 offset:4096
    ds_read_b64_tr_b16 v[54:55], v7 offset:5120
    v_mov_b32 v3, v172
    s_nop 1
    v_permlane32_swap_b32 v172, v3
    v_pk_add_f32 v[2:3], v[152:153], v[154:155]
    v_pk_add_f32 v[4:5], v[156:157], v[158:159]
    v_pk_add_f32 v[2:3], v[2:3], v[160:161]
    v_pk_add_f32 v[4:5], v[4:5], v[162:163]
    v_pk_add_f32 v[2:3], v[2:3], v[164:165]
    v_pk_add_f32 v[4:5], v[4:5], v[166:167]
    v_pk_add_f32 v[2:3], v[2:3], v[4:5]
    v_cmp_nge_f32 vcc, s56, v172
    v_add_f32 v2, v2, v3
    v_cmp_gt_f32 s[68:69], s70, v172
    v_cmp_class_f32 s[58:59], v2, s57
    s_or_b64 vcc, vcc, s[68:69]
    s_or_b64 vcc, vcc, s[58:59]
    s_cbranch_vccnz L_truemax1
    v_rcp_f32 v2, v172
    s_nop 0
    v_pk_mul_f32 v[152:153], v[152:153], v[2:3] op_sel_hi:[1,0]
    v_pk_mul_f32 v[154:155], v[154:155], v[2:3] op_sel_hi:[1,0]
    v_pk_mul_f32 v[156:157], v[156:157], v[2:3] op_sel_hi:[1,0]
    v_pk_mul_f32 v[158:159], v[158:159], v[2:3] op_sel_hi:[1,0]
    v_pk_mul_f32 v[160:161], v[160:161], v[2:3] op_sel_hi:[1,0]
    v_pk_mul_f32 v[162:163], v[162:163], v[2:3] op_sel_hi:[1,0]
    v_pk_mul_f32 v[164:165], v[164:165], v[2:3] op_sel_hi:[1,0]
    v_pk_mul_f32 v[166:167], v[166:167], v[2:3] op_sel_hi:[1,0]
    v_cvt_pk_bf16_f32 v184, v152, v153
    v_cvt_pk_bf16_f32 v185, v154, v155
    v_cvt_pk_bf16_f32 v186, v156, v157
    v_cvt_pk_bf16_f32 v187, v158, v159
    v_cvt_pk_bf16_f32 v188, v160, v161
    v_cvt_pk_bf16_f32 v189, v162, v163
    v_cvt_pk_bf16_f32 v190, v164, v165
    v_cvt_pk_bf16_f32 v191, v166, v167
L_norm1:
    s_nop 0
    v_permlane32_swap_b32 v184, v188
    v_permlane32_swap_b32 v185, v189
    v_permlane32_swap_b32 v186, v190
    v_permlane32_swap_b32 v187, v191
    v_permlane16_swap_b32 v184, v188
    v_permlane16_swap_b32 v185, v189
    v_permlane16_swap_b32 v186, v190
    v_permlane16_swap_b32 v187, v191
    buffer_store_dwordx4 v[184:187], v1, s[44:47], s80 offen offset:2048 sc1
    buffer_store_dwordx4 v[188:191], v1, s[44:47], s80 offen offset:3072 sc1
    s_add_u32 s56, s65, 32768
    s_waitcnt lgkmcnt(10)
    v_mfma_f32_16x16x32_bf16 v[16:19], v[136:139], v[176:179], 0
    ds_read_b64_tr_b16 v[56:57], v8 offset:4096
    v_mfma_f32_16x16x32_bf16 v[20:23], v[136:139], v[180:183], 0
    s_waitcnt lgkmcnt(9)
    ds_read_b64_tr_b16 v[58:59], v8 offset:5120
    v_mfma_f32_16x16x32_bf16 v[24:27], v[140:143], v[176:179], 0
    ds_read_b64_tr_b16 v[60:61], v9 offset:4096
    v_mfma_f32_16x16x32_bf16 v[28:31], v[140:143], v[180:183], 0
    s_waitcnt lgkmcnt(9)
    ds_read_b64_tr_b16 v[62:63], v9 offset:5120
    v_mfma_f32_16x16x32_bf16 v[32:35], v[144:147], v[176:179], 0
    buffer_load_dwordx4 v[64:67], v1, s[44:47], s89 offen offset:0 sc1
    v_mfma_f32_16x16x32_bf16 v[36:39], v[144:147], v[180:183], 0
    s_waitcnt lgkmcnt(8)
    ds_read_b64_tr_b16 v[136:137], v6 offset:8192
    ds_read_b64_tr_b16 v[138:139], v6 offset:9216
    v_mfma_f32_16x16x32_bf16 v[40:43], v[148:151], v[176:179], 0
    ds_read_b64_tr_b16 v[140:141], v7 offset:8192
    v_mfma_f32_16x16x32_bf16 v[44:47], v[148:151], v[180:183], 0
    s_waitcnt lgkmcnt(9)
    ds_read_b64_tr_b16 v[142:143], v7 offset:9216
    v_mfma_f32_16x16x32_bf16 v[16:19], v[48:51], v[184:187], v[16:19]
    buffer_load_dwordx4 v[68:71], v1, s[44:47], s89 offen offset:1024 sc1
    v_mfma_f32_16x16x32_bf16 v[20:23], v[48:51], v[188:191], v[20:23]
    s_waitcnt lgkmcnt(8)
    ds_read_b64_tr_b16 v[144:145], v8 offset:8192
    ds_read_b64_tr_b16 v[146:147], v8 offset:9216
    v_mfma_f32_16x16x32_bf16 v[24:27], v[52:55], v[184:187], v[24:27]
    s_waitcnt vmcnt(16)
    ds_read_b64_tr_b16 v[148:149], v9 offset:8192
    v_max_u32 v5, v192, v193
    v_mfma_f32_16x16x32_bf16 v[28:31], v[52:55], v[188:191], v[28:31]
    s_waitcnt lgkmcnt(9)
    ds_read_b64_tr_b16 v[150:151], v9 offset:9216
    v_max3_u32 v5, v5, v194, v195
    v_max3_u32 v5, v5, v196, v197
    v_max3_u32 v5, v5, v198, v199
    v_max3_u32 v5, v5, v200, v201
    v_max3_u32 v5, v5, v202, v203
    v_max3_u32 v5, v5, v204, v205
    v_max3_u32 v5, v5, v206, v207
    v_cmp_eq_u32 vcc, -1, v5
    v_mfma_f32_16x16x32_bf16 v[32:35], v[56:59], v[184:187], v[32:35]
    buffer_load_dwordx4 v[72:75], v1, s[44:47], s90 offen offset:0 sc1
    v_mfma_f32_16x16x32_bf16 v[36:39], v[56:59], v[188:191], v[36:39]
    s_waitcnt lgkmcnt(8)
    ds_read_b64_tr_b16 v[48:49], v6 offset:16384
    ds_read_b64_tr_b16 v[50:51], v6 offset:17408
    v_mfma_f32_16x16x32_bf16 v[40:43], v[60:63], v[184:187], v[40:43]
    s_cbranch_vccnz L_retry1
L_ok1:
    s_waitcnt vmcnt(16)
    ds_read_b64_tr_b16 v[52:53], v7 offset:16384
    v_max_u32 v4, v208, v209
    v_mfma_f32_16x16x32_bf16 v[44:47], v[60:63], v[188:191], v[44:47]
    s_waitcnt lgkmcnt(9)
    ds_read_b64_tr_b16 v[54:55], v7 offset:17408
    v_max3_u32 v4, v4, v210, v211
    v_mfma_f32_16x16x32_bf16 v[16:19], v[136:139], v[192:195], v[16:19]
    buffer_load_dwordx4 v[76:79], v1, s[44:47], s90 offen offset:1024 sc1
    v_mfma_f32_16x16x32_bf16 v[20:23], v[136:139], v[196:199], v[20:23]
    s_waitcnt lgkmcnt(8)
    ds_read_b64_tr_b16 v[56:57], v8 offset:16384
    ds_read_b64_tr_b16 v[58:59], v8 offset:17408
    v_mfma_f32_16x16x32_bf16 v[24:27], v[140:143], v[192:195], v[24:27]
    s_waitcnt vmcnt(16)
    ds_read_b64_tr_b16 v[60:61], v9 offset:16384
    v_max3_u32 v4, v4, v212, v213
L_pg6:
    s_cbranch_execz L_pgret
    v_mfma_f32_16x16x32_bf16 v[28:31], v[140:143], v[196:199], v[28:31]
    s_waitcnt lgkmcnt(9)
    ds_read_b64_tr_b16 v[62:63], v9 offset:17408
    v_max3_u32 v4, v4, v214, v215
    v_mfma_f32_16x16x32_bf16 v[32:35], v[144:147], v[192:195], v[32:35]
    buffer_load_dwordx4 v[80:83], v1, s[44:47], s91 offen offset:0 sc1
    v_mfma_f32_16x16x32_bf16 v[36:39], v[144:147], v[196:199], v[36:39]
    s_waitcnt lgkmcnt(8)
    ds_read_b64_tr_b16 v[136:137], v6 offset:24576
    ds_read_b64_tr_b16 v[138:139], v6 offset:25600
    v_mfma_f32_16x16x32_bf16 v[40:43], v[148:151], v[192:195], v[40:43]
    s_waitcnt vmcnt(16)
    ds_read_b64_tr_b16 v[140:141], v7 offset:24576
    v_max3_u32 v4, v4, v216, v217
    v_mfma_f32_16x16x32_bf16 v[44:47], v[148:151], v[196:199], v[44:47]
    s_waitcnt lgkmcnt(9)
    ds_read_b64_tr_b16 v[142:143], v7 offset:25600
    v_max3_u32 v4, v4, v218, v219
    v_mfma_f32_16x16x32_bf16 v[16:19], v[48:51], v[200:203], v[16:19]
    buffer_load_dwordx4 v[84:87], v1, s[44:47], s91 offen offset:1024 sc1
    v_mfma_f32_16x16x32_bf16 v[20:23], v[48:51], v[204:207], v[20:23]
    s_waitcnt lgkmcnt(8)
    ds_read_b64_tr_b16 v[144:145], v8 offset:24576
    ds_read_b64_tr_b16 v[146:147], v8 offset:25600
    v_mfma_f32_16x16x32_bf16 v[24:27], v[52:55], v[200:203], v[24:27]
    s_waitcnt vmcnt(16)
    ds_read_b64_tr_b16 v[148:149], v9 offset:24576
    v_max3_u32 v4, v4, v220, v221
    v_mfma_f32_16x16x32_bf16 v[28:31], v[52:55], v[204:207], v[28:31]
    s_waitcnt lgkmcnt(9)
    ds_read_b64_tr_b16 v[150:151], v9 offset:25600
    v_max3_u32 v4, v4, v222, v223
    v_cmp_eq_u32 vcc, -1, v4
    v_mfma_f32_16x16x32_bf16 v[32:35], v[56:59], v[200:203], v[32:35]
    buffer_load_dwordx4 v[88:91], v1, s[44:47], s92 offen offset:0 sc1
    v_mfma_f32_16x16x32_bf16 v[36:39], v[56:59], v[204:207], v[36:39]
    s_waitcnt lgkmcnt(8)
    ds_read_b64_tr_b16 v[48:49], v6 offset:32768
    ds_read_b64_tr_b16 v[50:51], v6 offset:33792
    v_mfma_f32_16x16x32_bf16 v[40:43], v[60:63], v[200:203], v[40:43]
    s_cbranch_vccnz L_retry2
L_ok2:
    s_waitcnt vmcnt(16)
    ds_read_b64_tr_b16 v[52:53], v7 offset:32768
    v_max_u32 v5, v224, v225
    v_mfma_f32_16x16x32_bf16 v[44:47], v[60:63], v[204:207], v[44:47]
    s_waitcnt lgkmcnt(9)
    ds_read_b64_tr_b16 v[54:55], v7 offset:33792
    v_max3_u32 v5, v5, v226, v227
    v_mfma_f32_16x16x32_bf16 v[16:19], v[136:139], v[208:211], v[16:19]
    buffer_load_dwordx4 v[92:95], v1, s[44:47], s92 offen offset:1024 sc1
    v_mfma_f32_16x16x32_bf16 v[20:23], v[136:139], v[212:215], v[20:23]
    s_waitcnt lgkmcnt(8)
    ds_read_b64_tr_b16 v[56:57], v8 offset:32768
    ds_read_b64_tr_b16 v[58:59], v8 offset:33792
    v_mfma_f32_16x16x32_bf16 v[24:27], v[140:143], v[208:211], v[24:27]
    s_waitcnt vmcnt(16)
    ds_read_b64_tr_b16 v[60:61], v9 offset:32768
    v_max3_u32 v5, v5, v228, v229
    v_mfma_f32_16x16x32_bf16 v[28:31], v[140:143], v[212:215], v[28:31]
    s_waitcnt lgkmcnt(9)
    ds_read_b64_tr_b16 v[62:63], v9 offset:33792
    v_max3_u32 v5, v5, v230, v231
    v_mfma_f32_16x16x32_bf16 v[32:35], v[144:147], v[208:211], v[32:35]
    buffer_load_dwordx4 v[96:99], v1, s[44:47], s93 offen offset:0 sc1
    v_mfma_f32_16x16x32_bf16 v[36:39], v[144:147], v[212:215], v[36:39]
    s_waitcnt lgkmcnt(8)
    ds_read_b64_tr_b16 v[136:137], v6 offset:40960
    ds_read_b64_tr_b16 v[138:139], v6 offset:41984
    v_mfma_f32_16x16x32_bf16 v[40:43], v[148:151], v[208:211], v[40:43]
    s_waitcnt vmcnt(16)
    ds_read_b64_tr_b16 v[140:141], v7 offset:40960
    v_max3_u32 v5, v5, v232, v233
    v_mfma_f32_16x16x32_bf16 v[44:47], v[148:151], v[212:215], v[44:47]
    s_waitcnt lgkmcnt(9)
    ds_read_b64_tr_b16 v[142:143], v7 offset:41984
    v_max3_u32 v5, v5, v234, v235
    v_mfma_f32_16x16x32_bf16 v[16:19], v[48:51], v[216:219], v[16:19]
    buffer_load_dwordx4 v[100:103], v1, s[44:47], s93 offen offset:1024 sc1
    v_mfma_f32_16x16x32_bf16 v[20:23], v[48:51], v[220:223], v[20:23]
    s_waitcnt lgkmcnt(8)
    ds_read_b64_tr_b16 v[144:145], v8 offset:40960
    ds_read_b64_tr_b16 v[146:147], v8 offset:41984
    v_mfma_f32_16x16x32_bf16 v[24:27], v[52:55], v[216:219], v[24:27]
    s_waitcnt vmcnt(16)
    ds_read_b64_tr_b16 v[148:149], v9 offset:40960
    v_max3_u32 v5, v5, v236, v237
    v_mfma_f32_16x16x32_bf16 v[28:31], v[52:55], v[220:223], v[28:31]
    s_waitcnt lgkmcnt(9)
    ds_read_b64_tr_b16 v[150:151], v9 offset:41984
    v_max3_u32 v5, v5, v238, v239
    v_cmp_eq_u32 vcc, -1, v5
    v_mfma_f32_16x16x32_bf16 v[32:35], v[56:59], v[216:219], v[32:35]
    buffer_load_dwordx4 v[104:107], v1, s[44:47], s94 offen offset:0 sc1
    v_mfma_f32_16x16x32_bf16 v[36:39], v[56:59], v[220:223], v[36:39]
    s_waitcnt lgkmcnt(8)
    ds_read_b64_tr_b16 v[48:49], v6 offset:49152
    ds_read_b64_tr_b16 v[50:51], v6 offset:50176
    v_mfma_f32_16x16x32_bf16 v[40:43], v[60:63], v[216:219], v[40:43]
    s_cbranch_vccnz L_retry3
L_ok3:
    s_waitcnt vmcnt(16)
    ds_read_b64_tr_b16 v[52:53], v7 offset:49152
    v_max_u32 v4, v240, v241
    v_mfma_f32_16x16x32_bf16 v[44:47], v[60:63], v[220:223], v[44:47]
    s_waitcnt lgkmcnt(9)
    ds_read_b64_tr_b16 v[54:55], v7 offset:50176
    v_max3_u32 v4, v4, v242, v243
    v_mfma_f32_16x16x32_bf16 v[16:19], v[136:139], v[224:227], v[16:19]
    buffer_load_dwordx4 v[108:111], v1, s[44:47], s94 offen offset:1024 sc1
    v_mfma_f32_16x16x32_bf16 v[20:23], v[136:139], v[228:231], v[20:23]
    s_waitcnt lgkmcnt(8)
    ds_read_b64_tr_b16 v[56:57], v8 offset:49152
    ds_read_b64_tr_b16 v[58:59], v8 offset:50176
    v_mfma_f32_16x16x32_bf16 v[24:27], v[140:143], v[224:227], v[24:27]
    s_waitcnt vmcnt(16)
    ds_read_b64_tr_b16 v[60:61], v9 offset:49152
    v_max3_u32 v4, v4, v244, v245
    v_mfma_f32_16x16x32_bf16 v[28:31], v[140:143], v[228:231], v[28:31]
    s_waitcnt lgkmcnt(9)
    ds_read_b64_tr_b16 v[62:63], v9 offset:50176
    v_max3_u32 v4, v4, v246, v247
    v_mfma_f32_16x16x32_bf16 v[32:35], v[144:147], v[224:227], v[32:35]
    buffer_load_dwordx4 v[112:115], v1, s[44:47], s95 offen offset:0 sc1
    v_mfma_f32_16x16x32_bf16 v[36:39], v[144:147], v[228:231], v[36:39]
    s_waitcnt lgkmcnt(8)
    ds_read_b64_tr_b16 v[136:137], v6 offset:57344
    ds_read_b64_tr_b16 v[138:139], v6 offset:58368
    v_mfma_f32_16x16x32_bf16 v[40:43], v[148:151], v[224:227], v[40:43]
    s_waitcnt vmcnt(16)
    ds_read_b64_tr_b16 v[140:141], v7 offset:57344
    v_max3_u32 v4, v4, v248, v249
    v_mfma_f32_16x16x32_bf16 v[44:47], v[148:151], v[228:231], v[44:47]
    s_waitcnt lgkmcnt(9)
    ds_read_b64_tr_b16 v[142:143], v7 offset:58368
    v_max3_u32 v4, v4, v250, v251
    v_mfma_f32_16x16x32_bf16 v[16:19], v[48:51], v[232:235], v[16:19]
    buffer_load_dwordx4 v[116:119], v1, s[44:47], s95 offen offset:1024 sc1
    v_mfma_f32_16x16x32_bf16 v[20:23], v[48:51], v[236:239], v[20:23]
    s_waitcnt lgkmcnt(8)
    ds_read_b64_tr_b16 v[144:145], v8 offset:57344
    ds_read_b64_tr_b16 v[146:147], v8 offset:58368
    v_mfma_f32_16x16x32_bf16 v[24:27], v[52:55], v[232:235], v[24:27]
    s_waitcnt vmcnt(16)
    ds_read_b64_tr_b16 v[148:149], v9 offset:57344
    v_max3_u32 v4, v4, v252, v253
    v_mfma_f32_16x16x32_bf16 v[28:31], v[52:55], v[236:239], v[28:31]
    s_waitcnt lgkmcnt(9)
    ds_read_b64_tr_b16 v[150:151], v9 offset:58368
    v_max3_u32 v4, v4, v254, v255
    v_cmp_eq_u32 vcc, -1, v4
    v_mfma_f32_16x16x32_bf16 v[32:35], v[56:59], v[232:235], v[32:35]
    buffer_load_dwordx4 v[120:123], v1, s[44:47], s81 offen offset:2048 sc1
    v_mfma_f32_16x16x32_bf16 v[36:39], v[56:59], v[236:239], v[36:39]
    s_waitcnt lgkmcnt(8)
    ds_read_b64_tr_b16 v[48:49], v168 offset:0
    ds_read_b64_tr_b16 v[50:51], v168 offset:1024
    v_mfma_f32_16x16x32_bf16 v[40:43], v[60:63], v[232:235], v[40:43]
    s_cbranch_vccnz L_retry4
L_ok4:
    s_waitcnt vmcnt(14)
    ds_read_b64_tr_b16 v[52:53], v169 offset:0
    v_max_u32 v5, v64, v65
    v_mfma_f32_16x16x32_bf16 v[44:47], v[60:63], v[236:239], v[44:47]
    s_waitcnt lgkmcnt(9)
    ds_read_b64_tr_b16 v[54:55], v169 offset:1024
    v_max3_u32 v5, v5, v66, v67
    v_mfma_f32_16x16x32_bf16 v[16:19], v[136:139], v[240:243], v[16:19]
    buffer_load_dwordx4 v[124:127], v1, s[44:47], s81 offen offset:3072 sc1
    v_mfma_f32_16x16x32_bf16 v[20:23], v[136:139], v[244:247], v[20:23]
    s_waitcnt lgkmcnt(8)
    ds_read_b64_tr_b16 v[56:57], v170 offset:0
    ds_read_b64_tr_b16 v[58:59], v170 offset:1024
    v_mfma_f32_16x16x32_bf16 v[24:27], v[140:143], v[240:243], v[24:27]
    s_waitcnt vmcnt(14)
    ds_read_b64_tr_b16 v[60:61], v171 offset:0
    v_max3_u32 v5, v5, v68, v69
    v_mfma_f32_16x16x32_bf16 v[28:31], v[140:143], v[244:247], v[28:31]
    s_waitcnt lgkmcnt(9)
    ds_read_b64_tr_b16 v[62:63], v171 offset:1024
    v_max3_u32 v5, v5, v70, v71
    v_mfma_f32_16x16x32_bf16 v[32:35], v[144:147], v[240:243], v[32:35]
    buffer_load_dwordx4 v[192:195], v1, s[44:47], s82 offen offset:2048 sc1
    v_mfma_f32_16x16x32_bf16 v[36:39], v[144:147], v[244:247], v[36:39]
    s_waitcnt lgkmcnt(8)
    ds_read_b64_tr_b16 v[136:137], v168 offset:8192
    ds_read_b64_tr_b16 v[138:139], v168 offset:9216
    v_mfma_f32_16x16x32_bf16 v[40:43], v[148:151], v[240:243], v[40:43]
    s_waitcnt vmcnt(14)
    ds_read_b64_tr_b16 v[140:141], v169 offset:8192
    v_max3_u32 v5, v5, v72, v73
    v_mfma_f32_16x16x32_bf16 v[44:47], v[148:151], v[244:247], v[44:47]
    s_waitcnt lgkmcnt(9)
    ds_read_b64_tr_b16 v[142:143], v169 offset:9216
    v_max3_u32 v5, v5, v74, v75
    v_mfma_f32_16x16x32_bf16 v[16:19], v[48:51], v[248:251], v[16:19]
    buffer_load_dwordx4 v[196:199], v1, s[44:47], s82 offen offset:3072 sc1
    v_mfma_f32_16x16x32_bf16 v[20:23], v[48:51], v[252:255], v[20:23]
    s_waitcnt lgkmcnt(8)
    ds_read_b64_tr_b16 v[144:145], v170 offset:8192
    ds_read_b64_tr_b16 v[146:147], v170 offset:9216
    v_mfma_f32_16x16x32_bf16 v[24:27], v[52:55], v[248:251], v[24:27]
    s_waitcnt vmcnt(14)
    ds_read_b64_tr_b16 v[148:149], v171 offset:8192
    v_max3_u32 v5, v5, v76, v77
    v_mfma_f32_16x16x32_bf16 v[28:31], v[52:55], v[252:255], v[28:31]
    s_waitcnt lgkmcnt(9)
    ds_read_b64_tr_b16 v[150:151], v171 offset:9216
    v_max3_u32 v5, v5, v78, v79
    v_cmp_eq_u32 vcc, -1, v5
    v_mfma_f32_16x16x32_bf16 v[32:35], v[56:59], v[248:251], v[32:35]
    buffer_load_dwordx4 v[200:203], v1, s[44:47], s83 offen offset:2048 sc1
    v_mfma_f32_16x16x32_bf16 v[36:39], v[56:59], v[252:255], v[36:39]
    s_waitcnt lgkmcnt(8)
    ds_read_b64_tr_b16 v[48:49], v168 offset:16384
    ds_read_b64_tr_b16 v[50:51], v168 offset:17408
    v_mfma_f32_16x16x32_bf16 v[40:43], v[60:63], v[248:251], v[40:43]
    s_cbranch_vccnz L_retry5
L_ok5:
    s_waitcnt vmcnt(14)
    ds_read_b64_tr_b16 v[52:53], v169 offset:16384
    v_max_u32 v4, v80, v81
    v_mfma_f32_16x16x32_bf16 v[44:47], v[60:63], v[252:255], v[44:47]
    s_waitcnt lgkmcnt(9)
    ds_read_b64_tr_b16 v[54:55], v169 offset:17408
    v_max3_u32 v4, v4, v82, v83
    v_mfma_f32_16x16x32_bf16 v[16:19], v[136:139], v[64:67], v[16:19]
    buffer_load_dwordx4 v[204:207], v1, s[44:47], s83 offen offset:3072 sc1
    v_mfma_f32_16x16x32_bf16 v[20:23], v[136:139], v[68:71], v[20:23]
    s_waitcnt lgkmcnt(8)
    ds_read_b64_tr_b16 v[56:57], v170 offset:16384
    ds_read_b64_tr_b16 v[58:59], v170 offset:17408
    v_mfma_f32_16x16x32_bf16 v[24:27], v[140:143], v[64:67], v[24:27]
    s_barrier
    s_waitcnt vmcnt(14)
    ds_read_b64_tr_b16 v[60:61], v171 offset:16384
    v_max3_u32 v4, v4, v84, v85
    v_mfma_f32_16x16x32_bf16 v[28:31], v[140:143], v[68:71], v[28:31]
    s_waitcnt lgkmcnt(9)
    ds_read_b64_tr_b16 v[62:63], v171 offset:17408
    v_max3_u32 v4, v4, v86, v87
    v_mfma_f32_16x16x32_bf16 v[32:35], v[144:147], v[64:67], v[32:35]
    buffer_load_dwordx4 v[208:211], v1, s[44:47], s84 offen offset:2048 sc1
    v_mfma_f32_16x16x32_bf16 v[36:39], v[144:147], v[68:71], v[36:39]
    s_waitcnt lgkmcnt(8)
    ds_read_b64_tr_b16 v[136:137], v168 offset:24576
    ds_read_b64_tr_b16 v[138:139], v168 offset:25600
    v_mfma_f32_16x16x32_bf16 v[40:43], v[148:151], v[64:67], v[40:43]
    s_waitcnt vmcnt(14)
    ds_read_b64_tr_b16 v[140:141], v169 offset:24576
    v_max3_u32 v4, v4, v88, v89
    v_mfma_f32_16x16x32_bf16 v[44:47], v[148:151], v[68:71], v[44:47]
    s_waitcnt lgkmcnt(9)
    ds_read_b64_tr_b16 v[142:143], v169 offset:25600
    v_max3_u32 v4, v4, v90, v91
    v_mfma_f32_16x16x32_bf16 v[16:19], v[48:51], v[72:75], v[16:19]
    buffer_load_dwordx4 v[212:215], v1, s[44:47], s84 offen offset:3072 sc1
    v_mfma_f32_16x16x32_bf16 v[20:23], v[48:51], v[76:79], v[20:23]
    s_waitcnt lgkmcnt(8)
    ds_read_b64_tr_b16 v[144:145], v170 offset:24576
    ds_read_b64_tr_b16 v[146:147], v170 offset:25600
    v_mfma_f32_16x16x32_bf16 v[24:27], v[52:55], v[72:75], v[24:27]
    s_waitcnt vmcnt(14)
    ds_read_b64_tr_b16 v[148:149], v171 offset:24576
    v_max3_u32 v4, v4, v92, v93
    v_mfma_f32_16x16x32_bf16 v[28:31], v[52:55], v[76:79], v[28:31]
    s_waitcnt lgkmcnt(9)
    ds_read_b64_tr_b16 v[150:151], v171 offset:25600
    v_max3_u32 v4, v4, v94, v95
    v_cmp_eq_u32 vcc, -1, v4
    v_mfma_f32_16x16x32_bf16 v[32:35], v[56:59], v[72:75], v[32:35]
    buffer_load_dwordx4 v[216:219], v1, s[44:47], s85 offen offset:2048 sc1
    v_mfma_f32_16x16x32_bf16 v[36:39], v[56:59], v[76:79], v[36:39]
    s_waitcnt lgkmcnt(8)
    ds_read_b64_tr_b16 v[48:49], v168 offset:32768
    ds_read_b64_tr_b16 v[50:51], v168 offset:33792
    v_mfma_f32_16x16x32_bf16 v[40:43], v[60:63], v[72:75], v[40:43]
    s_cbranch_vccnz L_retry6
L_ok6:
    s_waitcnt vmcnt(14)
    ds_read_b64_tr_b16 v[52:53], v169 offset:32768
    v_max_u32 v5, v96, v97
    v_mfma_f32_16x16x32_bf16 v[44:47], v[60:63], v[76:79], v[44:47]
    s_waitcnt lgkmcnt(9)
    ds_read_b64_tr_b16 v[54:55], v169 offset:33792
    v_max3_u32 v5, v5, v98, v99
    v_mfma_f32_16x16x32_bf16 v[16:19], v[136:139], v[80:83], v[16:19]
    buffer_load_dwordx4 v[220:223], v1, s[44:47], s85 offen offset:3072 sc1
    v_mfma_f32_16x16x32_bf16 v[20:23], v[136:139], v[84:87], v[20:23]
    s_waitcnt lgkmcnt(8)
    ds_read_b64_tr_b16 v[56:57], v170 offset:32768
    ds_read_b64_tr_b16 v[58:59], v170 offset:33792
    v_mfma_f32_16x16x32_bf16 v[24:27], v[140:143], v[80:83], v[24:27]
    s_waitcnt vmcnt(14)
    ds_read_b64_tr_b16 v[60:61], v171 offset:32768
    v_max3_u32 v5, v5, v100, v101
    v_mfma_f32_16x16x32_bf16 v[28:31], v[140:143], v[84:87], v[28:31]
    s_waitcnt lgkmcnt(9)
    ds_read_b64_tr_b16 v[62:63], v171 offset:33792
    v_max3_u32 v5, v5, v102, v103
    v_mfma_f32_16x16x32_bf16 v[32:35], v[144:147], v[80:83], v[32:35]
    buffer_load_dwordx4 v[224:227], v1, s[44:47], s86 offen offset:2048 sc1
    v_mfma_f32_16x16x32_bf16 v[36:39], v[144:147], v[84:87], v[36:39]
    s_waitcnt lgkmcnt(8)
    ds_read_b64_tr_b16 v[136:137], v168 offset:40960
    ds_read_b64_tr_b16 v[138:139], v168 offset:41984
    v_mfma_f32_16x16x32_bf16 v[40:43], v[148:151], v[80:83], v[40:43]
    s_waitcnt vmcnt(14)
    ds_read_b64_tr_b16 v[140:141], v169 offset:40960
    v_max3_u32 v5, v5, v104, v105
    v_mfma_f32_16x16x32_bf16 v[44:47], v[148:151], v[84:87], v[44:47]
    s_waitcnt lgkmcnt(9)
    ds_read_b64_tr_b16 v[142:143], v169 offset:41984
    v_max3_u32 v5, v5, v106, v107
    v_mfma_f32_16x16x32_bf16 v[16:19], v[48:51], v[88:91], v[16:19]
    buffer_load_dwordx4 v[228:231], v1, s[44:47], s86 offen offset:3072 sc1
    v_mfma_f32_16x16x32_bf16 v[20:23], v[48:51], v[92:95], v[20:23]
    s_waitcnt lgkmcnt(8)
    ds_read_b64_tr_b16 v[144:145], v170 offset:40960
    ds_read_b64_tr_b16 v[146:147], v170 offset:41984
    v_mfma_f32_16x16x32_bf16 v[24:27], v[52:55], v[88:91], v[24:27]
    s_waitcnt vmcnt(14)
    ds_read_b64_tr_b16 v[148:149], v171 offset:40960
    v_max3_u32 v5, v5, v108, v109
    v_mfma_f32_16x16x32_bf16 v[28:31], v[52:55], v[92:95], v[28:31]
    s_waitcnt lgkmcnt(9)
    ds_read_b64_tr_b16 v[150:151], v171 offset:41984
    v_max3_u32 v5, v5, v110, v111
    v_cmp_eq_u32 vcc, -1, v5
    v_mfma_f32_16x16x32_bf16 v[32:35], v[56:59], v[88:91], v[32:35]
    buffer_load_dwordx4 v[232:235], v1, s[44:47], s87 offen offset:2048 sc1
    v_mfma_f32_16x16x32_bf16 v[36:39], v[56:59], v[92:95], v[36:39]
    s_waitcnt lgkmcnt(8)
    ds_read_b64_tr_b16 v[48:49], v168 offset:49152
    ds_read_b64_tr_b16 v[50:51], v168 offset:50176
    v_mfma_f32_16x16x32_bf16 v[40:43], v[60:63], v[88:91], v[40:43]
    s_cbranch_vccnz L_retry7
L_ok7:
    s_waitcnt vmcnt(14)
    ds_read_b64_tr_b16 v[52:53], v169 offset:49152
    v_max_u32 v4, v112, v113
    v_mfma_f32_16x16x32_bf16 v[44:47], v[60:63], v[92:95], v[44:47]
    s_waitcnt lgkmcnt(9)
    ds_read_b64_tr_b16 v[54:55], v169 offset:50176
    v_max3_u32 v4, v4, v114, v115
    v_mfma_f32_16x16x32_bf16 v[16:19], v[136:139], v[96:99], v[16:19]
    buffer_load_dwordx4 v[236:239], v1, s[44:47], s87 offen offset:3072 sc1
    v_mfma_f32_16x16x32_bf16 v[20:23], v[136:139], v[100:103], v[20:23]
    s_waitcnt lgkmcnt(8)
    ds_read_b64_tr_b16 v[56:57], v170 offset:49152
    ds_read_b64_tr_b16 v[58:59], v170 offset:50176
    v_mfma_f32_16x16x32_bf16 v[24:27], v[140:143], v[96:99], v[24:27]
    s_waitcnt vmcnt(14)
    ds_read_b64_tr_b16 v[60:61], v171 offset:49152
    v_max3_u32 v4, v4, v116, v117
    v_mfma_f32_16x16x32_bf16 v[28:31], v[140:143], v[100:103], v[28:31]
    s_waitcnt lgkmcnt(9)
    ds_read_b64_tr_b16 v[62:63], v171 offset:50176
    v_max3_u32 v4, v4, v118, v119
    v_mfma_f32_16x16x32_bf16 v[32:35], v[144:147], v[96:99], v[32:35]
    buffer_load_dwordx4 v[240:243], v1, s[44:47], s88 offen offset:2048 sc1
    v_mfma_f32_16x16x32_bf16 v[36:39], v[144:147], v[100:103], v[36:39]
    s_waitcnt lgkmcnt(8)
    ds_read_b64_tr_b16 v[136:137], v168 offset:57344
    ds_read_b64_tr_b16 v[138:139], v168 offset:58368
    v_mfma_f32_16x16x32_bf16 v[40:43], v[148:151], v[96:99], v[40:43]
    s_waitcnt vmcnt(14)
    ds_read_b64_tr_b16 v[140:141], v169 offset:57344
    v_max3_u32 v4, v4, v120, v121
    v_mfma_f32_16x16x32_bf16 v[44:47], v[148:151], v[100:103], v[44:47]
    s_waitcnt lgkmcnt(9)
    ds_read_b64_tr_b16 v[142:143], v169 offset:58368
    v_max3_u32 v4, v4, v122, v123
    v_mfma_f32_16x16x32_bf16 v[16:19], v[48:51], v[104:107], v[16:19]
    buffer_load_dwordx4 v[244:247], v1, s[44:47], s88 offen offset:3072 sc1
    v_mfma_f32_16x16x32_bf16 v[20:23], v[48:51], v[108:111], v[20:23]
    s_waitcnt lgkmcnt(8)
    ds_read_b64_tr_b16 v[144:145], v170 offset:57344
    ds_read_b64_tr_b16 v[146:147], v170 offset:58368
    v_mfma_f32_16x16x32_bf16 v[24:27], v[52:55], v[104:107], v[24:27]
    s_waitcnt vmcnt(14)
    ds_read_b64_tr_b16 v[148:149], v171 offset:57344
    v_max3_u32 v4, v4, v124, v125
    v_mfma_f32_16x16x32_bf16 v[28:31], v[52:55], v[108:111], v[28:31]
    s_waitcnt lgkmcnt(9)
    ds_read_b64_tr_b16 v[150:151], v171 offset:58368
    v_max3_u32 v4, v4, v126, v127
    v_cmp_eq_u32 vcc, -1, v4
    v_mfma_f32_16x16x32_bf16 v[32:35], v[56:59], v[104:107], v[32:35]
    buffer_load_dwordx4 v[248:251], v1, s[44:47], s89 offen offset:2048 sc1
    v_mfma_f32_16x16x32_bf16 v[36:39], v[56:59], v[108:111], v[36:39]
    s_waitcnt lgkmcnt(8)
    ds_read_b64_tr_b16 v[48:49], v6 offset:12288
    ds_read_b64_tr_b16 v[50:51], v6 offset:13312
    v_mfma_f32_16x16x32_bf16 v[40:43], v[60:63], v[104:107], v[40:43]
    s_cbranch_vccnz L_retry8
L_ok8:
    s_waitcnt vmcnt(14)
    ds_read_b64_tr_b16 v[52:53], v7 offset:12288
    v_max_u32 v5, v192, v193
    v_mfma_f32_16x16x32_bf16 v[44:47], v[60:63], v[108:111], v[44:47]
    s_waitcnt lgkmcnt(9)
    ds_read_b64_tr_b16 v[54:55], v7 offset:13312
    v_max3_u32 v5, v5, v194, v195
    v_mfma_f32_16x16x32_bf16 v[16:19], v[136:139], v[112:115], v[16:19]
    buffer_load_dwordx4 v[252:255], v1, s[44:47], s89 offen offset:3072 sc1
    v_mfma_f32_16x16x32_bf16 v[20:23], v[136:139], v[116:119], v[20:23]
    s_waitcnt lgkmcnt(8)
    ds_read_b64_tr_b16 v[56:57], v8 offset:12288
    ds_read_b64_tr_b16 v[58:59], v8 offset:13312
    v_mfma_f32_16x16x32_bf16 v[24:27], v[140:143], v[112:115], v[24:27]
    s_waitcnt vmcnt(14)
    ds_read_b64_tr_b16 v[60:61], v9 offset:12288
    v_max3_u32 v5, v5, v196, v197
    v_mfma_f32_16x16x32_bf16 v[28:31], v[140:143], v[116:119], v[28:31]
    s_waitcnt lgkmcnt(9)
    ds_read_b64_tr_b16 v[62:63], v9 offset:13312
    v_max3_u32 v5, v5, v198, v199
    v_mfma_f32_16x16x32_bf16 v[32:35], v[144:147], v[112:115], v[32:35]
    buffer_load_dwordx4 v[64:67], v1, s[44:47], s90 offen offset:2048 sc1
    v_mfma_f32_16x16x32_bf16 v[36:39], v[144:147], v[116:119], v[36:39]
    s_waitcnt lgkmcnt(8)
    ds_read_b64_tr_b16 v[136:137], v6 offset:20480
    ds_read_b64_tr_b16 v[138:139], v6 offset:21504
    v_mfma_f32_16x16x32_bf16 v[40:43], v[148:151], v[112:115], v[40:43]
    s_waitcnt vmcnt(14)
    ds_read_b64_tr_b16 v[140:141], v7 offset:20480
    v_max3_u32 v5, v5, v200, v201
    v_mfma_f32_16x16x32_bf16 v[44:47], v[148:151], v[116:119], v[44:47]
    s_waitcnt lgkmcnt(9)
    ds_read_b64_tr_b16 v[142:143], v7 offset:21504
    v_max3_u32 v5, v5, v202, v203
    v_mfma_f32_16x16x32_bf16 v[16:19], v[48:51], v[120:123], v[16:19]
    buffer_load_dwordx4 v[68:71], v1, s[44:47], s90 offen offset:3072 sc1
    v_mfma_f32_16x16x32_bf16 v[20:23], v[48:51], v[124:127], v[20:23]
    s_waitcnt lgkmcnt(8)
    ds_read_b64_tr_b16 v[144:145], v8 offset:20480
    ds_read_b64_tr_b16 v[146:147], v8 offset:21504
    v_mfma_f32_16x16x32_bf16 v[24:27], v[52:55], v[120:123], v[24:27]
    s_waitcnt vmcnt(14)
    ds_read_b64_tr_b16 v[148:149], v9 offset:20480
    v_max3_u32 v5, v5, v204, v205
    v_mfma_f32_16x16x32_bf16 v[28:31], v[52:55], v[124:127], v[28:31]
    s_waitcnt lgkmcnt(9)
    ds_read_b64_tr_b16 v[150:151], v9 offset:21504
    v_max3_u32 v5, v5, v206, v207
    v_cmp_eq_u32 vcc, -1, v5
    v_mfma_f32_16x16x32_bf16 v[32:35], v[56:59], v[120:123], v[32:35]
    buffer_load_dwordx4 v[72:75], v1, s[44:47], s91 offen offset:2048 sc1
    v_mfma_f32_16x16x32_bf16 v[36:39], v[56:59], v[124:127], v[36:39]
    s_waitcnt lgkmcnt(8)
    ds_read_b64_tr_b16 v[48:49], v6 offset:28672
    ds_read_b64_tr_b16 v[50:51], v6 offset:29696
    v_mfma_f32_16x16x32_bf16 v[40:43], v[60:63], v[120:123], v[40:43]
    s_cbranch_vccnz L_retry9
L_ok9:
    s_waitcnt vmcnt(14)
    ds_read_b64_tr_b16 v[52:53], v7 offset:28672
    v_max_u32 v4, v208, v209
    v_mfma_f32_16x16x32_bf16 v[44:47], v[60:63], v[124:127], v[44:47]
    s_waitcnt lgkmcnt(9)
    ds_read_b64_tr_b16 v[54:55], v7 offset:29696
    v_max3_u32 v4, v4, v210, v211
    v_mfma_f32_16x16x32_bf16 v[16:19], v[136:139], v[192:195], v[16:19]
    buffer_load_dwordx4 v[76:79], v1, s[44:47], s91 offen offset:3072 sc1
    v_mfma_f32_16x16x32_bf16 v[20:23], v[136:139], v[196:199], v[20:23]
    s_waitcnt lgkmcnt(8)
    ds_read_b64_tr_b16 v[56:57], v8 offset:28672
    ds_read_b64_tr_b16 v[58:59], v8 offset:29696
    v_mfma_f32_16x16x32_bf16 v[24:27], v[140:143], v[192:195], v[24:27]
    s_waitcnt vmcnt(14)
    ds_read_b64_tr_b16 v[60:61], v9 offset:28672
    v_max3_u32 v4, v4, v212, v213
    v_mfma_f32_16x16x32_bf16 v[28:31], v[140:143], v[196:199], v[28:31]
    s_waitcnt lgkmcnt(9)
    ds_read_b64_tr_b16 v[62:63], v9 offset:29696
    v_max3_u32 v4, v4, v214, v215
    v_mfma_f32_16x16x32_bf16 v[32:35], v[144:147], v[192:195], v[32:35]
    buffer_load_dwordx4 v[80:83], v1, s[44:47], s92 offen offset:2048 sc1
    v_mfma_f32_16x16x32_bf16 v[36:39], v[144:147], v[196:199], v[36:39]
    s_waitcnt lgkmcnt(8)
    ds_read_b64_tr_b16 v[136:137], v6 offset:36864
    ds_read_b64_tr_b16 v[138:139], v6 offset:37888
    v_mfma_f32_16x16x32_bf16 v[40:43], v[148:151], v[192:195], v[40:43]
    s_waitcnt vmcnt(14)
    ds_read_b64_tr_b16 v[140:141], v7 offset:36864
    v_max3_u32 v4, v4, v216, v217
    v_mfma_f32_16x16x32_bf16 v[44:47], v[148:151], v[196:199], v[44:47]
    s_waitcnt lgkmcnt(9)
    ds_read_b64_tr_b16 v[142:143], v7 offset:37888
    v_max3_u32 v4, v4, v218, v219
    v_mfma_f32_16x16x32_bf16 v[16:19], v[48:51], v[200:203], v[16:19]
    buffer_load_dwordx4 v[84:87], v1, s[44:47], s92 offen offset:3072 sc1
    v_mfma_f32_16x16x32_bf16 v[20:23], v[48:51], v[204:207], v[20:23]
    s_waitcnt lgkmcnt(8)
    ds_read_b64_tr_b16 v[144:145], v8 offset:36864
    ds_read_b64_tr_b16 v[146:147], v8 offset:37888
    v_mfma_f32_16x16x32_bf16 v[24:27], v[52:55], v[200:203], v[24:27]
    s_waitcnt vmcnt(14)
    ds_read_b64_tr_b16 v[148:149], v9 offset:36864
    v_max3_u32 v4, v4, v220, v221
    v_mfma_f32_16x16x32_bf16 v[28:31], v[52:55], v[204:207], v[28:31]
    s_waitcnt lgkmcnt(9)
    ds_read_b64_tr_b16 v[150:151], v9 offset:37888
    v_max3_u32 v4, v4, v222, v223
    v_cmp_eq_u32 vcc, -1, v4
    v_mfma_f32_16x16x32_bf16 v[32:35], v[56:59], v[200:203], v[32:35]
    buffer_load_dwordx4 v[88:91], v1, s[44:47], s93 offen offset:2048 sc1
    v_mfma_f32_16x16x32_bf16 v[36:39], v[56:59], v[204:207], v[36:39]
    s_waitcnt lgkmcnt(8)
    ds_read_b64_tr_b16 v[48:49], v6 offset:45056
    ds_read_b64_tr_b16 v[50:51], v6 offset:46080
    v_mfma_f32_16x16x32_bf16 v[40:43], v[60:63], v[200:203], v[40:43]
    s_cbranch_vccnz L_retry10
L_ok10:
    s_waitcnt vmcnt(14)
    ds_read_b64_tr_b16 v[52:53], v7 offset:45056
    v_max_u32 v5, v224, v225
    v_mfma_f32_16x16x32_bf16 v[44:47], v[60:63], v[204:207], v[44:47]
    s_waitcnt lgkmcnt(9)
    ds_read_b64_tr_b16 v[54:55], v7 offset:46080
    v_max3_u32 v5, v5, v226, v227
    v_mfma_f32_16x16x32_bf16 v[16:19], v[136:139], v[208:211], v[16:19]
    buffer_load_dwordx4 v[92:95], v1, s[44:47], s93 offen offset:3072 sc1
    v_mfma_f32_16x16x32_bf16 v[20:23], v[136:139], v[212:215], v[20:23]
    s_waitcnt lgkmcnt(8)
    ds_read_b64_tr_b16 v[56:57], v8 offset:45056
    ds_read_b64_tr_b16 v[58:59], v8 offset:46080
    v_mfma_f32_16x16x32_bf16 v[24:27], v[140:143], v[208:211], v[24:27]
    s_waitcnt vmcnt(14)
    ds_read_b64_tr_b16 v[60:61], v9 offset:45056
    v_max3_u32 v5, v5, v228, v229
    v_mfma_f32_16x16x32_bf16 v[28:31], v[140:143], v[212:215], v[28:31]
    s_waitcnt lgkmcnt(9)
    ds_read_b64_tr_b16 v[62:63], v9 offset:46080
    v_max3_u32 v5, v5, v230, v231
    v_mfma_f32_16x16x32_bf16 v[32:35], v[144:147], v[208:211], v[32:35]
    buffer_load_dwordx4 v[96:99], v1, s[44:47], s94 offen offset:2048 sc1
    v_mfma_f32_16x16x32_bf16 v[36:39], v[144:147], v[212:215], v[36:39]
    s_waitcnt lgkmcnt(8)
    ds_read_b64_tr_b16 v[136:137], v6 offset:53248
    ds_read_b64_tr_b16 v[138:139], v6 offset:54272
    v_mfma_f32_16x16x32_bf16 v[40:43], v[148:151], v[208:211], v[40:43]
    s_waitcnt vmcnt(14)
    ds_read_b64_tr_b16 v[140:141], v7 offset:53248
    v_max3_u32 v5, v5, v232, v233
    v_mfma_f32_16x16x32_bf16 v[44:47], v[148:151], v[212:215], v[44:47]
    s_waitcnt lgkmcnt(9)
    ds_read_b64_tr_b16 v[142:143], v7 offset:54272
    v_max3_u32 v5, v5, v234, v235
    v_mfma_f32_16x16x32_bf16 v[16:19], v[48:51], v[216:219], v[16:19]
    buffer_load_dwordx4 v[100:103], v1, s[44:47], s94 offen offset:3072 sc1
    v_mfma_f32_16x16x32_bf16 v[20:23], v[48:51], v[220:223], v[20:23]
    s_waitcnt lgkmcnt(8)
    ds_read_b64_tr_b16 v[144:145], v8 offset:53248
    ds_read_b64_tr_b16 v[146:147], v8 offset:54272
    v_mfma_f32_16x16x32_bf16 v[24:27], v[52:55], v[216:219], v[24:27]
    s_waitcnt vmcnt(14)
    ds_read_b64_tr_b16 v[148:149], v9 offset:53248
    v_max3_u32 v5, v5, v236, v237
    v_mfma_f32_16x16x32_bf16 v[28:31], v[52:55], v[220:223], v[28:31]
    s_waitcnt lgkmcnt(9)
    ds_read_b64_tr_b16 v[150:151], v9 offset:54272
    v_max3_u32 v5, v5, v238, v239
    v_cmp_eq_u32 vcc, -1, v5
    v_mfma_f32_16x16x32_bf16 v[32:35], v[56:59], v[216:219], v[32:35]
    buffer_load_dwordx4 v[104:107], v1, s[44:47], s95 offen offset:2048 sc1
    v_mfma_f32_16x16x32_bf16 v[36:39], v[56:59], v[220:223], v[36:39]
    s_waitcnt lgkmcnt(8)
    ds_read_b64_tr_b16 v[48:49], v6 offset:61440
    ds_read_b64_tr_b16 v[50:51], v6 offset:62464
    v_mfma_f32_16x16x32_bf16 v[40:43], v[60:63], v[216:219], v[40:43]
    s_cbranch_vccnz L_retry11
L_ok11:
    s_waitcnt vmcnt(14)
    ds_read_b64_tr_b16 v[52:53], v7 offset:61440
    v_max_u32 v4, v240, v241
    v_mfma_f32_16x16x32_bf16 v[44:47], v[60:63], v[220:223], v[44:47]
    s_waitcnt lgkmcnt(9)
    ds_read_b64_tr_b16 v[54:55], v7 offset:62464
    v_max3_u32 v4, v4, v242, v243
    v_mfma_f32_16x16x32_bf16 v[16:19], v[136:139], v[224:227], v[16:19]
    buffer_load_dwordx4 v[108:111], v1, s[44:47], s95 offen offset:3072 sc1
    v_mfma_f32_16x16x32_bf16 v[20:23], v[136:139], v[228:231], v[20:23]
    s_waitcnt lgkmcnt(8)
    ds_read_b64_tr_b16 v[56:57], v8 offset:61440
    ds_read_b64_tr_b16 v[58:59], v8 offset:62464
    v_mfma_f32_16x16x32_bf16 v[24:27], v[140:143], v[224:227], v[24:27]
    s_waitcnt vmcnt(14)
    ds_read_b64_tr_b16 v[60:61], v9 offset:61440
    v_max3_u32 v4, v4, v244, v245
    v_mfma_f32_16x16x32_bf16 v[28:31], v[140:143], v[228:231], v[28:31]
    s_waitcnt lgkmcnt(9)
    ds_read_b64_tr_b16 v[62:63], v9 offset:62464
    v_max3_u32 v4, v4, v246, v247
    v_mfma_f32_16x16x32_bf16 v[32:35], v[144:147], v[224:227], v[32:35]
    ds_read_b64_tr_b16 v[136:137], v168 offset:4096
L_pg7:
    s_cbranch_execz L_pgret
    v_mfma_f32_16x16x32_bf16 v[36:39], v[144:147], v[228:231], v[36:39]
    s_waitcnt lgkmcnt(9)
    ds_read_b64_tr_b16 v[138:139], v168 offset:5120
    v_mfma_f32_16x16x32_bf16 v[40:43], v[148:151], v[224:227], v[40:43]
    s_waitcnt vmcnt(13)
    ds_read_b64_tr_b16 v[140:141], v169 offset:4096
    v_max3_u32 v4, v4, v248, v249
    v_mfma_f32_16x16x32_bf16 v[44:47], v[148:151], v[228:231], v[44:47]
    s_waitcnt lgkmcnt(9)
    ds_read_b64_tr_b16 v[142:143], v169 offset:5120
    v_max3_u32 v4, v4, v250, v251
    v_mfma_f32_16x16x32_bf16 v[16:19], v[48:51], v[232:235], v[16:19]
    ds_read_b64_tr_b16 v[144:145], v170 offset:4096
    v_mfma_f32_16x16x32_bf16 v[20:23], v[48:51], v[236:239], v[20:23]
    s_waitcnt lgkmcnt(9)
    ds_read_b64_tr_b16 v[146:147], v170 offset:5120
    v_mfma_f32_16x16x32_bf16 v[24:27], v[52:55], v[232:235], v[24:27]
    s_waitcnt vmcnt(12)
    ds_read_b64_tr_b16 v[148:149], v171 offset:4096
    v_max3_u32 v4, v4, v252, v253
    v_mfma_f32_16x16x32_bf16 v[28:31], v[52:55], v[236:239], v[28:31]
    s_waitcnt lgkmcnt(9)
    ds_read_b64_tr_b16 v[150:151], v171 offset:5120
    v_max3_u32 v4, v4, v254, v255
    v_cmp_eq_u32 vcc, -1, v4
    v_mfma_f32_16x16x32_bf16 v[32:35], v[56:59], v[232:235], v[32:35]
    ds_read_b64_tr_b16 v[48:49], v168 offset:12288
    v_mfma_f32_16x16x32_bf16 v[36:39], v[56:59], v[236:239], v[36:39]
    s_waitcnt lgkmcnt(9)
    ds_read_b64_tr_b16 v[50:51], v168 offset:13312
    v_mfma_f32_16x16x32_bf16 v[40:43], v[60:63], v[232:235], v[40:43]
    s_cbranch_vccnz L_retry12
L_ok12:
    ds_read_b64_tr_b16 v[52:53], v169 offset:12288
    v_mfma_f32_16x16x32_bf16 v[44:47], v[60:63], v[236:239], v[44:47]
    s_waitcnt lgkmcnt(9)
    ds_read_b64_tr_b16 v[54:55], v169 offset:13312
    v_mfma_f32_16x16x32_bf16 v[16:19], v[136:139], v[240:243], v[16:19]
    ds_read_b64_tr_b16 v[56:57], v170 offset:12288
    v_mfma_f32_16x16x32_bf16 v[20:23], v[136:139], v[244:247], v[20:23]
    s_waitcnt lgkmcnt(9)
    ds_read_b64_tr_b16 v[58:59], v170 offset:13312
    v_mfma_f32_16x16x32_bf16 v[24:27], v[140:143], v[240:243], v[24:27]
    ds_read_b64_tr_b16 v[60:61], v171 offset:12288
    v_mfma_f32_16x16x32_bf16 v[28:31], v[140:143], v[244:247], v[28:31]
    s_waitcnt lgkmcnt(9)
    ds_read_b64_tr_b16 v[62:63], v171 offset:13312
    v_mfma_f32_16x16x32_bf16 v[32:35], v[144:147], v[240:243], v[32:35]
    s_waitcnt vmcnt(11)
    ds_read_b64_tr_b16 v[136:137], v168 offset:20480
    v_max_u32 v5, v64, v65
    v_mfma_f32_16x16x32_bf16 v[36:39], v[144:147], v[244:247], v[36:39]
    s_waitcnt lgkmcnt(9)
    ds_read_b64_tr_b16 v[138:139], v168 offset:21504
    v_max3_u32 v5, v5, v66, v67
    v_mfma_f32_16x16x32_bf16 v[40:43], v[148:151], v[240:243], v[40:43]
    s_waitcnt vmcnt(10)
    ds_read_b64_tr_b16 v[140:141], v169 offset:20480
    v_max3_u32 v5, v5, v68, v69
    v_mfma_f32_16x16x32_bf16 v[44:47], v[148:151], v[244:247], v[44:47]
    s_waitcnt lgkmcnt(9)
    ds_read_b64_tr_b16 v[142:143], v169 offset:21504
    v_max3_u32 v5, v5, v70, v71
    v_mfma_f32_16x16x32_bf16 v[16:19], v[48:51], v[248:251], v[16:19]
    s_waitcnt vmcnt(9)
    ds_read_b64_tr_b16 v[144:145], v168 offset:28672
    v_max3_u32 v5, v5, v72, v73
    v_mfma_f32_16x16x32_bf16 v[20:23], v[48:51], v[252:255], v[20:23]
    s_waitcnt lgkmcnt(9)
    ds_read_b64_tr_b16 v[146:147], v168 offset:29696
    v_max3_u32 v5, v5, v74, v75
    v_mfma_f32_16x16x32_bf16 v[24:27], v[52:55], v[248:251], v[24:27]
    s_waitcnt vmcnt(8)
    ds_read_b64_tr_b16 v[148:149], v169 offset:28672
    v_max3_u32 v5, v5, v76, v77
    v_mfma_f32_16x16x32_bf16 v[28:31], v[52:55], v[252:255], v[28:31]
    s_waitcnt lgkmcnt(9)
    ds_read_b64_tr_b16 v[150:151], v169 offset:29696
    v_max3_u32 v5, v5, v78, v79
    v_cmp_eq_u32 vcc, -1, v5
    v_mfma_f32_16x16x32_bf16 v[32:35], v[56:59], v[248:251], v[32:35]
    s_waitcnt vmcnt(7)
    ds_read_b64_tr_b16 v[48:49], v168 offset:36864
    v_max_u32 v4, v80, v81
    v_mfma_f32_16x16x32_bf16 v[36:39], v[56:59], v[252:255], v[36:39]
    s_waitcnt lgkmcnt(9)
    ds_read_b64_tr_b16 v[50:51], v168 offset:37888
    v_max3_u32 v4, v4, v82, v83
    v_mfma_f32_16x16x32_bf16 v[40:43], v[60:63], v[248:251], v[40:43]
    s_cbranch_vccnz L_retry13
L_ok13:
    s_waitcnt vmcnt(6)
    ds_read_b64_tr_b16 v[52:53], v169 offset:36864
    v_max3_u32 v4, v4, v84, v85
    v_mfma_f32_16x16x32_bf16 v[44:47], v[60:63], v[252:255], v[44:47]
    s_waitcnt lgkmcnt(9)
    ds_read_b64_tr_b16 v[54:55], v169 offset:37888
    v_max3_u32 v4, v4, v86, v87
    v_mfma_f32_16x16x32_bf16 v[16:19], v[136:139], v[64:67], v[16:19]
    s_waitcnt vmcnt(5)
    ds_read_b64_tr_b16 v[56:57], v168 offset:45056
    v_max3_u32 v4, v4, v88, v89
    v_mfma_f32_16x16x32_bf16 v[20:23], v[136:139], v[68:71], v[20:23]
    s_waitcnt lgkmcnt(9)
    ds_read_b64_tr_b16 v[58:59], v168 offset:46080
    v_max3_u32 v4, v4, v90, v91
    v_mfma_f32_16x16x32_bf16 v[24:27], v[140:143], v[64:67], v[24:27]
    s_waitcnt vmcnt(4)
    ds_read_b64_tr_b16 v[60:61], v169 offset:45056
    v_max3_u32 v4, v4, v92, v93
    v_mfma_f32_16x16x32_bf16 v[28:31], v[140:143], v[68:71], v[28:31]
    s_waitcnt lgkmcnt(9)
    ds_read_b64_tr_b16 v[62:63], v169 offset:46080
    v_max3_u32 v4, v4, v94, v95
    v_cmp_eq_u32 vcc, -1, v4
    v_mfma_f32_16x16x32_bf16 v[16:19], v[144:147], v[72:75], v[16:19]
    s_waitcnt vmcnt(3)
    ds_read_b64_tr_b16 v[136:137], v168 offset:53248
    v_max_u32 v5, v96, v97
    v_mfma_f32_16x16x32_bf16 v[20:23], v[144:147], v[76:79], v[20:23]
    s_waitcnt lgkmcnt(9)
    ds_read_b64_tr_b16 v[138:139], v168 offset:54272
    v_max3_u32 v5, v5, v98, v99
    v_mfma_f32_16x16x32_bf16 v[24:27], v[148:151], v[72:75], v[24:27]
    s_cbranch_vccnz L_retry14
L_ok14:
    s_waitcnt vmcnt(2)
    ds_read_b64_tr_b16 v[140:141], v169 offset:53248
    v_max3_u32 v5, v5, v100, v101
    v_mfma_f32_16x16x32_bf16 v[28:31], v[148:151], v[76:79], v[28:31]
    s_waitcnt lgkmcnt(9)
    ds_read_b64_tr_b16 v[142:143], v169 offset:54272
    v_max3_u32 v5, v5, v102, v103
    v_mfma_f32_16x16x32_bf16 v[16:19], v[48:51], v[80:83], v[16:19]
    s_waitcnt vmcnt(1)
    ds_read_b64_tr_b16 v[144:145], v168 offset:61440
    v_max3_u32 v5, v5, v104, v105
    v_mfma_f32_16x16x32_bf16 v[20:23], v[48:51], v[84:87], v[20:23]
    s_waitcnt lgkmcnt(9)
    ds_read_b64_tr_b16 v[146:147], v168 offset:62464
    v_max3_u32 v5, v5, v106, v107
    v_mfma_f32_16x16x32_bf16 v[24:27], v[52:55], v[80:83], v[24:27]
    s_waitcnt vmcnt(0)
    ds_read_b64_tr_b16 v[148:149], v169 offset:61440
    v_max3_u32 v5, v5, v108, v109
    v_mfma_f32_16x16x32_bf16 v[28:31], v[52:55], v[84:87], v[28:31]
    s_waitcnt lgkmcnt(9)
    ds_read_b64_tr_b16 v[150:151], v169 offset:62464
    v_max3_u32 v5, v5, v110, v111
    v_cmp_eq_u32 vcc, -1, v5
    v_mfma_f32_16x16x32_bf16 v[16:19], v[56:59], v[88:91], v[16:19]
    ds_read_b64_tr_b16 v[48:49], v170 offset:20480
    v_mfma_f32_16x16x32_bf16 v[20:23], v[56:59], v[92:95], v[20:23]
    s_waitcnt lgkmcnt(9)
    ds_read_b64_tr_b16 v[50:51], v170 offset:21504
    v_mfma_f32_16x16x32_bf16 v[24:27], v[60:63], v[88:91], v[24:27]
    s_cbranch_vccnz L_retry15
L_ok15:
    ds_read_b64_tr_b16 v[52:53], v171 offset:20480
    v_mfma_f32_16x16x32_bf16 v[28:31], v[60:63], v[92:95], v[28:31]
    s_waitcnt lgkmcnt(9)
    ds_read_b64_tr_b16 v[54:55], v171 offset:21504
    v_mfma_f32_16x16x32_bf16 v[16:19], v[136:139], v[96:99], v[16:19]
    ds_read_b64_tr_b16 v[56:57], v170 offset:28672
    v_mfma_f32_16x16x32_bf16 v[20:23], v[136:139], v[100:103], v[20:23]
    s_waitcnt lgkmcnt(9)
    ds_read_b64_tr_b16 v[58:59], v170 offset:29696
    v_mfma_f32_16x16x32_bf16 v[24:27], v[140:143], v[96:99], v[24:27]
    ds_read_b64_tr_b16 v[60:61], v171 offset:28672
    v_mfma_f32_16x16x32_bf16 v[28:31], v[140:143], v[100:103], v[28:31]
    s_waitcnt lgkmcnt(9)
    ds_read_b64_tr_b16 v[62:63], v171 offset:29696
    v_mfma_f32_16x16x32_bf16 v[16:19], v[144:147], v[104:107], v[16:19]
    ds_read_b64_tr_b16 v[136:137], v170 offset:36864
    v_mfma_f32_16x16x32_bf16 v[20:23], v[144:147], v[108:111], v[20:23]
    s_waitcnt lgkmcnt(9)
    ds_read_b64_tr_b16 v[138:139], v170 offset:37888
    v_mfma_f32_16x16x32_bf16 v[24:27], v[148:151], v[104:107], v[24:27]
    ds_read_b64_tr_b16 v[140:141], v171 offset:36864
    v_mfma_f32_16x16x32_bf16 v[28:31], v[148:151], v[108:111], v[28:31]
    s_waitcnt lgkmcnt(9)
    ds_read_b64_tr_b16 v[142:143], v171 offset:37888
    v_mfma_f32_16x16x32_bf16 v[32:35], v[48:51], v[64:67], v[32:35]
    ds_read_b64_tr_b16 v[144:145], v170 offset:45056
    v_mfma_f32_16x16x32_bf16 v[36:39], v[48:51], v[68:71], v[36:39]
    s_waitcnt lgkmcnt(9)
    ds_read_b64_tr_b16 v[146:147], v170 offset:46080
    v_cvt_pk_bf16_f32 v128, v16, v17
    v_cvt_pk_bf16_f32 v129, v18, v19
    ds_write_b64 v11, v[128:129] offset:0
    v_cvt_pk_bf16_f32 v130, v20, v21
    v_cvt_pk_bf16_f32 v131, v22, v23
    ds_write_b64 v11, v[130:131] offset:1024
    v_mfma_f32_16x16x32_bf16 v[40:43], v[52:55], v[64:67], v[40:43]
    ds_read_b64_tr_b16 v[148:149], v171 offset:45056
    v_mfma_f32_16x16x32_bf16 v[44:47], v[52:55], v[68:71], v[44:47]
    s_waitcnt lgkmcnt(11)
    ds_read_b64_tr_b16 v[150:151], v171 offset:46080
    v_cvt_pk_bf16_f32 v132, v24, v25
    v_cvt_pk_bf16_f32 v133, v26, v27
    ds_write_b64 v12, v[132:133] offset:0
    v_cvt_pk_bf16_f32 v134, v28, v29
    v_cvt_pk_bf16_f32 v135, v30, v31
    ds_write_b64 v12, v[134:135] offset:1024
    v_mfma_f32_16x16x32_bf16 v[32:35], v[56:59], v[72:75], v[32:35]
    ds_read_b64_tr_b16 v[48:49], v170 offset:53248
    v_mfma_f32_16x16x32_bf16 v[36:39], v[56:59], v[76:79], v[36:39]
    s_waitcnt lgkmcnt(13)
    ds_read_b64_tr_b16 v[50:51], v170 offset:54272
    s_waitcnt lgkmcnt(10)
    ds_read_b128 v[152:155], v13 offset:0
    ds_read_b128 v[156:159], v13 offset:1024
    v_mfma_f32_16x16x32_bf16 v[40:43], v[60:63], v[72:75], v[40:43]
    ds_read_b64_tr_b16 v[52:53], v171 offset:53248
    v_mfma_f32_16x16x32_bf16 v[44:47], v[60:63], v[76:79], v[44:47]
    ds_read_b64_tr_b16 v[54:55], v171 offset:54272
    s_waitcnt lgkmcnt(6)
    v_mfma_f32_16x16x32_bf16 v[32:35], v[136:139], v[80:83], v[32:35]
    ds_read_b64_tr_b16 v[56:57], v170 offset:61440
    v_mfma_f32_16x16x32_bf16 v[36:39], v[136:139], v[84:87], v[36:39]
    ds_read_b64_tr_b16 v[58:59], v170 offset:62464
    v_mfma_f32_16x16x32_bf16 v[40:43], v[140:143], v[80:83], v[40:43]
    ds_read_b64_tr_b16 v[60:61], v171 offset:61440
    v_mfma_f32_16x16x32_bf16 v[44:47], v[140:143], v[84:87], v[44:47]
    ds_read_b64_tr_b16 v[62:63], v171 offset:62464
    s_waitcnt lgkmcnt(7)
    buffer_store_dwordx4 v[152:155], v10, s[36:39], s65 offen offset:0 sc0 sc1
    s_waitcnt lgkmcnt(6)
    buffer_store_dwordx4 v[156:159], v10, s[36:39], s56 offen offset:0 sc0 sc1
    v_mfma_f32_16x16x32_bf16 v[32:35], v[144:147], v[88:91], v[32:35]
    v_mfma_f32_16x16x32_bf16 v[36:39], v[144:147], v[92:95], v[36:39]
    v_mfma_f32_16x16x32_bf16 v[40:43], v[148:151], v[88:91], v[40:43]
    v_mfma_f32_16x16x32_bf16 v[44:47], v[148:151], v[92:95], v[44:47]
    v_mfma_f32_16x16x32_bf16 v[32:35], v[48:51], v[96:99], v[32:35]
    v_mfma_f32_16x16x32_bf16 v[36:39], v[48:51], v[100:103], v[36:39]
    s_waitcnt lgkmcnt(4)
    v_mfma_f32_16x16x32_bf16 v[40:43], v[52:55], v[96:99], v[40:43]
    v_mfma_f32_16x16x32_bf16 v[44:47], v[52:55], v[100:103], v[44:47]
    s_waitcnt lgkmcnt(2)
    v_mfma_f32_16x16x32_bf16 v[32:35], v[56:59], v[104:107], v[32:35]
    v_mfma_f32_16x16x32_bf16 v[36:39], v[56:59], v[108:111], v[36:39]
    s_waitcnt lgkmcnt(0)
    v_mfma_f32_16x16x32_bf16 v[40:43], v[60:63], v[104:107], v[40:43]
    v_mfma_f32_16x16x32_bf16 v[44:47], v[60:63], v[108:111], v[44:47]
    s_nop 4
    v_cvt_pk_bf16_f32 v128, v32, v33
    v_cvt_pk_bf16_f32 v129, v34, v35
    ds_write_b64 v11, v[128:129] offset:2048
    v_cvt_pk_bf16_f32 v130, v36, v37
    v_cvt_pk_bf16_f32 v131, v38, v39
    ds_write_b64 v11, v[130:131] offset:3072
    v_cvt_pk_bf16_f32 v132, v40, v41
    v_cvt_pk_bf16_f32 v133, v42, v43
    ds_write_b64 v12, v[132:133] offset:2048
    v_cvt_pk_bf16_f32 v134, v44, v45
    v_cvt_pk_bf16_f32 v135, v46, v47
    ds_write_b64 v12, v[134:135] offset:3072
    ds_read_b128 v[160:163], v13 offset:2048
    ds_read_b128 v[164:167], v13 offset:3072
    s_waitcnt lgkmcnt(1)
    buffer_store_dwordx4 v[160:163], v10, s[36:39], s65 offen offset:64 sc0 sc1
    s_waitcnt lgkmcnt(0)
    buffer_store_dwordx4 v[164:167], v10, s[36:39], s56 offen offset:64 sc0 sc1
    s_endpgm
L_rare:
L_spin:
    buffer_load_dword v14, v186, s[40:43], 0 offen sc1
    s_add_u32 s67, s67, 1
    s_cmp_gt_u32 s67, 0x400000
    s_waitcnt vmcnt(0)
    s_cbranch_scc1 L_spun
    v_cmp_gt_u32 vcc, 4, v14
    s_cbranch_vccnz L_spin
    s_branch L_spun
L_retry1:
    buffer_load_dwordx4 v[192:195], v1, s[44:47], s81 offen offset:0 sc1
    buffer_load_dwordx4 v[196:199], v1, s[44:47], s81 offen offset:1024 sc1
    buffer_load_dwordx4 v[200:203], v1, s[44:47], s82 offen offset:0 sc1
    buffer_load_dwordx4 v[204:207], v1, s[44:47], s82 offen offset:1024 sc1
    s_add_u32 s67, s67, 1
    s_cmp_gt_u32 s67, 0x400000
    s_waitcnt vmcnt(0)
    s_cbranch_scc1 L_ok1
    v_max_u32 v5, v192, v193
    v_max3_u32 v5, v5, v194, v195
    v_max3_u32 v5, v5, v196, v197
    v_max3_u32 v5, v5, v198, v199
    v_max3_u32 v5, v5, v200, v201
    v_max3_u32 v5, v5, v202, v203
    v_max3_u32 v5, v5, v204, v205
    v_max3_u32 v5, v5, v206, v207
    v_cmp_eq_u32 vcc, -1, v5
    s_cbranch_vccnz L_retry1
    s_branch L_ok1
L_retry2:
    buffer_load_dwordx4 v[208:211], v1, s[44:47], s83 offen offset:0 sc1
    buffer_load_dwordx4 v[212:215], v1, s[44:47], s83 offen offset:1024 sc1
    buffer_load_dwordx4 v[216:219], v1, s[44:47], s84 offen offset:0 sc1
    buffer_load_dwordx4 v[220:223], v1, s[44:47], s84 offen offset:1024 sc1
    s_add_u32 s67, s67, 1
    s_cmp_gt_u32 s67, 0x400000
    s_waitcnt vmcnt(0)
    s_cbranch_scc1 L_ok2
    v_max_u32 v4, v208, v209
    v_max3_u32 v4, v4, v210, v211
    v_max3_u32 v4, v4, v212, v213
    v_max3_u32 v4, v4, v214, v215
    v_max3_u32 v4, v4, v216, v217
    v_max3_u32 v4, v4, v218, v219
    v_max3_u32 v4, v4, v220, v221
    v_max3_u32 v4, v4, v222, v223
    v_cmp_eq_u32 vcc, -1, v4
    s_cbranch_vccnz L_retry2
    s_branch L_ok2
L_retry3:
    buffer_load_dwordx4 v[224:227], v1, s[44:47], s85 offen offset:0 sc1
    buffer_load_dwordx4 v[228:231], v1, s[44:47], s85 offen offset:1024 sc1
    buffer_load_dwordx4 v[232:235], v1, s[44:47], s86 offen offset:0 sc1
    buffer_load_dwordx4 v[236:239], v1, s[44:47], s86 offen offset:1024 sc1
    s_add_u32 s67, s67, 1
    s_cmp_gt_u32 s67, 0x400000
    s_waitcnt vmcnt(0)
    s_cbranch_scc1 L_ok3
    v_max_u32 v5, v224, v225
    v_max3_u32 v5, v5, v226, v227
    v_max3_u32 v5, v5, v228, v229
    v_max3_u32 v5, v5, v230, v231
    v_max3_u32 v5, v5, v232, v233
    v_max3_u32 v5, v5, v234, v235
    v_max3_u32 v5, v5, v236, v237
    v_max3_u32 v5, v5, v238, v239
    v_cmp_eq_u32 vcc, -1, v5
    s_cbranch_vccnz L_retry3
    s_branch L_ok3
L_retry4:
    buffer_load_dwordx4 v[240:243], v1, s[44:47], s87 offen offset:0 sc1
    buffer_load_dwordx4 v[244:247], v1, s[44:47], s87 offen offset:1024 sc1
    buffer_load_dwordx4 v[248:251], v1, s[44:47], s88 offen offset:0 sc1
    buffer_load_dwordx4 v[252:255], v1, s[44:47], s88 offen offset:1024 sc1
    s_add_u32 s67, s67, 1
    s_cmp_gt_u32 s67, 0x400000
    s_waitcnt vmcnt(0)
    s_cbranch_scc1 L_ok4
    v_max_u32 v4, v240, v241
    v_max3_u32 v4, v4, v242, v243
    v_max3_u32 v4, v4, v244, v245
    v_max3_u32 v4, v4, v246, v247
    v_max3_u32 v4, v4, v248, v249
    v_max3_u32 v4, v4, v250, v251
    v_max3_u32 v4, v4, v252, v253
    v_max3_u32 v4, v4, v254, v255
    v_cmp_eq_u32 vcc, -1, v4
    s_cbranch_vccnz L_retry4
    s_branch L_ok4
L_retry5:
    buffer_load_dwordx4 v[64:67], v1, s[44:47], s89 offen offset:0 sc1
    buffer_load_dwordx4 v[68:71], v1, s[44:47], s89 offen offset:1024 sc1
    buffer_load_dwordx4 v[72:75], v1, s[44:47], s90 offen offset:0 sc1
    buffer_load_dwordx4 v[76:79], v1, s[44:47], s90 offen offset:1024 sc1
    s_add_u32 s67, s67, 1
    s_cmp_gt_u32 s67, 0x400000
    s_waitcnt vmcnt(0)
    s_cbranch_scc1 L_ok5
    v_max_u32 v5, v64, v65
    v_max3_u32 v5, v5, v66, v67
    v_max3_u32 v5, v5, v68, v69
    v_max3_u32 v5, v5, v70, v71
    v_max3_u32 v5, v5, v72, v73
    v_max3_u32 v5, v5, v74, v75
    v_max3_u32 v5, v5, v76, v77
    v_max3_u32 v5, v5, v78, v79
    v_cmp_eq_u32 vcc, -1, v5
    s_cbranch_vccnz L_retry5
    s_branch L_ok5
L_retry6:
    buffer_load_dwordx4 v[80:83], v1, s[44:47], s91 offen offset:0 sc1
    buffer_load_dwordx4 v[84:87], v1, s[44:47], s91 offen offset:1024 sc1
    buffer_load_dwordx4 v[88:91], v1, s[44:47], s92 offen offset:0 sc1
    buffer_load_dwordx4 v[92:95], v1, s[44:47], s92 offen offset:1024 sc1
    s_add_u32 s67, s67, 1
    s_cmp_gt_u32 s67, 0x400000
    s_waitcnt vmcnt(0)
    s_cbranch_scc1 L_ok6
    v_max_u32 v4, v80, v81
    v_max3_u32 v4, v4, v82, v83
    v_max3_u32 v4, v4, v84, v85
    v_max3_u32 v4, v4, v86, v87
    v_max3_u32 v4, v4, v88, v89
    v_max3_u32 v4, v4, v90, v91
    v_max3_u32 v4, v4, v92, v93
    v_max3_u32 v4, v4, v94, v95
    v_cmp_eq_u32 vcc, -1, v4
    s_cbranch_vccnz L_retry6
    s_branch L_ok6
L_retry7:
    buffer_load_dwordx4 v[96:99], v1, s[44:47], s93 offen offset:0 sc1
    buffer_load_dwordx4 v[100:103], v1, s[44:47], s93 offen offset:1024 sc1
    buffer_load_dwordx4 v[104:107], v1, s[44:47], s94 offen offset:0 sc1
    buffer_load_dwordx4 v[108:111], v1, s[44:47], s94 offen offset:1024 sc1
    s_add_u32 s67, s67, 1
    s_cmp_gt_u32 s67, 0x400000
    s_waitcnt vmcnt(0)
    s_cbranch_scc1 L_ok7
    v_max_u32 v5, v96, v97
    v_max3_u32 v5, v5, v98, v99
    v_max3_u32 v5, v5, v100, v101
    v_max3_u32 v5, v5, v102, v103
    v_max3_u32 v5, v5, v104, v105
    v_max3_u32 v5, v5, v106, v107
    v_max3_u32 v5, v5, v108, v109
    v_max3_u32 v5, v5, v110, v111
    v_cmp_eq_u32 vcc, -1, v5
    s_cbranch_vccnz L_retry7
    s_branch L_ok7
L_retry8:
    buffer_load_dwordx4 v[112:115], v1, s[44:47], s95 offen offset:0 sc1
    buffer_load_dwordx4 v[116:119], v1, s[44:47], s95 offen offset:1024 sc1
    buffer_load_dwordx4 v[120:123], v1, s[44:47], s81 offen offset:2048 sc1
    buffer_load_dwordx4 v[124:127], v1, s[44:47], s81 offen offset:3072 sc1
    s_add_u32 s67, s67, 1
    s_cmp_gt_u32 s67, 0x400000
    s_waitcnt vmcnt(0)
    s_cbranch_scc1 L_ok8
    v_max_u32 v4, v112, v113
    v_max3_u32 v4, v4, v114, v115
    v_max3_u32 v4, v4, v116, v117
    v_max3_u32 v4, v4, v118, v119
    v_max3_u32 v4, v4, v120, v121
    v_max3_u32 v4, v4, v122, v123
    v_max3_u32 v4, v4, v124, v125
    v_max3_u32 v4, v4, v126, v127
    v_cmp_eq_u32 vcc, -1, v4
    s_cbranch_vccnz L_retry8
    s_branch L_ok8
L_retry9:
    buffer_load_dwordx4 v[192:195], v1, s[44:47], s82 offen offset:2048 sc1
    buffer_load_dwordx4 v[196:199], v1, s[44:47], s82 offen offset:3072 sc1
    buffer_load_dwordx4 v[200:203], v1, s[44:47], s83 offen offset:2048 sc1
    buffer_load_dwordx4 v[204:207], v1, s[44:47], s83 offen offset:3072 sc1
    s_add_u32 s67, s67, 1
    s_cmp_gt_u32 s67, 0x400000
    s_waitcnt vmcnt(0)
    s_cbranch_scc1 L_ok9
    v_max_u32 v5, v192, v193
    v_max3_u32 v5, v5, v194, v195
    v_max3_u32 v5, v5, v196, v197
    v_max3_u32 v5, v5, v198, v199
    v_max3_u32 v5, v5, v200, v201
    v_max3_u32 v5, v5, v202, v203
    v_max3_u32 v5, v5, v204, v205
    v_max3_u32 v5, v5, v206, v207
    v_cmp_eq_u32 vcc, -1, v5
    s_cbranch_vccnz L_retry9
    s_branch L_ok9
L_retry10:
    buffer_load_dwordx4 v[208:211], v1, s[44:47], s84 offen offset:2048 sc1
    buffer_load_dwordx4 v[212:215], v1, s[44:47], s84 offen offset:3072 sc1
    buffer_load_dwordx4 v[216:219], v1, s[44:47], s85 offen offset:2048 sc1
    buffer_load_dwordx4 v[220:223], v1, s[44:47], s85 offen offset:3072 sc1
    s_add_u32 s67, s67, 1
    s_cmp_gt_u32 s67, 0x400000
    s_waitcnt vmcnt(0)
    s_cbranch_scc1 L_ok10
    v_max_u32 v4, v208, v209
    v_max3_u32 v4, v4, v210, v211
    v_max3_u32 v4, v4, v212, v213
    v_max3_u32 v4, v4, v214, v215
    v_max3_u32 v4, v4, v216, v217
    v_max3_u32 v4, v4, v218, v219
    v_max3_u32 v4, v4, v220, v221
    v_max3_u32 v4, v4, v222, v223
    v_cmp_eq_u32 vcc, -1, v4
    s_cbranch_vccnz L_retry10
    s_branch L_ok10
L_retry11:
    buffer_load_dwordx4 v[224:227], v1, s[44:47], s86 offen offset:2048 sc1
    buffer_load_dwordx4 v[228:231], v1, s[44:47], s86 offen offset:3072 sc1
    buffer_load_dwordx4 v[232:235], v1, s[44:47], s87 offen offset:2048 sc1
    buffer_load_dwordx4 v[236:239], v1, s[44:47], s87 offen offset:3072 sc1
    s_add_u32 s67, s67, 1
    s_cmp_gt_u32 s67, 0x400000
    s_waitcnt vmcnt(0)
    s_cbranch_scc1 L_ok11
    v_max_u32 v5, v224, v225
    v_max3_u32 v5, v5, v226, v227
    v_max3_u32 v5, v5, v228, v229
    v_max3_u32 v5, v5, v230, v231
    v_max3_u32 v5, v5, v232, v233
    v_max3_u32 v5, v5, v234, v235
    v_max3_u32 v5, v5, v236, v237
    v_max3_u32 v5, v5, v238, v239
    v_cmp_eq_u32 vcc, -1, v5
    s_cbranch_vccnz L_retry11
    s_branch L_ok11
L_retry12:
    buffer_load_dwordx4 v[240:243], v1, s[44:47], s88 offen offset:2048 sc1
    buffer_load_dwordx4 v[244:247], v1, s[44:47], s88 offen offset:3072 sc1
    buffer_load_dwordx4 v[248:251], v1, s[44:47], s89 offen offset:2048 sc1
    buffer_load_dwordx4 v[252:255], v1, s[44:47], s89 offen offset:3072 sc1
    s_add_u32 s67, s67, 1
    s_cmp_gt_u32 s67, 0x400000
    s_waitcnt vmcnt(0)
    s_cbranch_scc1 L_ok12
    v_max_u32 v4, v240, v241
    v_max3_u32 v4, v4, v242, v243
    v_max3_u32 v4, v4, v244, v245
    v_max3_u32 v4, v4, v246, v247
    v_max3_u32 v4, v4, v248, v249
    v_max3_u32 v4, v4, v250, v251
    v_max3_u32 v4, v4, v252, v253
    v_max3_u32 v4, v4, v254, v255
    v_cmp_eq_u32 vcc, -1, v4
    s_cbranch_vccnz L_retry12
    s_branch L_ok12
L_retry13:
    buffer_load_dwordx4 v[64:67], v1, s[44:47], s90 offen offset:2048 sc1
    buffer_load_dwordx4 v[68:71], v1, s[44:47], s90 offen offset:3072 sc1
    buffer_load_dwordx4 v[72:75], v1, s[44:47], s91 offen offset:2048 sc1
    buffer_load_dwordx4 v[76:79], v1, s[44:47], s91 offen offset:3072 sc1
    s_add_u32 s67, s67, 1
    s_cmp_gt_u32 s67, 0x400000
    s_waitcnt vmcnt(0)
    s_cbranch_scc1 L_ok13
    v_max_u32 v5, v64, v65
    v_max3_u32 v5, v5, v66, v67
    v_max3_u32 v5, v5, v68, v69
    v_max3_u32 v5, v5, v70, v71
    v_max3_u32 v5, v5, v72, v73
    v_max3_u32 v5, v5, v74, v75
    v_max3_u32 v5, v5, v76, v77
    v_max3_u32 v5, v5, v78, v79
    v_cmp_eq_u32 vcc, -1, v5
    s_cbranch_vccnz L_retry13
    s_branch L_ok13
L_retry14:
    buffer_load_dwordx4 v[80:83], v1, s[44:47], s92 offen offset:2048 sc1
    buffer_load_dwordx4 v[84:87], v1, s[44:47], s92 offen offset:3072 sc1
    buffer_load_dwordx4 v[88:91], v1, s[44:47], s93 offen offset:2048 sc1
    buffer_load_dwordx4 v[92:95], v1, s[44:47], s93 offen offset:3072 sc1
    s_add_u32 s67, s67, 1
    s_cmp_gt_u32 s67, 0x400000
    s_waitcnt vmcnt(0)
    s_cbranch_scc1 L_ok14
    v_max_u32 v4, v80, v81
    v_max3_u32 v4, v4, v82, v83
    v_max3_u32 v4, v4, v84, v85
    v_max3_u32 v4, v4, v86, v87
    v_max3_u32 v4, v4, v88, v89
    v_max3_u32 v4, v4, v90, v91
    v_max3_u32 v4, v4, v92, v93
    v_max3_u32 v4, v4, v94, v95
    v_cmp_eq_u32 vcc, -1, v4
    s_cbranch_vccnz L_retry14
    s_branch L_ok14
L_retry15:
    buffer_load_dwordx4 v[96:99], v1, s[44:47], s94 offen offset:2048 sc1
    buffer_load_dwordx4 v[100:103], v1, s[44:47], s94 offen offset:3072 sc1
    buffer_load_dwordx4 v[104:107], v1, s[44:47], s95 offen offset:2048 sc1
    buffer_load_dwordx4 v[108:111], v1, s[44:47], s95 offen offset:3072 sc1
    s_add_u32 s67, s67, 1
    s_cmp_gt_u32 s67, 0x400000
    s_waitcnt vmcnt(0)
    s_cbranch_scc1 L_ok15
    v_max_u32 v5, v96, v97
    v_max3_u32 v5, v5, v98, v99
    v_max3_u32 v5, v5, v100, v101
    v_max3_u32 v5, v5, v102, v103
    v_max3_u32 v5, v5, v104, v105
    v_max3_u32 v5, v5, v106, v107
    v_max3_u32 v5, v5, v108, v109
    v_max3_u32 v5, v5, v110, v111
    v_cmp_eq_u32 vcc, -1, v5
    s_cbranch_vccnz L_retry15
    s_branch L_ok15
L_truemax0:
    v_mov_b32 v2, 0xff800000
    s_mov_b32 s69, 0
L_tm10:
    buffer_load_dwordx4 v[208:211], v1, s[44:47], s69 offen offset:0 sc1
    buffer_load_dwordx4 v[212:215], v1, s[44:47], s69 offen offset:1024 sc1
    s_waitcnt vmcnt(0)
    v_mfma_f32_32x32x16_bf16 v[192:207], v[208:211], v[80:83], 0
    v_mfma_f32_32x32x16_bf16 v[192:207], v[212:215], v[84:87], v[192:207]
    s_nop 15
    v_max3_f32 v2, v2, v192, v193
    v_max3_f32 v2, v2, v194, v195
    v_max3_f32 v2, v2, v196, v197
    v_max3_f32 v2, v2, v198, v199
    v_max3_f32 v2, v2, v200, v201
    v_max3_f32 v2, v2, v202, v203
    v_max3_f32 v2, v2, v204, v205
    v_max3_f32 v2, v2, v206, v207
    s_add_u32 s69, s69, 4096
    s_cmp_lt_u32 s69, 262144
    s_cbranch_scc1 L_tm10
    v_mov_b32 v3, v2
    s_nop 1
    v_permlane32_swap_b32 v2, v3
    v_min_f32_e64 v48, -v2, -v3
    v_min_f32_e64 v49, -v2, -v3
    v_mov_b64 v[50:51], v[48:49]
    v_mov_b64 v[52:53], v[48:49]
    v_mov_b64 v[54:55], v[48:49]
    v_mov_b64 v[56:57], v[48:49]
    v_mov_b64 v[58:59], v[48:49]
    v_mov_b64 v[60:61], v[48:49]
    v_mov_b64 v[62:63], v[48:49]
    v_mov_b32 v136, 0
    v_mov_b32 v137, 0
    v_mov_b32 v138, 0
    v_mov_b32 v139, 0
    v_mov_b32 v140, 0
    v_mov_b32 v141, 0
    v_mov_b32 v142, 0
    v_mov_b32 v143, 0
    v_mov_b32 v144, 0
    v_mov_b32 v145, 0
    v_mov_b32 v146, 0
    v_mov_b32 v147, 0
    v_mov_b32 v148, 0
    v_mov_b32 v149, 0
    v_mov_b32 v150, 0
    v_mov_b32 v151, 0
    v_mov_b32 v168, 0
    v_mov_b32 v169, 0
    v_mov_b32 v170, 0
    v_mov_b32 v171, 0
    s_mov_b32 s69, 0
L_tm20:
    buffer_load_dwordx4 v[208:211], v1, s[44:47], s69 offen offset:0 sc1
    buffer_load_dwordx4 v[212:215], v1, s[44:47], s69 offen offset:1024 sc1
    buffer_load_dwordx4 v[216:219], v1, s[44:47], s69 offen offset:2048 sc1
    buffer_load_dwordx4 v[220:223], v1, s[44:47], s69 offen offset:3072 sc1
    s_waitcnt vmcnt(0)
    v_mfma_f32_32x32x16_bf16 v[192:207], v[208:211], v[80:83], 0
    v_mfma_f32_32x32x16_bf16 v[192:207], v[212:215], v[84:87], v[192:207]
    s_nop 15
    v_add_f32 v192, v48, v192
    v_add_f32 v193, v48, v193
    v_add_f32 v194, v48, v194
    v_add_f32 v195, v48, v195
    v_add_f32 v196, v48, v196
    v_add_f32 v197, v48, v197
    v_add_f32 v198, v48, v198
    v_add_f32 v199, v48, v199
    v_add_f32 v200, v48, v200
    v_add_f32 v201, v48, v201
    v_add_f32 v202, v48, v202
    v_add_f32 v203, v48, v203
    v_add_f32 v204, v48, v204
    v_add_f32 v205, v48, v205
    v_add_f32 v206, v48, v206
    v_add_f32 v207, v48, v207
    v_exp_f32 v192, v192
    v_exp_f32 v193, v193
    v_exp_f32 v194, v194
    v_exp_f32 v195, v195
    v_exp_f32 v196, v196
    v_exp_f32 v197, v197
    v_exp_f32 v198, v198
    v_exp_f32 v199, v199
    v_exp_f32 v200, v200
    v_exp_f32 v201, v201
    v_exp_f32 v202, v202
    v_exp_f32 v203, v203
    v_exp_f32 v204, v204
    v_exp_f32 v205, v205
    v_exp_f32 v206, v206
    v_exp_f32 v207, v207
    s_nop 1
    v_smfmac_f32_32x32x32_bf16 v[136:151], v[216:219], v[192:199], v132
    v_smfmac_f32_16x16x64_bf16 v[168:171], v[128:131], v[192:199], v132
    v_smfmac_f32_32x32x32_bf16 v[136:151], v[220:223], v[200:207], v132
    v_smfmac_f32_16x16x64_bf16 v[168:171], v[128:131], v[200:207], v132
    s_add_u32 s69, s69, 4096
    s_cmp_lt_u32 s69, 262144
    s_nop 15
    s_cbranch_scc1 L_tm20
    v_mov_b32 v3, v168
    s_nop 1
    v_permlane32_swap_b32 v168, v3
    v_rcp_f32 v2, v168
    s_nop 0
    v_pk_mul_f32 v[136:137], v[136:137], v[2:3] op_sel_hi:[1,0]
    v_pk_mul_f32 v[138:139], v[138:139], v[2:3] op_sel_hi:[1,0]
    v_pk_mul_f32 v[140:141], v[140:141], v[2:3] op_sel_hi:[1,0]
    v_pk_mul_f32 v[142:143], v[142:143], v[2:3] op_sel_hi:[1,0]
    v_pk_mul_f32 v[144:145], v[144:145], v[2:3] op_sel_hi:[1,0]
    v_pk_mul_f32 v[146:147], v[146:147], v[2:3] op_sel_hi:[1,0]
    v_pk_mul_f32 v[148:149], v[148:149], v[2:3] op_sel_hi:[1,0]
    v_pk_mul_f32 v[150:151], v[150:151], v[2:3] op_sel_hi:[1,0]
    v_cvt_pk_bf16_f32 v176, v136, v137
    v_cvt_pk_bf16_f32 v177, v138, v139
    v_cvt_pk_bf16_f32 v178, v140, v141
    v_cvt_pk_bf16_f32 v179, v142, v143
    v_cvt_pk_bf16_f32 v180, v144, v145
    v_cvt_pk_bf16_f32 v181, v146, v147
    v_cvt_pk_bf16_f32 v182, v148, v149
    v_cvt_pk_bf16_f32 v183, v150, v151
    v_min_u32 v176, -2, v176
    v_min_u32 v177, -2, v177
    v_min_u32 v178, -2, v178
    v_min_u32 v179, -2, v179
    v_min_u32 v180, -2, v180
    v_min_u32 v181, -2, v181
    v_min_u32 v182, -2, v182
    v_min_u32 v183, -2, v183
    s_branch L_norm0
L_truemax1:
    v_mov_b32 v2, 0xff800000
    s_mov_b32 s69, 0
L_tm11:
    buffer_load_dwordx4 v[96:99], v1, s[44:47], s69 offen offset:0 sc1
    buffer_load_dwordx4 v[100:103], v1, s[44:47], s69 offen offset:1024 sc1
    s_waitcnt vmcnt(0)
    v_mfma_f32_32x32x16_bf16 v[16:31], v[96:99], v[88:91], 0
    v_mfma_f32_32x32x16_bf16 v[16:31], v[100:103], v[92:95], v[16:31]
    s_nop 15
    v_max3_f32 v2, v2, v16, v17
    v_max3_f32 v2, v2, v18, v19
    v_max3_f32 v2, v2, v20, v21
    v_max3_f32 v2, v2, v22, v23
    v_max3_f32 v2, v2, v24, v25
    v_max3_f32 v2, v2, v26, v27
    v_max3_f32 v2, v2, v28, v29
    v_max3_f32 v2, v2, v30, v31
    s_add_u32 s69, s69, 4096
    s_cmp_lt_u32 s69, 262144
    s_cbranch_scc1 L_tm11
    v_mov_b32 v3, v2
    s_nop 1
    v_permlane32_swap_b32 v2, v3
    v_min_f32_e64 v64, -v2, -v3
    v_min_f32_e64 v65, -v2, -v3
    v_mov_b64 v[66:67], v[64:65]
    v_mov_b64 v[68:69], v[64:65]
    v_mov_b64 v[70:71], v[64:65]
    v_mov_b64 v[72:73], v[64:65]
    v_mov_b64 v[74:75], v[64:65]
    v_mov_b64 v[76:77], v[64:65]
    v_mov_b64 v[78:79], v[64:65]
    v_mov_b32 v152, 0
    v_mov_b32 v153, 0
    v_mov_b32 v154, 0
    v_mov_b32 v155, 0
    v_mov_b32 v156, 0
    v_mov_b32 v157, 0
    v_mov_b32 v158, 0
    v_mov_b32 v159, 0
    v_mov_b32 v160, 0
    v_mov_b32 v161, 0
    v_mov_b32 v162, 0
    v_mov_b32 v163, 0
    v_mov_b32 v164, 0
    v_mov_b32 v165, 0
    v_mov_b32 v166, 0
    v_mov_b32 v167, 0
    v_mov_b32 v172, 0
    v_mov_b32 v173, 0
    v_mov_b32 v174, 0
    v_mov_b32 v175, 0
    s_mov_b32 s69, 0
L_tm21:
    buffer_load_dwordx4 v[96:99], v1, s[44:47], s69 offen offset:0 sc1
    buffer_load_dwordx4 v[100:103], v1, s[44:47], s69 offen offset:1024 sc1
    buffer_load_dwordx4 v[104:107], v1, s[44:47], s69 offen offset:2048 sc1
    buffer_load_dwordx4 v[108:111], v1, s[44:47], s69 offen offset:3072 sc1
    s_waitcnt vmcnt(0)
    v_mfma_f32_32x32x16_bf16 v[16:31], v[96:99], v[88:91], 0
    v_mfma_f32_32x32x16_bf16 v[16:31], v[100:103], v[92:95], v[16:31]
    s_nop 15
    v_add_f32 v16, v64, v16
    v_add_f32 v17, v64, v17
    v_add_f32 v18, v64, v18
    v_add_f32 v19, v64, v19
    v_add_f32 v20, v64, v20
    v_add_f32 v21, v64, v21
    v_add_f32 v22, v64, v22
    v_add_f32 v23, v64, v23
    v_add_f32 v24, v64, v24
    v_add_f32 v25, v64, v25
    v_add_f32 v26, v64, v26
    v_add_f32 v27, v64, v27
    v_add_f32 v28, v64, v28
    v_add_f32 v29, v64, v29
    v_add_f32 v30, v64, v30
    v_add_f32 v31, v64, v31
    v_exp_f32 v16, v16
    v_exp_f32 v17, v17
    v_exp_f32 v18, v18
    v_exp_f32 v19, v19
    v_exp_f32 v20, v20
    v_exp_f32 v21, v21
    v_exp_f32 v22, v22
    v_exp_f32 v23, v23
    v_exp_f32 v24, v24
    v_exp_f32 v25, v25
    v_exp_f32 v26, v26
    v_exp_f32 v27, v27
    v_exp_f32 v28, v28
    v_exp_f32 v29, v29
    v_exp_f32 v30, v30
    v_exp_f32 v31, v31
    s_nop 1
    v_smfmac_f32_32x32x32_bf16 v[152:167], v[104:107], v[16:23], v132
    v_smfmac_f32_16x16x64_bf16 v[172:175], v[128:131], v[16:23], v132
    v_smfmac_f32_32x32x32_bf16 v[152:167], v[108:111], v[24:31], v132
    v_smfmac_f32_16x16x64_bf16 v[172:175], v[128:131], v[24:31], v132
    s_add_u32 s69, s69, 4096
    s_cmp_lt_u32 s69, 262144
    s_nop 15
    s_cbranch_scc1 L_tm21
    v_mov_b32 v3, v172
    s_nop 1
    v_permlane32_swap_b32 v172, v3
    v_rcp_f32 v2, v172
    s_nop 0
    v_pk_mul_f32 v[152:153], v[152:153], v[2:3] op_sel_hi:[1,0]
    v_pk_mul_f32 v[154:155], v[154:155], v[2:3] op_sel_hi:[1,0]
    v_pk_mul_f32 v[156:157], v[156:157], v[2:3] op_sel_hi:[1,0]
    v_pk_mul_f32 v[158:159], v[158:159], v[2:3] op_sel_hi:[1,0]
    v_pk_mul_f32 v[160:161], v[160:161], v[2:3] op_sel_hi:[1,0]
    v_pk_mul_f32 v[162:163], v[162:163], v[2:3] op_sel_hi:[1,0]
    v_pk_mul_f32 v[164:165], v[164:165], v[2:3] op_sel_hi:[1,0]
    v_pk_mul_f32 v[166:167], v[166:167], v[2:3] op_sel_hi:[1,0]
    v_cvt_pk_bf16_f32 v184, v152, v153
    v_cvt_pk_bf16_f32 v185, v154, v155
    v_cvt_pk_bf16_f32 v186, v156, v157
    v_cvt_pk_bf16_f32 v187, v158, v159
    v_cvt_pk_bf16_f32 v188, v160, v161
    v_cvt_pk_bf16_f32 v189, v162, v163
    v_cvt_pk_bf16_f32 v190, v164, v165
    v_cvt_pk_bf16_f32 v191, v166, v167
    v_min_u32 v184, -2, v184
    v_min_u32 v185, -2, v185
    v_min_u32 v186, -2, v186
    v_min_u32 v187, -2, v187
    v_min_u32 v188, -2, v188
    v_min_u32 v189, -2, v189
    v_min_u32 v190, -2, v190
    v_min_u32 v191, -2, v191
    s_branch L_norm1
L_end:
    s_endpgm
.section .rodata,"a"
.p2align 6
.amdhsa_kernel standalone__grouped_kv_mqa__prompt_kernel
  .amdhsa_next_free_vgpr 256
  .amdhsa_next_free_sgpr 102
  .amdhsa_accum_offset 256
  .amdhsa_group_segment_fixed_size 0
  .amdhsa_kernarg_size 64
  .amdhsa_user_sgpr_count 2
  .amdhsa_user_sgpr_kernarg_segment_ptr 1
  .amdhsa_system_sgpr_workgroup_id_x 1
.end_amdhsa_kernel
```
